```python
import torch

def _softmax(x, axis=-1):
    return torch.softmax(x, dim=axis)

def _gelu(x):
    return torch.nn.functional.gelu(x, approximate='tanh')

def _silu(x):
    return torch.nn.functional.silu(x)

def _sigmoid(x):
    return torch.sigmoid(x)

def _layernorm(x, axis=-1, eps=1e-05):
    m = x.mean(dim=axis, keepdim=True)
    v = x.var(dim=axis, keepdim=True, unbiased=False)
    return (x - m) / torch.sqrt(v + eps)

def _scatter_add(tgt, idx, src, axis=0):
    return tgt.clone().index_add_(axis, idx, src)

def _segment_sum(src, seg, n):
    out = torch.zeros((n,) + src.shape[1:], dtype=src.dtype)
    return out.index_add_(0, seg, src)

def _pad(x, pw):
    flat = tuple((v for pair in reversed(pw) for v in pair))
    return torch.nn.functional.pad(x, flat)
kernel_name = 'recurrent_scan__mha_block_cached__mixer_gmlp__prompt'

def setup_inputs():

    _w = lambda a: (lambda t: t.to(torch.bfloat16) if t.is_floating_point() else t)(torch.as_tensor(a))

    def _A_setup():
        B, Sq, D = (1, 2048, 448)
        H, Sk, Dh = (16, 2048, 256)
        return {'x': _w((lambda *s: torch.randn(*s, dtype=torch.bfloat16) * 0.05)(B, Sq, D)), 'k_cache': _w((lambda *s: torch.randn(*s, dtype=torch.bfloat16) * 0.8)(B, H, Sk, Dh)), 'v_cache': _w((lambda *s: torch.randn(*s, dtype=torch.bfloat16) * 0.2)(B, H, Sk, Dh)), 'wq': _w((lambda *s: torch.randn(*s, dtype=torch.bfloat16) * 0.8)(D, H * Dh) * D ** (-0.5)), 'wo': _w((lambda *s: torch.randn(*s, dtype=torch.bfloat16) * 0.2)(H * Dh, D) * (H * Dh) ** (-0.5))}
    _A_in = _A_setup()

    def _B_setup():
        B, S, D, F = (1, 2048, 448, 1792)
        Fh = F // 2
        return {'x': _w((lambda *s: torch.randn(*s, dtype=torch.bfloat16) * 0.05)(B, S, D)), 'w_in': _w((lambda *s: torch.randn(*s, dtype=torch.bfloat16) * 0.4)(D, 2 * Fh)), 'w_sp': _w(0.01 * (lambda *s: torch.randn(*s, dtype=torch.bfloat16) * 0.4)(S, S)), 'b_sp': _w(1.0 + 0.01 * (lambda *s: torch.randn(*s, dtype=torch.bfloat16) * 0.1)(S)), 'w_out': _w((lambda *s: torch.randn(*s, dtype=torch.bfloat16) * 0.1)(Fh, D))}
    _B_in = _B_setup()
    return {'A_x': _A_in['x'], 'A_k_cache': _A_in['k_cache'], 'A_v_cache': _A_in['v_cache'], 'A_wq': _A_in['wq'], 'A_wo': _A_in['wo'], 'B_x': _B_in['x'], 'B_w_in': _B_in['w_in'], 'B_w_sp': _B_in['w_sp'], 'B_b_sp': _B_in['b_sp'], 'B_w_out': _B_in['w_out']}

def reference(A_x, A_k_cache, A_v_cache, A_wq, A_wo, B_x, B_w_in, B_w_sp, B_b_sp, B_w_out):

    def _A_ref(x, k_cache, v_cache, wq, wo):
        B, Sq, D = x.shape
        H, Dh = (16, 256)
        q = (lambda x, *d: x.permute(*d))((x @ wq).reshape(B, Sq, H, Dh), 0, 2, 1, 3)
        scores = torch.einsum('bhqd,bhkd->bhqk', q, k_cache) * Dh ** (-0.5)
        p = _softmax(scores, axis=-1)
        o = torch.einsum('bhqk,bhkd->bhqd', p, v_cache)
        return (lambda x, *d: x.permute(*d))(o, 0, 2, 1, 3).reshape(B, Sq, H * Dh) @ wo

    def _B_ref(x, w_in, w_sp, b_sp, w_out):
        B, S, D = x.shape
        F = w_in.shape[-1]
        Fh = F // 2
        z = _gelu(torch.einsum('bsd,df->bsf', x, w_in))
        z1 = z[..., :Fh].clone()
        z2 = _layernorm(z[..., Fh:], axis=-1)
        g = torch.einsum('ts,bsf->btf', w_sp, z2) + b_sp[None, :, None]
        return torch.einsum('bsf,fd->bsd', z1 * g, w_out)
    x = A_x
    xn = _layernorm(x, axis=-1)
    s = _A_ref(xn, A_k_cache, A_v_cache, A_wq, A_wo)
    g = _silu(_B_ref(xn, B_w_in, B_w_sp, B_b_sp, B_w_out))
    return x + s * g
```

```asm
; @launch kernel=attn_kernel grid=(256,1,1) block=(256,1,1) lds=163840
; @launch kernel=fin_kernel grid=(224,1,1) block=(256,1,1) lds=65536
.amdgcn_target "amdgcn-amd-amdhsa--gfx950"
.text
.globl attn_kernel
.p2align 8
.type attn_kernel,@function
attn_kernel:
    s_cmp_ge_u32 s2, 256
    s_cbranch_scc1 L_attn_end
    s_load_dwordx4 s[40:43], s[0:1], 8
    s_load_dwordx2 s[44:45], s[0:1], 24
    s_load_dwordx2 s[46:47], s[0:1], 96
    s_load_dwordx2 s[58:59], s[0:1], 0
    s_load_dwordx2 s[60:61], s[0:1], 48
    s_load_dwordx2 s[62:63], s[0:1], 88
    s_and_b32 s32, s2, 7
    s_lshl_b32 s32, s32, 1
    s_lshr_b32 s33, s2, 3
    s_and_b32 s25, s33, 1
    s_add_u32 s25, s25, s32
    s_lshr_b32 s26, s2, 4
    v_lshrrev_b32 v2, 6, v0
    v_and_b32 v1, 63, v0
    v_readfirstlane_b32 s24, v2
    s_mov_b32 s31, 0x3db8aa3b
    s_mov_b32 s37, 0x41000000
    s_mov_b32 s38, 0xffff0000
    v_lshrrev_b32 v2, 5, v1
    v_and_b32 v3, 31, v1
    s_lshl_b32 s32, s26, 7
    s_lshl_b32 s33, s24, 5
    s_add_u32 s32, s32, s33
    v_add_u32 v40, s32, v3
    s_movk_i32 s33, 896
    v_mul_lo_u32 v41, v40, s33
    v_lshl_add_u32 v41, v2, 4, v41
    s_waitcnt lgkmcnt(0)
    s_add_u32 s16, s58, 0
    s_addc_u32 s17, s59, 0
    s_mov_b32 s18, 1835008
    s_mov_b32 s19, 0x20000
    buffer_load_dwordx4 v[48:51], v41, s[16:19], 0 offen offset:0
    buffer_load_dwordx4 v[52:55], v41, s[16:19], 0 offen offset:32
    buffer_load_dwordx4 v[56:59], v41, s[16:19], 0 offen offset:64
    buffer_load_dwordx4 v[60:63], v41, s[16:19], 0 offen offset:96
    buffer_load_dwordx4 v[64:67], v41, s[16:19], 0 offen offset:128
    buffer_load_dwordx4 v[68:71], v41, s[16:19], 0 offen offset:160
    buffer_load_dwordx4 v[72:75], v41, s[16:19], 0 offen offset:192
    buffer_load_dwordx4 v[76:79], v41, s[16:19], 0 offen offset:224
    buffer_load_dwordx4 v[80:83], v41, s[16:19], 0 offen offset:256
    buffer_load_dwordx4 v[84:87], v41, s[16:19], 0 offen offset:288
    buffer_load_dwordx4 v[88:91], v41, s[16:19], 0 offen offset:320
    buffer_load_dwordx4 v[92:95], v41, s[16:19], 0 offen offset:352
    buffer_load_dwordx4 v[96:99], v41, s[16:19], 0 offen offset:384
    buffer_load_dwordx4 v[100:103], v41, s[16:19], 0 offen offset:416
    buffer_load_dwordx4 v[104:107], v41, s[16:19], 0 offen offset:448
    buffer_load_dwordx4 v[108:111], v41, s[16:19], 0 offen offset:480
    buffer_load_dwordx4 v[112:115], v41, s[16:19], 0 offen offset:512
    buffer_load_dwordx4 v[116:119], v41, s[16:19], 0 offen offset:544
    buffer_load_dwordx4 v[120:123], v41, s[16:19], 0 offen offset:576
    buffer_load_dwordx4 v[124:127], v41, s[16:19], 0 offen offset:608
    buffer_load_dwordx4 v[128:131], v41, s[16:19], 0 offen offset:640
    buffer_load_dwordx4 v[132:135], v41, s[16:19], 0 offen offset:672
    buffer_load_dwordx4 v[136:139], v41, s[16:19], 0 offen offset:704
    buffer_load_dwordx4 v[140:143], v41, s[16:19], 0 offen offset:736
    buffer_load_dwordx4 v[144:147], v41, s[16:19], 0 offen offset:768
    buffer_load_dwordx4 v[148:151], v41, s[16:19], 0 offen offset:800
    buffer_load_dwordx4 v[152:155], v41, s[16:19], 0 offen offset:832
    buffer_load_dwordx4 v[156:159], v41, s[16:19], 0 offen offset:864
    v_lshlrev_b32 v38, 13, v40
    v_lshl_add_u32 v38, v2, 4, v38
    s_lshl_b32 s32, s25, 9
    v_add_u32 v38, s32, v38
    s_movk_i32 s33, 1792
    v_mul_lo_u32 v33, v40, s33
    v_lshl_add_u32 v33, v2, 4, v33
    s_and_b32 s32, s25, 7
    s_mul_i32 s32, s32, 224
    v_add_u32 v33, s32, v33
    s_lshl_b32 s32, s25, 20
    s_add_u32 s4, s40, s32
    s_addc_u32 s5, s41, 0
    s_mov_b32 s6, 1048576
    s_mov_b32 s7, 0x20000
    s_add_u32 s8, s42, s32
    s_addc_u32 s9, s43, 0
    s_mov_b32 s10, 1048576
    s_mov_b32 s11, 0x20000
    s_lshl_b32 s32, s25, 9
    s_add_u32 s12, s44, s32
    s_addc_u32 s13, s45, 0
    s_sub_u32 s14, 3670016, s32
    s_mov_b32 s15, 0x20000
    s_add_u32 s20, s46, 16777216
    s_addc_u32 s21, s47, 0
    s_mov_b32 s22, 16777216
    s_mov_b32 s23, 0x20000
    s_add_u32 s48, s60, 0
    s_addc_u32 s49, s61, 0
    s_mov_b32 s50, 1605632
    s_mov_b32 s51, 0x20000
    s_mov_b32 s32, 2097152
    s_cmp_ge_u32 s25, 8
    s_cselect_b32 s32, 6291456, s32
    s_add_u32 s52, s46, s32
    s_addc_u32 s53, s47, 0
    s_mov_b32 s54, 3670016
    s_mov_b32 s55, 0x20000
    s_lshl_b32 s27, s24, 12
    s_mul_i32 s32, s26, 28
    s_mul_i32 s33, s24, 7
    s_add_u32 s32, s32, s33
    v_lshlrev_b32 v42, 13, v2
    v_lshl_add_u32 v42, v3, 4, v42
    s_lshl_b32 s33, s32, 13
    buffer_load_dwordx4 v[192:195], v42, s[12:15], s33 offen
    s_add_u32 s33, s33, 16384
    buffer_load_dwordx4 v[196:199], v42, s[12:15], s33 offen
    s_add_u32 s33, s33, 16384
    buffer_load_dwordx4 v[200:203], v42, s[12:15], s33 offen
    s_add_u32 s33, s33, 16384
    buffer_load_dwordx4 v[204:207], v42, s[12:15], s33 offen
    s_add_u32 s33, s33, 16384
    v_lshrrev_b32 v42, 4, v1
    s_movk_i32 s33, 3584
    v_mul_lo_u32 v42, v42, s33
    v_and_b32 v43, 15, v1
    v_lshl_add_u32 v42, v43, 4, v42
    s_mul_i32 s33, s32, 3584
    s_mul_i32 s39, s25, 224
    s_add_u32 s33, s33, s39
    buffer_load_dwordx4 v[208:211], v42, s[48:51], s33 offen
    s_add_u32 s33, s33, 14336
    buffer_load_dwordx4 v[212:215], v42, s[48:51], s33 offen
    s_add_u32 s33, s33, 14336
    v_lshrrev_b32 v42, 4, v1
    v_and_b32 v43, 15, v1
    s_lshl_b32 s32, s24, 4
    s_movk_i32 s33, 3584
    s_mul_i32 s39, s25, 224
    v_add_u32 v40, 0, v42
    v_add_u32 v40, s32, v40
    v_and_b32 v41, 3, v40
    v_lshlrev_b32 v41, 2, v41
    v_xor_b32 v41, v41, v43
    v_lshlrev_b32 v41, 4, v41
    v_mul_lo_u32 v40, v40, s33
    v_add3_u32 v232, v40, v41, s39
    v_add_u32 v40, 4, v42
    v_add_u32 v40, s32, v40
    v_and_b32 v41, 3, v40
    v_lshlrev_b32 v41, 2, v41
    v_xor_b32 v41, v41, v43
    v_lshlrev_b32 v41, 4, v41
    v_mul_lo_u32 v40, v40, s33
    v_add3_u32 v233, v40, v41, s39
    v_add_u32 v40, 8, v42
    v_add_u32 v40, s32, v40
    v_and_b32 v41, 3, v40
    v_lshlrev_b32 v41, 2, v41
    v_xor_b32 v41, v41, v43
    v_lshlrev_b32 v41, 4, v41
    v_mul_lo_u32 v40, v40, s33
    v_add3_u32 v234, v40, v41, s39
    v_add_u32 v40, 12, v42
    v_add_u32 v40, s32, v40
    v_and_b32 v41, 3, v40
    v_lshlrev_b32 v41, 2, v41
    v_xor_b32 v41, v41, v43
    v_lshlrev_b32 v41, 4, v41
    v_mul_lo_u32 v40, v40, s33
    v_add3_u32 v235, v40, v41, s39
    s_mov_b32 s36, 0
    s_add_u32 m0, s27, 114688
    s_nop 0
    buffer_load_dwordx4 v232, s[48:51], s36 offen lds
    s_add_u32 m0, s27, 115712
    s_nop 0
    buffer_load_dwordx4 v233, s[48:51], s36 offen lds
    s_add_u32 m0, s27, 116736
    s_nop 0
    buffer_load_dwordx4 v234, s[48:51], s36 offen lds
    s_add_u32 m0, s27, 117760
    s_nop 0
    buffer_load_dwordx4 v235, s[48:51], s36 offen lds
    s_mov_b32 s36, 229376
    s_add_u32 m0, s27, 65536
    s_nop 0
    buffer_load_dwordx4 v232, s[48:51], s36 offen lds
    s_add_u32 m0, s27, 66560
    s_nop 0
    buffer_load_dwordx4 v233, s[48:51], s36 offen lds
    s_add_u32 m0, s27, 67584
    s_nop 0
    buffer_load_dwordx4 v234, s[48:51], s36 offen lds
    s_add_u32 m0, s27, 68608
    s_nop 0
    buffer_load_dwordx4 v235, s[48:51], s36 offen lds
    v_bfe_u32 v42, v1, 2, 2
    v_bfe_u32 v43, v1, 4, 1
    v_and_b32 v44, 3, v1
    v_lshrrev_b32 v40, 1, v44
    v_lshl_add_u32 v40, v43, 1, v40
    v_add_u32 v40, 0, v40
    v_lshlrev_b32 v41, 2, v42
    v_xor_b32 v40, v40, v41
    v_lshlrev_b32 v40, 4, v40
    v_and_b32 v41, 1, v44
    v_lshl_add_u32 v40, v41, 3, v40
    v_lshl_add_u32 v41, v2, 3, v42
    v_lshl_add_u32 v45, v41, 8, v40
    v_add_u32 v236, 65536, v45
    v_lshrrev_b32 v40, 1, v44
    v_lshl_add_u32 v40, v43, 1, v40
    v_add_u32 v40, 4, v40
    v_lshlrev_b32 v41, 2, v42
    v_xor_b32 v40, v40, v41
    v_lshlrev_b32 v40, 4, v40
    v_and_b32 v41, 1, v44
    v_lshl_add_u32 v40, v41, 3, v40
    v_lshl_add_u32 v41, v2, 3, v42
    v_lshl_add_u32 v45, v41, 8, v40
    v_add_u32 v237, 65536, v45
    v_lshrrev_b32 v40, 1, v44
    v_lshl_add_u32 v40, v43, 1, v40
    v_add_u32 v40, 8, v40
    v_lshlrev_b32 v41, 2, v42
    v_xor_b32 v40, v40, v41
    v_lshlrev_b32 v40, 4, v40
    v_and_b32 v41, 1, v44
    v_lshl_add_u32 v40, v41, 3, v40
    v_lshl_add_u32 v41, v2, 3, v42
    v_lshl_add_u32 v45, v41, 8, v40
    v_add_u32 v238, 65536, v45
    v_lshrrev_b32 v40, 1, v44
    v_lshl_add_u32 v40, v43, 1, v40
    v_add_u32 v40, 12, v40
    v_lshlrev_b32 v41, 2, v42
    v_xor_b32 v40, v40, v41
    v_lshlrev_b32 v40, 4, v40
    v_and_b32 v41, 1, v44
    v_lshl_add_u32 v40, v41, 3, v40
    v_lshl_add_u32 v41, v2, 3, v42
    v_lshl_add_u32 v45, v41, 8, v40
    v_add_u32 v239, 65536, v45
    s_mov_b32 s32, 0x3f803f80
    v_mov_b32 v32, s32
    v_mov_b32 v160, 0
    v_mov_b32 v161, 0
    v_mov_b32 v162, 0
    v_mov_b32 v163, 0
    s_waitcnt vmcnt(14)
    v_dot2_f32_bf16 v160, v48, v32, v160
    v_dot2_f32_bf16 v161, v48, v48, v161
    v_dot2_f32_bf16 v162, v49, v32, v162
    v_dot2_f32_bf16 v163, v49, v49, v163
    v_dot2_f32_bf16 v160, v50, v32, v160
    v_dot2_f32_bf16 v161, v50, v50, v161
    v_dot2_f32_bf16 v162, v51, v32, v162
    v_dot2_f32_bf16 v163, v51, v51, v163
    v_dot2_f32_bf16 v160, v52, v32, v160
    v_dot2_f32_bf16 v161, v52, v52, v161
    v_dot2_f32_bf16 v162, v53, v32, v162
    v_dot2_f32_bf16 v163, v53, v53, v163
    v_dot2_f32_bf16 v160, v54, v32, v160
    v_dot2_f32_bf16 v161, v54, v54, v161
    v_dot2_f32_bf16 v162, v55, v32, v162
    v_dot2_f32_bf16 v163, v55, v55, v163
    v_dot2_f32_bf16 v160, v56, v32, v160
    v_dot2_f32_bf16 v161, v56, v56, v161
    v_dot2_f32_bf16 v162, v57, v32, v162
    v_dot2_f32_bf16 v163, v57, v57, v163
    s_mov_b32 s36, 458752
    v_dot2_f32_bf16 v160, v58, v32, v160
    v_dot2_f32_bf16 v161, v58, v58, v161
    v_dot2_f32_bf16 v162, v59, v32, v162
    v_dot2_f32_bf16 v163, v59, v59, v163
    v_dot2_f32_bf16 v160, v60, v32, v160
    v_dot2_f32_bf16 v161, v60, v60, v161
    v_dot2_f32_bf16 v162, v61, v32, v162
    v_dot2_f32_bf16 v163, v61, v61, v163
    v_dot2_f32_bf16 v160, v62, v32, v160
    v_dot2_f32_bf16 v161, v62, v62, v161
    v_dot2_f32_bf16 v162, v63, v32, v162
    v_dot2_f32_bf16 v163, v63, v63, v163
    v_dot2_f32_bf16 v160, v64, v32, v160
    v_dot2_f32_bf16 v161, v64, v64, v161
    v_dot2_f32_bf16 v162, v65, v32, v162
    v_dot2_f32_bf16 v163, v65, v65, v163
    v_dot2_f32_bf16 v160, v66, v32, v160
    v_dot2_f32_bf16 v161, v66, v66, v161
    v_dot2_f32_bf16 v162, v67, v32, v162
    v_dot2_f32_bf16 v163, v67, v67, v163
    s_add_u32 m0, s27, 81920
    s_nop 0
    buffer_load_dwordx4 v232, s[48:51], s36 offen lds
    v_dot2_f32_bf16 v160, v68, v32, v160
    v_dot2_f32_bf16 v161, v68, v68, v161
    v_dot2_f32_bf16 v162, v69, v32, v162
    v_dot2_f32_bf16 v163, v69, v69, v163
    v_dot2_f32_bf16 v160, v70, v32, v160
    v_dot2_f32_bf16 v161, v70, v70, v161
    v_dot2_f32_bf16 v162, v71, v32, v162
    v_dot2_f32_bf16 v163, v71, v71, v163
    v_dot2_f32_bf16 v160, v72, v32, v160
    v_dot2_f32_bf16 v161, v72, v72, v161
    v_dot2_f32_bf16 v162, v73, v32, v162
    v_dot2_f32_bf16 v163, v73, v73, v163
    v_dot2_f32_bf16 v160, v74, v32, v160
    v_dot2_f32_bf16 v161, v74, v74, v161
    v_dot2_f32_bf16 v162, v75, v32, v162
    v_dot2_f32_bf16 v163, v75, v75, v163
    v_dot2_f32_bf16 v160, v76, v32, v160
    v_dot2_f32_bf16 v161, v76, v76, v161
    v_dot2_f32_bf16 v162, v77, v32, v162
    v_dot2_f32_bf16 v163, v77, v77, v163
    s_add_u32 m0, s27, 82944
    s_nop 0
    buffer_load_dwordx4 v233, s[48:51], s36 offen lds
    v_dot2_f32_bf16 v160, v78, v32, v160
    v_dot2_f32_bf16 v161, v78, v78, v161
    v_dot2_f32_bf16 v162, v79, v32, v162
    v_dot2_f32_bf16 v163, v79, v79, v163
    v_dot2_f32_bf16 v160, v80, v32, v160
    v_dot2_f32_bf16 v161, v80, v80, v161
    v_dot2_f32_bf16 v162, v81, v32, v162
    v_dot2_f32_bf16 v163, v81, v81, v163
    v_dot2_f32_bf16 v160, v82, v32, v160
    v_dot2_f32_bf16 v161, v82, v82, v161
    v_dot2_f32_bf16 v162, v83, v32, v162
    v_dot2_f32_bf16 v163, v83, v83, v163
    v_dot2_f32_bf16 v160, v84, v32, v160
    v_dot2_f32_bf16 v161, v84, v84, v161
    v_dot2_f32_bf16 v162, v85, v32, v162
    v_dot2_f32_bf16 v163, v85, v85, v163
    v_dot2_f32_bf16 v160, v86, v32, v160
    v_dot2_f32_bf16 v161, v86, v86, v161
    v_dot2_f32_bf16 v162, v87, v32, v162
    v_dot2_f32_bf16 v163, v87, v87, v163
    s_add_u32 m0, s27, 83968
    s_nop 0
    buffer_load_dwordx4 v234, s[48:51], s36 offen lds
    v_dot2_f32_bf16 v160, v88, v32, v160
    v_dot2_f32_bf16 v161, v88, v88, v161
    v_dot2_f32_bf16 v162, v89, v32, v162
    v_dot2_f32_bf16 v163, v89, v89, v163
    v_dot2_f32_bf16 v160, v90, v32, v160
    v_dot2_f32_bf16 v161, v90, v90, v161
    v_dot2_f32_bf16 v162, v91, v32, v162
    v_dot2_f32_bf16 v163, v91, v91, v163
    v_dot2_f32_bf16 v160, v92, v32, v160
    v_dot2_f32_bf16 v161, v92, v92, v161
    v_dot2_f32_bf16 v162, v93, v32, v162
    v_dot2_f32_bf16 v163, v93, v93, v163
    v_dot2_f32_bf16 v160, v94, v32, v160
    v_dot2_f32_bf16 v161, v94, v94, v161
    v_dot2_f32_bf16 v162, v95, v32, v162
    v_dot2_f32_bf16 v163, v95, v95, v163
    v_dot2_f32_bf16 v160, v96, v32, v160
    v_dot2_f32_bf16 v161, v96, v96, v161
    v_dot2_f32_bf16 v162, v97, v32, v162
    v_dot2_f32_bf16 v163, v97, v97, v163
    s_add_u32 m0, s27, 84992
    s_nop 0
    buffer_load_dwordx4 v235, s[48:51], s36 offen lds
    v_dot2_f32_bf16 v160, v98, v32, v160
    v_dot2_f32_bf16 v161, v98, v98, v161
    v_dot2_f32_bf16 v162, v99, v32, v162
    v_dot2_f32_bf16 v163, v99, v99, v163
    v_dot2_f32_bf16 v160, v100, v32, v160
    v_dot2_f32_bf16 v161, v100, v100, v161
    v_dot2_f32_bf16 v162, v101, v32, v162
    v_dot2_f32_bf16 v163, v101, v101, v163
    v_dot2_f32_bf16 v160, v102, v32, v160
    v_dot2_f32_bf16 v161, v102, v102, v161
    v_dot2_f32_bf16 v162, v103, v32, v162
    v_dot2_f32_bf16 v163, v103, v103, v163
    v_dot2_f32_bf16 v160, v104, v32, v160
    v_dot2_f32_bf16 v161, v104, v104, v161
    v_dot2_f32_bf16 v162, v105, v32, v162
    v_dot2_f32_bf16 v163, v105, v105, v163
    v_dot2_f32_bf16 v160, v106, v32, v160
    v_dot2_f32_bf16 v161, v106, v106, v161
    v_dot2_f32_bf16 v162, v107, v32, v162
    v_dot2_f32_bf16 v163, v107, v107, v163
    s_mov_b32 s36, 688128
    v_dot2_f32_bf16 v160, v108, v32, v160
    v_dot2_f32_bf16 v161, v108, v108, v161
    v_dot2_f32_bf16 v162, v109, v32, v162
    v_dot2_f32_bf16 v163, v109, v109, v163
    v_dot2_f32_bf16 v160, v110, v32, v160
    v_dot2_f32_bf16 v161, v110, v110, v161
    v_dot2_f32_bf16 v162, v111, v32, v162
    v_dot2_f32_bf16 v163, v111, v111, v163
    v_dot2_f32_bf16 v160, v112, v32, v160
    v_dot2_f32_bf16 v161, v112, v112, v161
    v_dot2_f32_bf16 v162, v113, v32, v162
    v_dot2_f32_bf16 v163, v113, v113, v163
    v_dot2_f32_bf16 v160, v114, v32, v160
    v_dot2_f32_bf16 v161, v114, v114, v161
    v_dot2_f32_bf16 v162, v115, v32, v162
    v_dot2_f32_bf16 v163, v115, v115, v163
    v_dot2_f32_bf16 v160, v116, v32, v160
    v_dot2_f32_bf16 v161, v116, v116, v161
    v_dot2_f32_bf16 v162, v117, v32, v162
    v_dot2_f32_bf16 v163, v117, v117, v163
    s_add_u32 m0, s27, 98304
    s_nop 0
    buffer_load_dwordx4 v232, s[48:51], s36 offen lds
    v_dot2_f32_bf16 v160, v118, v32, v160
    v_dot2_f32_bf16 v161, v118, v118, v161
    v_dot2_f32_bf16 v162, v119, v32, v162
    v_dot2_f32_bf16 v163, v119, v119, v163
    v_dot2_f32_bf16 v160, v120, v32, v160
    v_dot2_f32_bf16 v161, v120, v120, v161
    v_dot2_f32_bf16 v162, v121, v32, v162
    v_dot2_f32_bf16 v163, v121, v121, v163
    v_dot2_f32_bf16 v160, v122, v32, v160
    v_dot2_f32_bf16 v161, v122, v122, v161
    v_dot2_f32_bf16 v162, v123, v32, v162
    v_dot2_f32_bf16 v163, v123, v123, v163
    v_dot2_f32_bf16 v160, v124, v32, v160
    v_dot2_f32_bf16 v161, v124, v124, v161
    v_dot2_f32_bf16 v162, v125, v32, v162
    v_dot2_f32_bf16 v163, v125, v125, v163
    v_dot2_f32_bf16 v160, v126, v32, v160
    v_dot2_f32_bf16 v161, v126, v126, v161
    v_dot2_f32_bf16 v162, v127, v32, v162
    v_dot2_f32_bf16 v163, v127, v127, v163
    s_add_u32 m0, s27, 99328
    s_nop 0
    buffer_load_dwordx4 v233, s[48:51], s36 offen lds
    v_dot2_f32_bf16 v160, v128, v32, v160
    v_dot2_f32_bf16 v161, v128, v128, v161
    v_dot2_f32_bf16 v162, v129, v32, v162
    v_dot2_f32_bf16 v163, v129, v129, v163
    v_dot2_f32_bf16 v160, v130, v32, v160
    v_dot2_f32_bf16 v161, v130, v130, v161
    v_dot2_f32_bf16 v162, v131, v32, v162
    v_dot2_f32_bf16 v163, v131, v131, v163
    v_dot2_f32_bf16 v160, v132, v32, v160
    v_dot2_f32_bf16 v161, v132, v132, v161
    v_dot2_f32_bf16 v162, v133, v32, v162
    v_dot2_f32_bf16 v163, v133, v133, v163
    v_dot2_f32_bf16 v160, v134, v32, v160
    v_dot2_f32_bf16 v161, v134, v134, v161
    v_dot2_f32_bf16 v162, v135, v32, v162
    v_dot2_f32_bf16 v163, v135, v135, v163
    v_dot2_f32_bf16 v160, v136, v32, v160
    v_dot2_f32_bf16 v161, v136, v136, v161
    v_dot2_f32_bf16 v162, v137, v32, v162
    v_dot2_f32_bf16 v163, v137, v137, v163
    s_add_u32 m0, s27, 100352
    s_nop 0
    buffer_load_dwordx4 v234, s[48:51], s36 offen lds
    v_dot2_f32_bf16 v160, v138, v32, v160
    v_dot2_f32_bf16 v161, v138, v138, v161
    v_dot2_f32_bf16 v162, v139, v32, v162
    v_dot2_f32_bf16 v163, v139, v139, v163
    v_dot2_f32_bf16 v160, v140, v32, v160
    v_dot2_f32_bf16 v161, v140, v140, v161
    v_dot2_f32_bf16 v162, v141, v32, v162
    v_dot2_f32_bf16 v163, v141, v141, v163
    v_dot2_f32_bf16 v160, v142, v32, v160
    v_dot2_f32_bf16 v161, v142, v142, v161
    v_dot2_f32_bf16 v162, v143, v32, v162
    v_dot2_f32_bf16 v163, v143, v143, v163
    v_dot2_f32_bf16 v160, v144, v32, v160
    v_dot2_f32_bf16 v161, v144, v144, v161
    v_dot2_f32_bf16 v162, v145, v32, v162
    v_dot2_f32_bf16 v163, v145, v145, v163
    v_dot2_f32_bf16 v160, v146, v32, v160
    v_dot2_f32_bf16 v161, v146, v146, v161
    v_dot2_f32_bf16 v162, v147, v32, v162
    v_dot2_f32_bf16 v163, v147, v147, v163
    s_add_u32 m0, s27, 101376
    s_nop 0
    buffer_load_dwordx4 v235, s[48:51], s36 offen lds
    v_dot2_f32_bf16 v160, v148, v32, v160
    v_dot2_f32_bf16 v161, v148, v148, v161
    v_dot2_f32_bf16 v162, v149, v32, v162
    v_dot2_f32_bf16 v163, v149, v149, v163
    v_dot2_f32_bf16 v160, v150, v32, v160
    v_dot2_f32_bf16 v161, v150, v150, v161
    v_dot2_f32_bf16 v162, v151, v32, v162
    v_dot2_f32_bf16 v163, v151, v151, v163
    v_dot2_f32_bf16 v160, v152, v32, v160
    v_dot2_f32_bf16 v161, v152, v152, v161
    v_dot2_f32_bf16 v162, v153, v32, v162
    v_dot2_f32_bf16 v163, v153, v153, v163
    v_dot2_f32_bf16 v160, v154, v32, v160
    v_dot2_f32_bf16 v161, v154, v154, v161
    v_dot2_f32_bf16 v162, v155, v32, v162
    v_dot2_f32_bf16 v163, v155, v155, v163
    v_dot2_f32_bf16 v160, v156, v32, v160
    v_dot2_f32_bf16 v161, v156, v156, v161
    v_dot2_f32_bf16 v162, v157, v32, v162
    v_dot2_f32_bf16 v163, v157, v157, v163
    v_dot2_f32_bf16 v160, v158, v32, v160
    v_dot2_f32_bf16 v161, v158, v158, v161
    v_dot2_f32_bf16 v162, v159, v32, v162
    v_dot2_f32_bf16 v163, v159, v159, v163
    s_nop 3
    v_add_f32 v160, v160, v162
    v_add_f32 v161, v161, v163
    v_mov_b32 v40, v160
    v_mov_b32 v41, v161
    s_nop 1
    v_permlane32_swap_b32 v40, v160
    v_permlane32_swap_b32 v41, v161
    s_nop 1
    v_add_f32 v160, v160, v40
    v_add_f32 v161, v161, v41
    v_mul_f32 v160, 0x3b124925, v160
    v_mul_f32 v161, 0x3b124925, v161
    v_fma_f32 v161, -v160, v160, v161
    v_max_f32 v161, 0, v161
    v_cvt_pk_bf16_f32 v40, v160, v161
    v_lshlrev_b32 v160, 16, v40
    v_and_b32 v161, 0xffff0000, v40
    v_add_f32 v161, 0x3727c5ac, v161
    v_cvt_pk_bf16_f32 v40, v161, v161
    v_lshlrev_b32 v161, 16, v40
    v_sqrt_f32 v161, v161
    s_nop 0
    v_cvt_pk_bf16_f32 v40, v161, v161
    v_lshlrev_b32 v161, 16, v40
    v_rcp_f32 v161, v161
    s_nop 0
    v_lshlrev_b32 v168, 16, v48
    v_lshlrev_b32 v170, 16, v49
    v_lshlrev_b32 v172, 16, v50
    v_lshlrev_b32 v174, 16, v51
    v_and_b32 v169, s38, v48
    v_and_b32 v171, s38, v49
    v_and_b32 v173, s38, v50
    v_and_b32 v175, s38, v51
    v_sub_f32 v168, v168, v160
    v_sub_f32 v170, v170, v160
    v_sub_f32 v172, v172, v160
    v_sub_f32 v174, v174, v160
    v_sub_f32 v169, v169, v160
    v_sub_f32 v171, v171, v160
    v_sub_f32 v173, v173, v160
    v_sub_f32 v175, v175, v160
    v_cvt_pk_bf16_f32 v48, v168, v169
    v_cvt_pk_bf16_f32 v49, v170, v171
    v_cvt_pk_bf16_f32 v50, v172, v173
    v_cvt_pk_bf16_f32 v51, v174, v175
    v_lshlrev_b32 v168, 16, v48
    v_lshlrev_b32 v170, 16, v49
    v_lshlrev_b32 v172, 16, v50
    v_lshlrev_b32 v174, 16, v51
    v_and_b32 v169, s38, v48
    v_and_b32 v171, s38, v49
    v_and_b32 v173, s38, v50
    v_and_b32 v175, s38, v51
    v_mul_f32 v168, v168, v161
    v_mul_f32 v170, v170, v161
    v_mul_f32 v172, v172, v161
    v_mul_f32 v174, v174, v161
    v_mul_f32 v169, v169, v161
    v_mul_f32 v171, v171, v161
    v_mul_f32 v173, v173, v161
    v_mul_f32 v175, v175, v161
    v_cvt_pk_bf16_f32 v48, v168, v169
    v_cvt_pk_bf16_f32 v49, v170, v171
    v_cvt_pk_bf16_f32 v50, v172, v173
    v_cvt_pk_bf16_f32 v51, v174, v175
    v_accvgpr_write_b32 a128, v48
    v_accvgpr_write_b32 a129, v49
    v_accvgpr_write_b32 a130, v50
    v_accvgpr_write_b32 a131, v51
    v_lshlrev_b32 v168, 16, v52
    v_lshlrev_b32 v170, 16, v53
    v_lshlrev_b32 v172, 16, v54
    v_lshlrev_b32 v174, 16, v55
    v_and_b32 v169, s38, v52
    v_and_b32 v171, s38, v53
    v_and_b32 v173, s38, v54
    v_and_b32 v175, s38, v55
    v_sub_f32 v168, v168, v160
    v_sub_f32 v170, v170, v160
    v_sub_f32 v172, v172, v160
    v_sub_f32 v174, v174, v160
    v_sub_f32 v169, v169, v160
    v_sub_f32 v171, v171, v160
    v_sub_f32 v173, v173, v160
    v_sub_f32 v175, v175, v160
    v_cvt_pk_bf16_f32 v52, v168, v169
    v_cvt_pk_bf16_f32 v53, v170, v171
    v_cvt_pk_bf16_f32 v54, v172, v173
    v_cvt_pk_bf16_f32 v55, v174, v175
    v_lshlrev_b32 v168, 16, v52
    v_lshlrev_b32 v170, 16, v53
    v_lshlrev_b32 v172, 16, v54
    v_lshlrev_b32 v174, 16, v55
    v_and_b32 v169, s38, v52
    v_and_b32 v171, s38, v53
    v_and_b32 v173, s38, v54
    v_and_b32 v175, s38, v55
    v_mul_f32 v168, v168, v161
    v_mul_f32 v170, v170, v161
    v_mul_f32 v172, v172, v161
    v_mul_f32 v174, v174, v161
    v_mul_f32 v169, v169, v161
    v_mul_f32 v171, v171, v161
    v_mul_f32 v173, v173, v161
    v_mul_f32 v175, v175, v161
    v_cvt_pk_bf16_f32 v52, v168, v169
    v_cvt_pk_bf16_f32 v53, v170, v171
    v_cvt_pk_bf16_f32 v54, v172, v173
    v_cvt_pk_bf16_f32 v55, v174, v175
    v_accvgpr_write_b32 a132, v52
    v_accvgpr_write_b32 a133, v53
    v_accvgpr_write_b32 a134, v54
    v_accvgpr_write_b32 a135, v55
    v_lshlrev_b32 v168, 16, v56
    v_lshlrev_b32 v170, 16, v57
    v_lshlrev_b32 v172, 16, v58
    v_lshlrev_b32 v174, 16, v59
    v_and_b32 v169, s38, v56
    v_and_b32 v171, s38, v57
    v_and_b32 v173, s38, v58
    v_and_b32 v175, s38, v59
    v_sub_f32 v168, v168, v160
    v_sub_f32 v170, v170, v160
    v_sub_f32 v172, v172, v160
    v_sub_f32 v174, v174, v160
    v_sub_f32 v169, v169, v160
    v_sub_f32 v171, v171, v160
    v_sub_f32 v173, v173, v160
    v_sub_f32 v175, v175, v160
    v_cvt_pk_bf16_f32 v56, v168, v169
    v_cvt_pk_bf16_f32 v57, v170, v171
    v_cvt_pk_bf16_f32 v58, v172, v173
    v_cvt_pk_bf16_f32 v59, v174, v175
    v_lshlrev_b32 v168, 16, v56
    v_lshlrev_b32 v170, 16, v57
    v_lshlrev_b32 v172, 16, v58
    v_lshlrev_b32 v174, 16, v59
    v_and_b32 v169, s38, v56
    v_and_b32 v171, s38, v57
    v_and_b32 v173, s38, v58
    v_and_b32 v175, s38, v59
    v_mul_f32 v168, v168, v161
    v_mul_f32 v170, v170, v161
    v_mul_f32 v172, v172, v161
    v_mul_f32 v174, v174, v161
    v_mul_f32 v169, v169, v161
    v_mul_f32 v171, v171, v161
    v_mul_f32 v173, v173, v161
    v_mul_f32 v175, v175, v161
    v_cvt_pk_bf16_f32 v56, v168, v169
    v_cvt_pk_bf16_f32 v57, v170, v171
    v_cvt_pk_bf16_f32 v58, v172, v173
    v_cvt_pk_bf16_f32 v59, v174, v175
    v_accvgpr_write_b32 a136, v56
    v_accvgpr_write_b32 a137, v57
    v_accvgpr_write_b32 a138, v58
    v_accvgpr_write_b32 a139, v59
    v_lshlrev_b32 v168, 16, v60
    v_lshlrev_b32 v170, 16, v61
    v_lshlrev_b32 v172, 16, v62
    v_lshlrev_b32 v174, 16, v63
    v_and_b32 v169, s38, v60
    v_and_b32 v171, s38, v61
    v_and_b32 v173, s38, v62
    v_and_b32 v175, s38, v63
    v_sub_f32 v168, v168, v160
    v_sub_f32 v170, v170, v160
    v_sub_f32 v172, v172, v160
    v_sub_f32 v174, v174, v160
    v_sub_f32 v169, v169, v160
    v_sub_f32 v171, v171, v160
    v_sub_f32 v173, v173, v160
    v_sub_f32 v175, v175, v160
    v_cvt_pk_bf16_f32 v60, v168, v169
    v_cvt_pk_bf16_f32 v61, v170, v171
    v_cvt_pk_bf16_f32 v62, v172, v173
    v_cvt_pk_bf16_f32 v63, v174, v175
    v_lshlrev_b32 v168, 16, v60
    v_lshlrev_b32 v170, 16, v61
    v_lshlrev_b32 v172, 16, v62
    v_lshlrev_b32 v174, 16, v63
    v_and_b32 v169, s38, v60
    v_and_b32 v171, s38, v61
    v_and_b32 v173, s38, v62
    v_and_b32 v175, s38, v63
    v_mul_f32 v168, v168, v161
    v_mul_f32 v170, v170, v161
    v_mul_f32 v172, v172, v161
    v_mul_f32 v174, v174, v161
    v_mul_f32 v169, v169, v161
    v_mul_f32 v171, v171, v161
    v_mul_f32 v173, v173, v161
    v_mul_f32 v175, v175, v161
    v_cvt_pk_bf16_f32 v60, v168, v169
    v_cvt_pk_bf16_f32 v61, v170, v171
    v_cvt_pk_bf16_f32 v62, v172, v173
    v_cvt_pk_bf16_f32 v63, v174, v175
    v_accvgpr_write_b32 a140, v60
    v_accvgpr_write_b32 a141, v61
    v_accvgpr_write_b32 a142, v62
    v_accvgpr_write_b32 a143, v63
    v_lshlrev_b32 v168, 16, v64
    v_lshlrev_b32 v170, 16, v65
    v_lshlrev_b32 v172, 16, v66
    v_lshlrev_b32 v174, 16, v67
    v_and_b32 v169, s38, v64
    v_and_b32 v171, s38, v65
    v_and_b32 v173, s38, v66
    v_and_b32 v175, s38, v67
    v_sub_f32 v168, v168, v160
    v_sub_f32 v170, v170, v160
    v_sub_f32 v172, v172, v160
    v_sub_f32 v174, v174, v160
    v_sub_f32 v169, v169, v160
    v_sub_f32 v171, v171, v160
    v_sub_f32 v173, v173, v160
    v_sub_f32 v175, v175, v160
    v_cvt_pk_bf16_f32 v64, v168, v169
    v_cvt_pk_bf16_f32 v65, v170, v171
    v_cvt_pk_bf16_f32 v66, v172, v173
    v_cvt_pk_bf16_f32 v67, v174, v175
    v_lshlrev_b32 v168, 16, v64
    v_lshlrev_b32 v170, 16, v65
    v_lshlrev_b32 v172, 16, v66
    v_lshlrev_b32 v174, 16, v67
    v_and_b32 v169, s38, v64
    v_and_b32 v171, s38, v65
    v_and_b32 v173, s38, v66
    v_and_b32 v175, s38, v67
    v_mul_f32 v168, v168, v161
    v_mul_f32 v170, v170, v161
    v_mul_f32 v172, v172, v161
    v_mul_f32 v174, v174, v161
    v_mul_f32 v169, v169, v161
    v_mul_f32 v171, v171, v161
    v_mul_f32 v173, v173, v161
    v_mul_f32 v175, v175, v161
    v_cvt_pk_bf16_f32 v64, v168, v169
    v_cvt_pk_bf16_f32 v65, v170, v171
    v_cvt_pk_bf16_f32 v66, v172, v173
    v_cvt_pk_bf16_f32 v67, v174, v175
    v_accvgpr_write_b32 a144, v64
    v_accvgpr_write_b32 a145, v65
    v_accvgpr_write_b32 a146, v66
    v_accvgpr_write_b32 a147, v67
    v_lshlrev_b32 v168, 16, v68
    v_lshlrev_b32 v170, 16, v69
    v_lshlrev_b32 v172, 16, v70
    v_lshlrev_b32 v174, 16, v71
    v_and_b32 v169, s38, v68
    v_and_b32 v171, s38, v69
    v_and_b32 v173, s38, v70
    v_and_b32 v175, s38, v71
    v_sub_f32 v168, v168, v160
    v_sub_f32 v170, v170, v160
    v_sub_f32 v172, v172, v160
    v_sub_f32 v174, v174, v160
    v_sub_f32 v169, v169, v160
    v_sub_f32 v171, v171, v160
    v_sub_f32 v173, v173, v160
    v_sub_f32 v175, v175, v160
    v_cvt_pk_bf16_f32 v68, v168, v169
    v_cvt_pk_bf16_f32 v69, v170, v171
    v_cvt_pk_bf16_f32 v70, v172, v173
    v_cvt_pk_bf16_f32 v71, v174, v175
    v_lshlrev_b32 v168, 16, v68
    v_lshlrev_b32 v170, 16, v69
    v_lshlrev_b32 v172, 16, v70
    v_lshlrev_b32 v174, 16, v71
    v_and_b32 v169, s38, v68
    v_and_b32 v171, s38, v69
    v_and_b32 v173, s38, v70
    v_and_b32 v175, s38, v71
    v_mul_f32 v168, v168, v161
    v_mul_f32 v170, v170, v161
    v_mul_f32 v172, v172, v161
    v_mul_f32 v174, v174, v161
    v_mul_f32 v169, v169, v161
    v_mul_f32 v171, v171, v161
    v_mul_f32 v173, v173, v161
    v_mul_f32 v175, v175, v161
    v_cvt_pk_bf16_f32 v68, v168, v169
    v_cvt_pk_bf16_f32 v69, v170, v171
    v_cvt_pk_bf16_f32 v70, v172, v173
    v_cvt_pk_bf16_f32 v71, v174, v175
    v_accvgpr_write_b32 a148, v68
    v_accvgpr_write_b32 a149, v69
    v_accvgpr_write_b32 a150, v70
    v_accvgpr_write_b32 a151, v71
    v_lshlrev_b32 v168, 16, v72
    v_lshlrev_b32 v170, 16, v73
    v_lshlrev_b32 v172, 16, v74
    v_lshlrev_b32 v174, 16, v75
    v_and_b32 v169, s38, v72
    v_and_b32 v171, s38, v73
    v_and_b32 v173, s38, v74
    v_and_b32 v175, s38, v75
    v_sub_f32 v168, v168, v160
    v_sub_f32 v170, v170, v160
    v_sub_f32 v172, v172, v160
    v_sub_f32 v174, v174, v160
    v_sub_f32 v169, v169, v160
    v_sub_f32 v171, v171, v160
    v_sub_f32 v173, v173, v160
    v_sub_f32 v175, v175, v160
    v_cvt_pk_bf16_f32 v72, v168, v169
    v_cvt_pk_bf16_f32 v73, v170, v171
    v_cvt_pk_bf16_f32 v74, v172, v173
    v_cvt_pk_bf16_f32 v75, v174, v175
    v_lshlrev_b32 v168, 16, v72
    v_lshlrev_b32 v170, 16, v73
    v_lshlrev_b32 v172, 16, v74
    v_lshlrev_b32 v174, 16, v75
    v_and_b32 v169, s38, v72
    v_and_b32 v171, s38, v73
    v_and_b32 v173, s38, v74
    v_and_b32 v175, s38, v75
    v_mul_f32 v168, v168, v161
    v_mul_f32 v170, v170, v161
    v_mul_f32 v172, v172, v161
    v_mul_f32 v174, v174, v161
    v_mul_f32 v169, v169, v161
    v_mul_f32 v171, v171, v161
    v_mul_f32 v173, v173, v161
    v_mul_f32 v175, v175, v161
    v_cvt_pk_bf16_f32 v72, v168, v169
    v_cvt_pk_bf16_f32 v73, v170, v171
    v_cvt_pk_bf16_f32 v74, v172, v173
    v_cvt_pk_bf16_f32 v75, v174, v175
    v_accvgpr_write_b32 a152, v72
    v_accvgpr_write_b32 a153, v73
    v_accvgpr_write_b32 a154, v74
    v_accvgpr_write_b32 a155, v75
    v_lshlrev_b32 v168, 16, v76
    v_lshlrev_b32 v170, 16, v77
    v_lshlrev_b32 v172, 16, v78
    v_lshlrev_b32 v174, 16, v79
    v_and_b32 v169, s38, v76
    v_and_b32 v171, s38, v77
    v_and_b32 v173, s38, v78
    v_and_b32 v175, s38, v79
    v_sub_f32 v168, v168, v160
    v_sub_f32 v170, v170, v160
    v_sub_f32 v172, v172, v160
    v_sub_f32 v174, v174, v160
    v_sub_f32 v169, v169, v160
    v_sub_f32 v171, v171, v160
    v_sub_f32 v173, v173, v160
    v_sub_f32 v175, v175, v160
    v_cvt_pk_bf16_f32 v76, v168, v169
    v_cvt_pk_bf16_f32 v77, v170, v171
    v_cvt_pk_bf16_f32 v78, v172, v173
    v_cvt_pk_bf16_f32 v79, v174, v175
    v_lshlrev_b32 v168, 16, v76
    v_lshlrev_b32 v170, 16, v77
    v_lshlrev_b32 v172, 16, v78
    v_lshlrev_b32 v174, 16, v79
    v_and_b32 v169, s38, v76
    v_and_b32 v171, s38, v77
    v_and_b32 v173, s38, v78
    v_and_b32 v175, s38, v79
    v_mul_f32 v168, v168, v161
    v_mul_f32 v170, v170, v161
    v_mul_f32 v172, v172, v161
    v_mul_f32 v174, v174, v161
    v_mul_f32 v169, v169, v161
    v_mul_f32 v171, v171, v161
    v_mul_f32 v173, v173, v161
    v_mul_f32 v175, v175, v161
    v_cvt_pk_bf16_f32 v76, v168, v169
    v_cvt_pk_bf16_f32 v77, v170, v171
    v_cvt_pk_bf16_f32 v78, v172, v173
    v_cvt_pk_bf16_f32 v79, v174, v175
    v_accvgpr_write_b32 a156, v76
    v_accvgpr_write_b32 a157, v77
    v_accvgpr_write_b32 a158, v78
    v_accvgpr_write_b32 a159, v79
    v_lshlrev_b32 v168, 16, v80
    v_lshlrev_b32 v170, 16, v81
    v_lshlrev_b32 v172, 16, v82
    v_lshlrev_b32 v174, 16, v83
    v_and_b32 v169, s38, v80
    v_and_b32 v171, s38, v81
    v_and_b32 v173, s38, v82
    v_and_b32 v175, s38, v83
    v_sub_f32 v168, v168, v160
    v_sub_f32 v170, v170, v160
    v_sub_f32 v172, v172, v160
    v_sub_f32 v174, v174, v160
    v_sub_f32 v169, v169, v160
    v_sub_f32 v171, v171, v160
    v_sub_f32 v173, v173, v160
    v_sub_f32 v175, v175, v160
    v_cvt_pk_bf16_f32 v80, v168, v169
    v_cvt_pk_bf16_f32 v81, v170, v171
    v_cvt_pk_bf16_f32 v82, v172, v173
    v_cvt_pk_bf16_f32 v83, v174, v175
    v_lshlrev_b32 v168, 16, v80
    v_lshlrev_b32 v170, 16, v81
    v_lshlrev_b32 v172, 16, v82
    v_lshlrev_b32 v174, 16, v83
    v_and_b32 v169, s38, v80
    v_and_b32 v171, s38, v81
    v_and_b32 v173, s38, v82
    v_and_b32 v175, s38, v83
    v_mul_f32 v168, v168, v161
    v_mul_f32 v170, v170, v161
    v_mul_f32 v172, v172, v161
    v_mul_f32 v174, v174, v161
    v_mul_f32 v169, v169, v161
    v_mul_f32 v171, v171, v161
    v_mul_f32 v173, v173, v161
    v_mul_f32 v175, v175, v161
    v_cvt_pk_bf16_f32 v80, v168, v169
    v_cvt_pk_bf16_f32 v81, v170, v171
    v_cvt_pk_bf16_f32 v82, v172, v173
    v_cvt_pk_bf16_f32 v83, v174, v175
    v_accvgpr_write_b32 a160, v80
    v_accvgpr_write_b32 a161, v81
    v_accvgpr_write_b32 a162, v82
    v_accvgpr_write_b32 a163, v83
    v_lshlrev_b32 v168, 16, v84
    v_lshlrev_b32 v170, 16, v85
    v_lshlrev_b32 v172, 16, v86
    v_lshlrev_b32 v174, 16, v87
    v_and_b32 v169, s38, v84
    v_and_b32 v171, s38, v85
    v_and_b32 v173, s38, v86
    v_and_b32 v175, s38, v87
    v_sub_f32 v168, v168, v160
    v_sub_f32 v170, v170, v160
    v_sub_f32 v172, v172, v160
    v_sub_f32 v174, v174, v160
    v_sub_f32 v169, v169, v160
    v_sub_f32 v171, v171, v160
    v_sub_f32 v173, v173, v160
    v_sub_f32 v175, v175, v160
    v_cvt_pk_bf16_f32 v84, v168, v169
    v_cvt_pk_bf16_f32 v85, v170, v171
    v_cvt_pk_bf16_f32 v86, v172, v173
    v_cvt_pk_bf16_f32 v87, v174, v175
    v_lshlrev_b32 v168, 16, v84
    v_lshlrev_b32 v170, 16, v85
    v_lshlrev_b32 v172, 16, v86
    v_lshlrev_b32 v174, 16, v87
    v_and_b32 v169, s38, v84
    v_and_b32 v171, s38, v85
    v_and_b32 v173, s38, v86
    v_and_b32 v175, s38, v87
    v_mul_f32 v168, v168, v161
    v_mul_f32 v170, v170, v161
    v_mul_f32 v172, v172, v161
    v_mul_f32 v174, v174, v161
    v_mul_f32 v169, v169, v161
    v_mul_f32 v171, v171, v161
    v_mul_f32 v173, v173, v161
    v_mul_f32 v175, v175, v161
    v_cvt_pk_bf16_f32 v84, v168, v169
    v_cvt_pk_bf16_f32 v85, v170, v171
    v_cvt_pk_bf16_f32 v86, v172, v173
    v_cvt_pk_bf16_f32 v87, v174, v175
    v_accvgpr_write_b32 a164, v84
    v_accvgpr_write_b32 a165, v85
    v_accvgpr_write_b32 a166, v86
    v_accvgpr_write_b32 a167, v87
    v_lshlrev_b32 v168, 16, v88
    v_lshlrev_b32 v170, 16, v89
    v_lshlrev_b32 v172, 16, v90
    v_lshlrev_b32 v174, 16, v91
    v_and_b32 v169, s38, v88
    v_and_b32 v171, s38, v89
    v_and_b32 v173, s38, v90
    v_and_b32 v175, s38, v91
    v_sub_f32 v168, v168, v160
    v_sub_f32 v170, v170, v160
    v_sub_f32 v172, v172, v160
    v_sub_f32 v174, v174, v160
    v_sub_f32 v169, v169, v160
    v_sub_f32 v171, v171, v160
    v_sub_f32 v173, v173, v160
    v_sub_f32 v175, v175, v160
    v_cvt_pk_bf16_f32 v88, v168, v169
    v_cvt_pk_bf16_f32 v89, v170, v171
    v_cvt_pk_bf16_f32 v90, v172, v173
    v_cvt_pk_bf16_f32 v91, v174, v175
    v_lshlrev_b32 v168, 16, v88
    v_lshlrev_b32 v170, 16, v89
    v_lshlrev_b32 v172, 16, v90
    v_lshlrev_b32 v174, 16, v91
    v_and_b32 v169, s38, v88
    v_and_b32 v171, s38, v89
    v_and_b32 v173, s38, v90
    v_and_b32 v175, s38, v91
    v_mul_f32 v168, v168, v161
    v_mul_f32 v170, v170, v161
    v_mul_f32 v172, v172, v161
    v_mul_f32 v174, v174, v161
    v_mul_f32 v169, v169, v161
    v_mul_f32 v171, v171, v161
    v_mul_f32 v173, v173, v161
    v_mul_f32 v175, v175, v161
    v_cvt_pk_bf16_f32 v88, v168, v169
    v_cvt_pk_bf16_f32 v89, v170, v171
    v_cvt_pk_bf16_f32 v90, v172, v173
    v_cvt_pk_bf16_f32 v91, v174, v175
    v_accvgpr_write_b32 a168, v88
    v_accvgpr_write_b32 a169, v89
    v_accvgpr_write_b32 a170, v90
    v_accvgpr_write_b32 a171, v91
    v_lshlrev_b32 v168, 16, v92
    v_lshlrev_b32 v170, 16, v93
    v_lshlrev_b32 v172, 16, v94
    v_lshlrev_b32 v174, 16, v95
    v_and_b32 v169, s38, v92
    v_and_b32 v171, s38, v93
    v_and_b32 v173, s38, v94
    v_and_b32 v175, s38, v95
    v_sub_f32 v168, v168, v160
    v_sub_f32 v170, v170, v160
    v_sub_f32 v172, v172, v160
    v_sub_f32 v174, v174, v160
    v_sub_f32 v169, v169, v160
    v_sub_f32 v171, v171, v160
    v_sub_f32 v173, v173, v160
    v_sub_f32 v175, v175, v160
    v_cvt_pk_bf16_f32 v92, v168, v169
    v_cvt_pk_bf16_f32 v93, v170, v171
    v_cvt_pk_bf16_f32 v94, v172, v173
    v_cvt_pk_bf16_f32 v95, v174, v175
    v_lshlrev_b32 v168, 16, v92
    v_lshlrev_b32 v170, 16, v93
    v_lshlrev_b32 v172, 16, v94
    v_lshlrev_b32 v174, 16, v95
    v_and_b32 v169, s38, v92
    v_and_b32 v171, s38, v93
    v_and_b32 v173, s38, v94
    v_and_b32 v175, s38, v95
    v_mul_f32 v168, v168, v161
    v_mul_f32 v170, v170, v161
    v_mul_f32 v172, v172, v161
    v_mul_f32 v174, v174, v161
    v_mul_f32 v169, v169, v161
    v_mul_f32 v171, v171, v161
    v_mul_f32 v173, v173, v161
    v_mul_f32 v175, v175, v161
    v_cvt_pk_bf16_f32 v92, v168, v169
    v_cvt_pk_bf16_f32 v93, v170, v171
    v_cvt_pk_bf16_f32 v94, v172, v173
    v_cvt_pk_bf16_f32 v95, v174, v175
    v_accvgpr_write_b32 a172, v92
    v_accvgpr_write_b32 a173, v93
    v_accvgpr_write_b32 a174, v94
    v_accvgpr_write_b32 a175, v95
    v_lshlrev_b32 v168, 16, v96
    v_lshlrev_b32 v170, 16, v97
    v_lshlrev_b32 v172, 16, v98
    v_lshlrev_b32 v174, 16, v99
    v_and_b32 v169, s38, v96
    v_and_b32 v171, s38, v97
    v_and_b32 v173, s38, v98
    v_and_b32 v175, s38, v99
    v_sub_f32 v168, v168, v160
    v_sub_f32 v170, v170, v160
    v_sub_f32 v172, v172, v160
    v_sub_f32 v174, v174, v160
    v_sub_f32 v169, v169, v160
    v_sub_f32 v171, v171, v160
    v_sub_f32 v173, v173, v160
    v_sub_f32 v175, v175, v160
    v_cvt_pk_bf16_f32 v96, v168, v169
    v_cvt_pk_bf16_f32 v97, v170, v171
    v_cvt_pk_bf16_f32 v98, v172, v173
    v_cvt_pk_bf16_f32 v99, v174, v175
    v_lshlrev_b32 v168, 16, v96
    v_lshlrev_b32 v170, 16, v97
    v_lshlrev_b32 v172, 16, v98
    v_lshlrev_b32 v174, 16, v99
    v_and_b32 v169, s38, v96
    v_and_b32 v171, s38, v97
    v_and_b32 v173, s38, v98
    v_and_b32 v175, s38, v99
    v_mul_f32 v168, v168, v161
    v_mul_f32 v170, v170, v161
    v_mul_f32 v172, v172, v161
    v_mul_f32 v174, v174, v161
    v_mul_f32 v169, v169, v161
    v_mul_f32 v171, v171, v161
    v_mul_f32 v173, v173, v161
    v_mul_f32 v175, v175, v161
    v_cvt_pk_bf16_f32 v96, v168, v169
    v_cvt_pk_bf16_f32 v97, v170, v171
    v_cvt_pk_bf16_f32 v98, v172, v173
    v_cvt_pk_bf16_f32 v99, v174, v175
    v_accvgpr_write_b32 a176, v96
    v_accvgpr_write_b32 a177, v97
    v_accvgpr_write_b32 a178, v98
    v_accvgpr_write_b32 a179, v99
    v_lshlrev_b32 v168, 16, v100
    v_lshlrev_b32 v170, 16, v101
    v_lshlrev_b32 v172, 16, v102
    v_lshlrev_b32 v174, 16, v103
    v_and_b32 v169, s38, v100
    v_and_b32 v171, s38, v101
    v_and_b32 v173, s38, v102
    v_and_b32 v175, s38, v103
    v_sub_f32 v168, v168, v160
    v_sub_f32 v170, v170, v160
    v_sub_f32 v172, v172, v160
    v_sub_f32 v174, v174, v160
    v_sub_f32 v169, v169, v160
    v_sub_f32 v171, v171, v160
    v_sub_f32 v173, v173, v160
    v_sub_f32 v175, v175, v160
    v_cvt_pk_bf16_f32 v100, v168, v169
    v_cvt_pk_bf16_f32 v101, v170, v171
    v_cvt_pk_bf16_f32 v102, v172, v173
    v_cvt_pk_bf16_f32 v103, v174, v175
    v_lshlrev_b32 v168, 16, v100
    v_lshlrev_b32 v170, 16, v101
    v_lshlrev_b32 v172, 16, v102
    v_lshlrev_b32 v174, 16, v103
    v_and_b32 v169, s38, v100
    v_and_b32 v171, s38, v101
    v_and_b32 v173, s38, v102
    v_and_b32 v175, s38, v103
    v_mul_f32 v168, v168, v161
    v_mul_f32 v170, v170, v161
    v_mul_f32 v172, v172, v161
    v_mul_f32 v174, v174, v161
    v_mul_f32 v169, v169, v161
    v_mul_f32 v171, v171, v161
    v_mul_f32 v173, v173, v161
    v_mul_f32 v175, v175, v161
    v_cvt_pk_bf16_f32 v100, v168, v169
    v_cvt_pk_bf16_f32 v101, v170, v171
    v_cvt_pk_bf16_f32 v102, v172, v173
    v_cvt_pk_bf16_f32 v103, v174, v175
    v_accvgpr_write_b32 a180, v100
    v_accvgpr_write_b32 a181, v101
    v_accvgpr_write_b32 a182, v102
    v_accvgpr_write_b32 a183, v103
    v_lshlrev_b32 v168, 16, v104
    v_lshlrev_b32 v170, 16, v105
    v_lshlrev_b32 v172, 16, v106
    v_lshlrev_b32 v174, 16, v107
    v_and_b32 v169, s38, v104
    v_and_b32 v171, s38, v105
    v_and_b32 v173, s38, v106
    v_and_b32 v175, s38, v107
    v_sub_f32 v168, v168, v160
    v_sub_f32 v170, v170, v160
    v_sub_f32 v172, v172, v160
    v_sub_f32 v174, v174, v160
    v_sub_f32 v169, v169, v160
    v_sub_f32 v171, v171, v160
    v_sub_f32 v173, v173, v160
    v_sub_f32 v175, v175, v160
    v_cvt_pk_bf16_f32 v104, v168, v169
    v_cvt_pk_bf16_f32 v105, v170, v171
    v_cvt_pk_bf16_f32 v106, v172, v173
    v_cvt_pk_bf16_f32 v107, v174, v175
    v_lshlrev_b32 v168, 16, v104
    v_lshlrev_b32 v170, 16, v105
    v_lshlrev_b32 v172, 16, v106
    v_lshlrev_b32 v174, 16, v107
    v_and_b32 v169, s38, v104
    v_and_b32 v171, s38, v105
    v_and_b32 v173, s38, v106
    v_and_b32 v175, s38, v107
    v_mul_f32 v168, v168, v161
    v_mul_f32 v170, v170, v161
    v_mul_f32 v172, v172, v161
    v_mul_f32 v174, v174, v161
    v_mul_f32 v169, v169, v161
    v_mul_f32 v171, v171, v161
    v_mul_f32 v173, v173, v161
    v_mul_f32 v175, v175, v161
    v_cvt_pk_bf16_f32 v104, v168, v169
    v_cvt_pk_bf16_f32 v105, v170, v171
    v_cvt_pk_bf16_f32 v106, v172, v173
    v_cvt_pk_bf16_f32 v107, v174, v175
    v_accvgpr_write_b32 a184, v104
    v_accvgpr_write_b32 a185, v105
    v_accvgpr_write_b32 a186, v106
    v_accvgpr_write_b32 a187, v107
    v_lshlrev_b32 v168, 16, v108
    v_lshlrev_b32 v170, 16, v109
    v_lshlrev_b32 v172, 16, v110
    v_lshlrev_b32 v174, 16, v111
    v_and_b32 v169, s38, v108
    v_and_b32 v171, s38, v109
    v_and_b32 v173, s38, v110
    v_and_b32 v175, s38, v111
    v_sub_f32 v168, v168, v160
    v_sub_f32 v170, v170, v160
    v_sub_f32 v172, v172, v160
    v_sub_f32 v174, v174, v160
    v_sub_f32 v169, v169, v160
    v_sub_f32 v171, v171, v160
    v_sub_f32 v173, v173, v160
    v_sub_f32 v175, v175, v160
    v_cvt_pk_bf16_f32 v108, v168, v169
    v_cvt_pk_bf16_f32 v109, v170, v171
    v_cvt_pk_bf16_f32 v110, v172, v173
    v_cvt_pk_bf16_f32 v111, v174, v175
    v_lshlrev_b32 v168, 16, v108
    v_lshlrev_b32 v170, 16, v109
    v_lshlrev_b32 v172, 16, v110
    v_lshlrev_b32 v174, 16, v111
    v_and_b32 v169, s38, v108
    v_and_b32 v171, s38, v109
    v_and_b32 v173, s38, v110
    v_and_b32 v175, s38, v111
    v_mul_f32 v168, v168, v161
    v_mul_f32 v170, v170, v161
    v_mul_f32 v172, v172, v161
    v_mul_f32 v174, v174, v161
    v_mul_f32 v169, v169, v161
    v_mul_f32 v171, v171, v161
    v_mul_f32 v173, v173, v161
    v_mul_f32 v175, v175, v161
    v_cvt_pk_bf16_f32 v108, v168, v169
    v_cvt_pk_bf16_f32 v109, v170, v171
    v_cvt_pk_bf16_f32 v110, v172, v173
    v_cvt_pk_bf16_f32 v111, v174, v175
    v_accvgpr_write_b32 a188, v108
    v_accvgpr_write_b32 a189, v109
    v_accvgpr_write_b32 a190, v110
    v_accvgpr_write_b32 a191, v111
    v_lshlrev_b32 v168, 16, v112
    v_lshlrev_b32 v170, 16, v113
    v_lshlrev_b32 v172, 16, v114
    v_lshlrev_b32 v174, 16, v115
    v_and_b32 v169, s38, v112
    v_and_b32 v171, s38, v113
    v_and_b32 v173, s38, v114
    v_and_b32 v175, s38, v115
    v_sub_f32 v168, v168, v160
    v_sub_f32 v170, v170, v160
    v_sub_f32 v172, v172, v160
    v_sub_f32 v174, v174, v160
    v_sub_f32 v169, v169, v160
    v_sub_f32 v171, v171, v160
    v_sub_f32 v173, v173, v160
    v_sub_f32 v175, v175, v160
    v_cvt_pk_bf16_f32 v112, v168, v169
    v_cvt_pk_bf16_f32 v113, v170, v171
    v_cvt_pk_bf16_f32 v114, v172, v173
    v_cvt_pk_bf16_f32 v115, v174, v175
    v_lshlrev_b32 v168, 16, v112
    v_lshlrev_b32 v170, 16, v113
    v_lshlrev_b32 v172, 16, v114
    v_lshlrev_b32 v174, 16, v115
    v_and_b32 v169, s38, v112
    v_and_b32 v171, s38, v113
    v_and_b32 v173, s38, v114
    v_and_b32 v175, s38, v115
    v_mul_f32 v168, v168, v161
    v_mul_f32 v170, v170, v161
    v_mul_f32 v172, v172, v161
    v_mul_f32 v174, v174, v161
    v_mul_f32 v169, v169, v161
    v_mul_f32 v171, v171, v161
    v_mul_f32 v173, v173, v161
    v_mul_f32 v175, v175, v161
    v_cvt_pk_bf16_f32 v112, v168, v169
    v_cvt_pk_bf16_f32 v113, v170, v171
    v_cvt_pk_bf16_f32 v114, v172, v173
    v_cvt_pk_bf16_f32 v115, v174, v175
    v_accvgpr_write_b32 a192, v112
    v_accvgpr_write_b32 a193, v113
    v_accvgpr_write_b32 a194, v114
    v_accvgpr_write_b32 a195, v115
    v_lshlrev_b32 v168, 16, v116
    v_lshlrev_b32 v170, 16, v117
    v_lshlrev_b32 v172, 16, v118
    v_lshlrev_b32 v174, 16, v119
    v_and_b32 v169, s38, v116
    v_and_b32 v171, s38, v117
    v_and_b32 v173, s38, v118
    v_and_b32 v175, s38, v119
    v_sub_f32 v168, v168, v160
    v_sub_f32 v170, v170, v160
    v_sub_f32 v172, v172, v160
    v_sub_f32 v174, v174, v160
    v_sub_f32 v169, v169, v160
    v_sub_f32 v171, v171, v160
    v_sub_f32 v173, v173, v160
    v_sub_f32 v175, v175, v160
    v_cvt_pk_bf16_f32 v116, v168, v169
    v_cvt_pk_bf16_f32 v117, v170, v171
    v_cvt_pk_bf16_f32 v118, v172, v173
    v_cvt_pk_bf16_f32 v119, v174, v175
    v_lshlrev_b32 v168, 16, v116
    v_lshlrev_b32 v170, 16, v117
    v_lshlrev_b32 v172, 16, v118
    v_lshlrev_b32 v174, 16, v119
    v_and_b32 v169, s38, v116
    v_and_b32 v171, s38, v117
    v_and_b32 v173, s38, v118
    v_and_b32 v175, s38, v119
    v_mul_f32 v168, v168, v161
    v_mul_f32 v170, v170, v161
    v_mul_f32 v172, v172, v161
    v_mul_f32 v174, v174, v161
    v_mul_f32 v169, v169, v161
    v_mul_f32 v171, v171, v161
    v_mul_f32 v173, v173, v161
    v_mul_f32 v175, v175, v161
    v_cvt_pk_bf16_f32 v116, v168, v169
    v_cvt_pk_bf16_f32 v117, v170, v171
    v_cvt_pk_bf16_f32 v118, v172, v173
    v_cvt_pk_bf16_f32 v119, v174, v175
    v_accvgpr_write_b32 a196, v116
    v_accvgpr_write_b32 a197, v117
    v_accvgpr_write_b32 a198, v118
    v_accvgpr_write_b32 a199, v119
    v_lshlrev_b32 v168, 16, v120
    v_lshlrev_b32 v170, 16, v121
    v_lshlrev_b32 v172, 16, v122
    v_lshlrev_b32 v174, 16, v123
    v_and_b32 v169, s38, v120
    v_and_b32 v171, s38, v121
    v_and_b32 v173, s38, v122
    v_and_b32 v175, s38, v123
    v_sub_f32 v168, v168, v160
    v_sub_f32 v170, v170, v160
    v_sub_f32 v172, v172, v160
    v_sub_f32 v174, v174, v160
    v_sub_f32 v169, v169, v160
    v_sub_f32 v171, v171, v160
    v_sub_f32 v173, v173, v160
    v_sub_f32 v175, v175, v160
    v_cvt_pk_bf16_f32 v120, v168, v169
    v_cvt_pk_bf16_f32 v121, v170, v171
    v_cvt_pk_bf16_f32 v122, v172, v173
    v_cvt_pk_bf16_f32 v123, v174, v175
    v_lshlrev_b32 v168, 16, v120
    v_lshlrev_b32 v170, 16, v121
    v_lshlrev_b32 v172, 16, v122
    v_lshlrev_b32 v174, 16, v123
    v_and_b32 v169, s38, v120
    v_and_b32 v171, s38, v121
    v_and_b32 v173, s38, v122
    v_and_b32 v175, s38, v123
    v_mul_f32 v168, v168, v161
    v_mul_f32 v170, v170, v161
    v_mul_f32 v172, v172, v161
    v_mul_f32 v174, v174, v161
    v_mul_f32 v169, v169, v161
    v_mul_f32 v171, v171, v161
    v_mul_f32 v173, v173, v161
    v_mul_f32 v175, v175, v161
    v_cvt_pk_bf16_f32 v120, v168, v169
    v_cvt_pk_bf16_f32 v121, v170, v171
    v_cvt_pk_bf16_f32 v122, v172, v173
    v_cvt_pk_bf16_f32 v123, v174, v175
    v_accvgpr_write_b32 a200, v120
    v_accvgpr_write_b32 a201, v121
    v_accvgpr_write_b32 a202, v122
    v_accvgpr_write_b32 a203, v123
    v_lshlrev_b32 v168, 16, v124
    v_lshlrev_b32 v170, 16, v125
    v_lshlrev_b32 v172, 16, v126
    v_lshlrev_b32 v174, 16, v127
    v_and_b32 v169, s38, v124
    v_and_b32 v171, s38, v125
    v_and_b32 v173, s38, v126
    v_and_b32 v175, s38, v127
    v_sub_f32 v168, v168, v160
    v_sub_f32 v170, v170, v160
    v_sub_f32 v172, v172, v160
    v_sub_f32 v174, v174, v160
    v_sub_f32 v169, v169, v160
    v_sub_f32 v171, v171, v160
    v_sub_f32 v173, v173, v160
    v_sub_f32 v175, v175, v160
    v_cvt_pk_bf16_f32 v124, v168, v169
    v_cvt_pk_bf16_f32 v125, v170, v171
    v_cvt_pk_bf16_f32 v126, v172, v173
    v_cvt_pk_bf16_f32 v127, v174, v175
    v_lshlrev_b32 v168, 16, v124
    v_lshlrev_b32 v170, 16, v125
    v_lshlrev_b32 v172, 16, v126
    v_lshlrev_b32 v174, 16, v127
    v_and_b32 v169, s38, v124
    v_and_b32 v171, s38, v125
    v_and_b32 v173, s38, v126
    v_and_b32 v175, s38, v127
    v_mul_f32 v168, v168, v161
    v_mul_f32 v170, v170, v161
    v_mul_f32 v172, v172, v161
    v_mul_f32 v174, v174, v161
    v_mul_f32 v169, v169, v161
    v_mul_f32 v171, v171, v161
    v_mul_f32 v173, v173, v161
    v_mul_f32 v175, v175, v161
    v_cvt_pk_bf16_f32 v124, v168, v169
    v_cvt_pk_bf16_f32 v125, v170, v171
    v_cvt_pk_bf16_f32 v126, v172, v173
    v_cvt_pk_bf16_f32 v127, v174, v175
    v_accvgpr_write_b32 a204, v124
    v_accvgpr_write_b32 a205, v125
    v_accvgpr_write_b32 a206, v126
    v_accvgpr_write_b32 a207, v127
    v_lshlrev_b32 v168, 16, v128
    v_lshlrev_b32 v170, 16, v129
    v_lshlrev_b32 v172, 16, v130
    v_lshlrev_b32 v174, 16, v131
    v_and_b32 v169, s38, v128
    v_and_b32 v171, s38, v129
    v_and_b32 v173, s38, v130
    v_and_b32 v175, s38, v131
    v_sub_f32 v168, v168, v160
    v_sub_f32 v170, v170, v160
    v_sub_f32 v172, v172, v160
    v_sub_f32 v174, v174, v160
    v_sub_f32 v169, v169, v160
    v_sub_f32 v171, v171, v160
    v_sub_f32 v173, v173, v160
    v_sub_f32 v175, v175, v160
    v_cvt_pk_bf16_f32 v128, v168, v169
    v_cvt_pk_bf16_f32 v129, v170, v171
    v_cvt_pk_bf16_f32 v130, v172, v173
    v_cvt_pk_bf16_f32 v131, v174, v175
    v_lshlrev_b32 v168, 16, v128
    v_lshlrev_b32 v170, 16, v129
    v_lshlrev_b32 v172, 16, v130
    v_lshlrev_b32 v174, 16, v131
    v_and_b32 v169, s38, v128
    v_and_b32 v171, s38, v129
    v_and_b32 v173, s38, v130
    v_and_b32 v175, s38, v131
    v_mul_f32 v168, v168, v161
    v_mul_f32 v170, v170, v161
    v_mul_f32 v172, v172, v161
    v_mul_f32 v174, v174, v161
    v_mul_f32 v169, v169, v161
    v_mul_f32 v171, v171, v161
    v_mul_f32 v173, v173, v161
    v_mul_f32 v175, v175, v161
    v_cvt_pk_bf16_f32 v128, v168, v169
    v_cvt_pk_bf16_f32 v129, v170, v171
    v_cvt_pk_bf16_f32 v130, v172, v173
    v_cvt_pk_bf16_f32 v131, v174, v175
    v_accvgpr_write_b32 a208, v128
    v_accvgpr_write_b32 a209, v129
    v_accvgpr_write_b32 a210, v130
    v_accvgpr_write_b32 a211, v131
    v_lshlrev_b32 v168, 16, v132
    v_lshlrev_b32 v170, 16, v133
    v_lshlrev_b32 v172, 16, v134
    v_lshlrev_b32 v174, 16, v135
    v_and_b32 v169, s38, v132
    v_and_b32 v171, s38, v133
    v_and_b32 v173, s38, v134
    v_and_b32 v175, s38, v135
    v_sub_f32 v168, v168, v160
    v_sub_f32 v170, v170, v160
    v_sub_f32 v172, v172, v160
    v_sub_f32 v174, v174, v160
    v_sub_f32 v169, v169, v160
    v_sub_f32 v171, v171, v160
    v_sub_f32 v173, v173, v160
    v_sub_f32 v175, v175, v160
    v_cvt_pk_bf16_f32 v132, v168, v169
    v_cvt_pk_bf16_f32 v133, v170, v171
    v_cvt_pk_bf16_f32 v134, v172, v173
    v_cvt_pk_bf16_f32 v135, v174, v175
    v_lshlrev_b32 v168, 16, v132
    v_lshlrev_b32 v170, 16, v133
    v_lshlrev_b32 v172, 16, v134
    v_lshlrev_b32 v174, 16, v135
    v_and_b32 v169, s38, v132
    v_and_b32 v171, s38, v133
    v_and_b32 v173, s38, v134
    v_and_b32 v175, s38, v135
    v_mul_f32 v168, v168, v161
    v_mul_f32 v170, v170, v161
    v_mul_f32 v172, v172, v161
    v_mul_f32 v174, v174, v161
    v_mul_f32 v169, v169, v161
    v_mul_f32 v171, v171, v161
    v_mul_f32 v173, v173, v161
    v_mul_f32 v175, v175, v161
    v_cvt_pk_bf16_f32 v132, v168, v169
    v_cvt_pk_bf16_f32 v133, v170, v171
    v_cvt_pk_bf16_f32 v134, v172, v173
    v_cvt_pk_bf16_f32 v135, v174, v175
    v_accvgpr_write_b32 a212, v132
    v_accvgpr_write_b32 a213, v133
    v_accvgpr_write_b32 a214, v134
    v_accvgpr_write_b32 a215, v135
    v_lshlrev_b32 v168, 16, v136
    v_lshlrev_b32 v170, 16, v137
    v_lshlrev_b32 v172, 16, v138
    v_lshlrev_b32 v174, 16, v139
    v_and_b32 v169, s38, v136
    v_and_b32 v171, s38, v137
    v_and_b32 v173, s38, v138
    v_and_b32 v175, s38, v139
    v_sub_f32 v168, v168, v160
    v_sub_f32 v170, v170, v160
    v_sub_f32 v172, v172, v160
    v_sub_f32 v174, v174, v160
    v_sub_f32 v169, v169, v160
    v_sub_f32 v171, v171, v160
    v_sub_f32 v173, v173, v160
    v_sub_f32 v175, v175, v160
    v_cvt_pk_bf16_f32 v136, v168, v169
    v_cvt_pk_bf16_f32 v137, v170, v171
    v_cvt_pk_bf16_f32 v138, v172, v173
    v_cvt_pk_bf16_f32 v139, v174, v175
    v_lshlrev_b32 v168, 16, v136
    v_lshlrev_b32 v170, 16, v137
    v_lshlrev_b32 v172, 16, v138
    v_lshlrev_b32 v174, 16, v139
    v_and_b32 v169, s38, v136
    v_and_b32 v171, s38, v137
    v_and_b32 v173, s38, v138
    v_and_b32 v175, s38, v139
    v_mul_f32 v168, v168, v161
    v_mul_f32 v170, v170, v161
    v_mul_f32 v172, v172, v161
    v_mul_f32 v174, v174, v161
    v_mul_f32 v169, v169, v161
    v_mul_f32 v171, v171, v161
    v_mul_f32 v173, v173, v161
    v_mul_f32 v175, v175, v161
    v_cvt_pk_bf16_f32 v136, v168, v169
    v_cvt_pk_bf16_f32 v137, v170, v171
    v_cvt_pk_bf16_f32 v138, v172, v173
    v_cvt_pk_bf16_f32 v139, v174, v175
    v_accvgpr_write_b32 a216, v136
    v_accvgpr_write_b32 a217, v137
    v_accvgpr_write_b32 a218, v138
    v_accvgpr_write_b32 a219, v139
    v_lshlrev_b32 v168, 16, v140
    v_lshlrev_b32 v170, 16, v141
    v_lshlrev_b32 v172, 16, v142
    v_lshlrev_b32 v174, 16, v143
    v_and_b32 v169, s38, v140
    v_and_b32 v171, s38, v141
    v_and_b32 v173, s38, v142
    v_and_b32 v175, s38, v143
    v_sub_f32 v168, v168, v160
    v_sub_f32 v170, v170, v160
    v_sub_f32 v172, v172, v160
    v_sub_f32 v174, v174, v160
    v_sub_f32 v169, v169, v160
    v_sub_f32 v171, v171, v160
    v_sub_f32 v173, v173, v160
    v_sub_f32 v175, v175, v160
    v_cvt_pk_bf16_f32 v140, v168, v169
    v_cvt_pk_bf16_f32 v141, v170, v171
    v_cvt_pk_bf16_f32 v142, v172, v173
    v_cvt_pk_bf16_f32 v143, v174, v175
    v_lshlrev_b32 v168, 16, v140
    v_lshlrev_b32 v170, 16, v141
    v_lshlrev_b32 v172, 16, v142
    v_lshlrev_b32 v174, 16, v143
    v_and_b32 v169, s38, v140
    v_and_b32 v171, s38, v141
    v_and_b32 v173, s38, v142
    v_and_b32 v175, s38, v143
    v_mul_f32 v168, v168, v161
    v_mul_f32 v170, v170, v161
    v_mul_f32 v172, v172, v161
    v_mul_f32 v174, v174, v161
    v_mul_f32 v169, v169, v161
    v_mul_f32 v171, v171, v161
    v_mul_f32 v173, v173, v161
    v_mul_f32 v175, v175, v161
    v_cvt_pk_bf16_f32 v140, v168, v169
    v_cvt_pk_bf16_f32 v141, v170, v171
    v_cvt_pk_bf16_f32 v142, v172, v173
    v_cvt_pk_bf16_f32 v143, v174, v175
    v_accvgpr_write_b32 a220, v140
    v_accvgpr_write_b32 a221, v141
    v_accvgpr_write_b32 a222, v142
    v_accvgpr_write_b32 a223, v143
    v_lshlrev_b32 v168, 16, v144
    v_lshlrev_b32 v170, 16, v145
    v_lshlrev_b32 v172, 16, v146
    v_lshlrev_b32 v174, 16, v147
    v_and_b32 v169, s38, v144
    v_and_b32 v171, s38, v145
    v_and_b32 v173, s38, v146
    v_and_b32 v175, s38, v147
    v_sub_f32 v168, v168, v160
    v_sub_f32 v170, v170, v160
    v_sub_f32 v172, v172, v160
    v_sub_f32 v174, v174, v160
    v_sub_f32 v169, v169, v160
    v_sub_f32 v171, v171, v160
    v_sub_f32 v173, v173, v160
    v_sub_f32 v175, v175, v160
    v_cvt_pk_bf16_f32 v144, v168, v169
    v_cvt_pk_bf16_f32 v145, v170, v171
    v_cvt_pk_bf16_f32 v146, v172, v173
    v_cvt_pk_bf16_f32 v147, v174, v175
    v_lshlrev_b32 v168, 16, v144
    v_lshlrev_b32 v170, 16, v145
    v_lshlrev_b32 v172, 16, v146
    v_lshlrev_b32 v174, 16, v147
    v_and_b32 v169, s38, v144
    v_and_b32 v171, s38, v145
    v_and_b32 v173, s38, v146
    v_and_b32 v175, s38, v147
    v_mul_f32 v168, v168, v161
    v_mul_f32 v170, v170, v161
    v_mul_f32 v172, v172, v161
    v_mul_f32 v174, v174, v161
    v_mul_f32 v169, v169, v161
    v_mul_f32 v171, v171, v161
    v_mul_f32 v173, v173, v161
    v_mul_f32 v175, v175, v161
    v_cvt_pk_bf16_f32 v144, v168, v169
    v_cvt_pk_bf16_f32 v145, v170, v171
    v_cvt_pk_bf16_f32 v146, v172, v173
    v_cvt_pk_bf16_f32 v147, v174, v175
    v_accvgpr_write_b32 a224, v144
    v_accvgpr_write_b32 a225, v145
    v_accvgpr_write_b32 a226, v146
    v_accvgpr_write_b32 a227, v147
    v_lshlrev_b32 v168, 16, v148
    v_lshlrev_b32 v170, 16, v149
    v_lshlrev_b32 v172, 16, v150
    v_lshlrev_b32 v174, 16, v151
    v_and_b32 v169, s38, v148
    v_and_b32 v171, s38, v149
    v_and_b32 v173, s38, v150
    v_and_b32 v175, s38, v151
    v_sub_f32 v168, v168, v160
    v_sub_f32 v170, v170, v160
    v_sub_f32 v172, v172, v160
    v_sub_f32 v174, v174, v160
    v_sub_f32 v169, v169, v160
    v_sub_f32 v171, v171, v160
    v_sub_f32 v173, v173, v160
    v_sub_f32 v175, v175, v160
    v_cvt_pk_bf16_f32 v148, v168, v169
    v_cvt_pk_bf16_f32 v149, v170, v171
    v_cvt_pk_bf16_f32 v150, v172, v173
    v_cvt_pk_bf16_f32 v151, v174, v175
    v_lshlrev_b32 v168, 16, v148
    v_lshlrev_b32 v170, 16, v149
    v_lshlrev_b32 v172, 16, v150
    v_lshlrev_b32 v174, 16, v151
    v_and_b32 v169, s38, v148
    v_and_b32 v171, s38, v149
    v_and_b32 v173, s38, v150
    v_and_b32 v175, s38, v151
    v_mul_f32 v168, v168, v161
    v_mul_f32 v170, v170, v161
    v_mul_f32 v172, v172, v161
    v_mul_f32 v174, v174, v161
    v_mul_f32 v169, v169, v161
    v_mul_f32 v171, v171, v161
    v_mul_f32 v173, v173, v161
    v_mul_f32 v175, v175, v161
    v_cvt_pk_bf16_f32 v148, v168, v169
    v_cvt_pk_bf16_f32 v149, v170, v171
    v_cvt_pk_bf16_f32 v150, v172, v173
    v_cvt_pk_bf16_f32 v151, v174, v175
    v_accvgpr_write_b32 a228, v148
    v_accvgpr_write_b32 a229, v149
    v_accvgpr_write_b32 a230, v150
    v_accvgpr_write_b32 a231, v151
    v_lshlrev_b32 v168, 16, v152
    v_lshlrev_b32 v170, 16, v153
    v_lshlrev_b32 v172, 16, v154
    v_lshlrev_b32 v174, 16, v155
    v_and_b32 v169, s38, v152
    v_and_b32 v171, s38, v153
    v_and_b32 v173, s38, v154
    v_and_b32 v175, s38, v155
    v_sub_f32 v168, v168, v160
    v_sub_f32 v170, v170, v160
    v_sub_f32 v172, v172, v160
    v_sub_f32 v174, v174, v160
    v_sub_f32 v169, v169, v160
    v_sub_f32 v171, v171, v160
    v_sub_f32 v173, v173, v160
    v_sub_f32 v175, v175, v160
    v_cvt_pk_bf16_f32 v152, v168, v169
    v_cvt_pk_bf16_f32 v153, v170, v171
    v_cvt_pk_bf16_f32 v154, v172, v173
    v_cvt_pk_bf16_f32 v155, v174, v175
    v_lshlrev_b32 v168, 16, v152
    v_lshlrev_b32 v170, 16, v153
    v_lshlrev_b32 v172, 16, v154
    v_lshlrev_b32 v174, 16, v155
    v_and_b32 v169, s38, v152
    v_and_b32 v171, s38, v153
    v_and_b32 v173, s38, v154
    v_and_b32 v175, s38, v155
    v_mul_f32 v168, v168, v161
    v_mul_f32 v170, v170, v161
    v_mul_f32 v172, v172, v161
    v_mul_f32 v174, v174, v161
    v_mul_f32 v169, v169, v161
    v_mul_f32 v171, v171, v161
    v_mul_f32 v173, v173, v161
    v_mul_f32 v175, v175, v161
    v_cvt_pk_bf16_f32 v152, v168, v169
    v_cvt_pk_bf16_f32 v153, v170, v171
    v_cvt_pk_bf16_f32 v154, v172, v173
    v_cvt_pk_bf16_f32 v155, v174, v175
    v_accvgpr_write_b32 a232, v152
    v_accvgpr_write_b32 a233, v153
    v_accvgpr_write_b32 a234, v154
    v_accvgpr_write_b32 a235, v155
    v_lshlrev_b32 v168, 16, v156
    v_lshlrev_b32 v170, 16, v157
    v_lshlrev_b32 v172, 16, v158
    v_lshlrev_b32 v174, 16, v159
    v_and_b32 v169, s38, v156
    v_and_b32 v171, s38, v157
    v_and_b32 v173, s38, v158
    v_and_b32 v175, s38, v159
    v_sub_f32 v168, v168, v160
    v_sub_f32 v170, v170, v160
    v_sub_f32 v172, v172, v160
    v_sub_f32 v174, v174, v160
    v_sub_f32 v169, v169, v160
    v_sub_f32 v171, v171, v160
    v_sub_f32 v173, v173, v160
    v_sub_f32 v175, v175, v160
    v_cvt_pk_bf16_f32 v156, v168, v169
    v_cvt_pk_bf16_f32 v157, v170, v171
    v_cvt_pk_bf16_f32 v158, v172, v173
    v_cvt_pk_bf16_f32 v159, v174, v175
    v_lshlrev_b32 v168, 16, v156
    v_lshlrev_b32 v170, 16, v157
    v_lshlrev_b32 v172, 16, v158
    v_lshlrev_b32 v174, 16, v159
    v_and_b32 v169, s38, v156
    v_and_b32 v171, s38, v157
    v_and_b32 v173, s38, v158
    v_and_b32 v175, s38, v159
    v_mul_f32 v168, v168, v161
    v_mul_f32 v170, v170, v161
    v_mul_f32 v172, v172, v161
    v_mul_f32 v174, v174, v161
    v_mul_f32 v169, v169, v161
    v_mul_f32 v171, v171, v161
    v_mul_f32 v173, v173, v161
    v_mul_f32 v175, v175, v161
    v_cvt_pk_bf16_f32 v156, v168, v169
    v_cvt_pk_bf16_f32 v157, v170, v171
    v_cvt_pk_bf16_f32 v158, v172, v173
    v_cvt_pk_bf16_f32 v159, v174, v175
    v_accvgpr_write_b32 a236, v156
    v_accvgpr_write_b32 a237, v157
    v_accvgpr_write_b32 a238, v158
    v_accvgpr_write_b32 a239, v159
    s_waitcnt vmcnt(12)
    s_barrier
    ds_read_b64_tr_b16 v[104:105], v236 offset:49152
    ds_read_b64_tr_b16 v[106:107], v236 offset:50176
    ds_read_b64_tr_b16 v[108:109], v237 offset:49152
    ds_read_b64_tr_b16 v[110:111], v237 offset:50176
    ds_read_b64_tr_b16 v[112:113], v238 offset:49152
    ds_read_b64_tr_b16 v[114:115], v238 offset:50176
    ds_read_b64_tr_b16 v[116:117], v239 offset:49152
    ds_read_b64_tr_b16 v[118:119], v239 offset:50176
    ds_read_b64_tr_b16 v[120:121], v236 offset:53248
    ds_read_b64_tr_b16 v[122:123], v236 offset:54272
    ds_read_b64_tr_b16 v[124:125], v237 offset:53248
    ds_read_b64_tr_b16 v[126:127], v237 offset:54272
    ds_read_b64_tr_b16 v[128:129], v238 offset:53248
    ds_read_b64_tr_b16 v[130:131], v238 offset:54272
    ds_read_b64_tr_b16 v[132:133], v239 offset:53248
    ds_read_b64_tr_b16 v[134:135], v239 offset:54272
    ds_read_b64_tr_b16 v[136:137], v236 offset:57344
    ds_read_b64_tr_b16 v[138:139], v236 offset:58368
    ds_read_b64_tr_b16 v[140:141], v237 offset:57344
    ds_read_b64_tr_b16 v[142:143], v237 offset:58368
    ds_read_b64_tr_b16 v[144:145], v238 offset:57344
    ds_read_b64_tr_b16 v[146:147], v238 offset:58368
    ds_read_b64_tr_b16 v[148:149], v239 offset:57344
    ds_read_b64_tr_b16 v[150:151], v239 offset:58368
    ds_read_b64_tr_b16 v[152:153], v236 offset:61440
    ds_read_b64_tr_b16 v[154:155], v236 offset:62464
    ds_read_b64_tr_b16 v[156:157], v237 offset:61440
    ds_read_b64_tr_b16 v[158:159], v237 offset:62464
    ds_read_b64_tr_b16 v[160:161], v238 offset:61440
    ds_read_b64_tr_b16 v[162:163], v238 offset:62464
    ds_read_b64_tr_b16 v[164:165], v239 offset:61440
    ds_read_b64_tr_b16 v[166:167], v239 offset:62464
    s_waitcnt vmcnt(8) lgkmcnt(0)
    s_barrier
    s_mov_b32 s36, 917504
    v_mfma_f32_32x32x16_bf16 v[48:63], v[104:107], a[128:131], 0
    ds_read_b64_tr_b16 v[168:169], v236 offset:0
    ds_read_b64_tr_b16 v[170:171], v236 offset:1024
    ds_read_b64_tr_b16 v[172:173], v237 offset:0
    s_lshl_b32 s56, s24, 3
    v_add_u32 v40, 0, v2
    v_add_u32 v40, s56, v40
    v_and_b32 v41, 15, v40
    v_mfma_f32_32x32x16_bf16 v[64:79], v[108:111], a[128:131], 0
    ds_read_b64_tr_b16 v[174:175], v237 offset:1024
    ds_read_b64_tr_b16 v[176:177], v238 offset:0
    ds_read_b64_tr_b16 v[178:179], v238 offset:1024
    v_xor_b32 v41, v41, v3
    v_lshlrev_b32 v41, 4, v41
    v_lshl_add_u32 v4, v40, 9, v41
    v_and_b32 v41, 3, v40
    v_mfma_f32_32x32x16_bf16 v[80:95], v[112:115], a[128:131], 0
    ds_read_b64_tr_b16 v[180:181], v239 offset:0
    ds_read_b64_tr_b16 v[182:183], v239 offset:1024
    ds_read_b64_tr_b16 v[184:185], v236 offset:4096
    s_add_u32 m0, s27, 114688
    s_nop 0
    buffer_load_dwordx4 v232, s[48:51], s36 offen lds
    v_lshlrev_b32 v41, 2, v41
    v_xor_b32 v41, v41, v3
    v_lshlrev_b32 v41, 4, v41
    v_lshl_add_u32 v8, v40, 9, v41
    v_mfma_f32_32x32x16_bf16 v[240:255], v[116:119], a[128:131], 0
    ds_read_b64_tr_b16 v[186:187], v236 offset:5120
    ds_read_b64_tr_b16 v[188:189], v237 offset:4096
    ds_read_b64_tr_b16 v[190:191], v237 offset:5120
    v_lshl_add_u32 v12, v40, 13, v41
    v_add_u32 v40, 2, v2
    v_add_u32 v40, s56, v40
    v_and_b32 v41, 15, v40
    v_mfma_f32_32x32x16_bf16 v[48:63], v[120:123], a[132:135], v[48:63]
    ds_read_b64_tr_b16 v[192:193], v238 offset:4096
    ds_read_b64_tr_b16 v[194:195], v238 offset:5120
    ds_read_b64_tr_b16 v[196:197], v239 offset:4096
    s_add_u32 m0, s27, 115712
    s_nop 0
    buffer_load_dwordx4 v233, s[48:51], s36 offen lds
    v_xor_b32 v41, v41, v3
    v_lshlrev_b32 v41, 4, v41
    v_lshl_add_u32 v5, v40, 9, v41
    v_and_b32 v41, 3, v40
    v_mfma_f32_32x32x16_bf16 v[64:79], v[124:127], a[132:135], v[64:79]
    ds_read_b64_tr_b16 v[198:199], v239 offset:5120
    ds_read_b64_tr_b16 v[200:201], v236 offset:8192
    ds_read_b64_tr_b16 v[202:203], v236 offset:9216
    v_lshlrev_b32 v41, 2, v41
    v_xor_b32 v41, v41, v3
    v_lshlrev_b32 v41, 4, v41
    v_lshl_add_u32 v9, v40, 9, v41
    v_mfma_f32_32x32x16_bf16 v[80:95], v[128:131], a[132:135], v[80:95]
    ds_read_b64_tr_b16 v[204:205], v237 offset:8192
    ds_read_b64_tr_b16 v[206:207], v237 offset:9216
    ds_read_b64_tr_b16 v[208:209], v238 offset:8192
    s_add_u32 m0, s27, 116736
    s_nop 0
    buffer_load_dwordx4 v234, s[48:51], s36 offen lds
    v_lshl_add_u32 v13, v40, 13, v41
    v_add_u32 v40, 4, v2
    v_add_u32 v40, s56, v40
    v_and_b32 v41, 15, v40
    v_mfma_f32_32x32x16_bf16 v[240:255], v[132:135], a[132:135], v[240:255]
    ds_read_b64_tr_b16 v[210:211], v238 offset:9216
    ds_read_b64_tr_b16 v[212:213], v239 offset:8192
    ds_read_b64_tr_b16 v[214:215], v239 offset:9216
    v_xor_b32 v41, v41, v3
    v_lshlrev_b32 v41, 4, v41
    v_lshl_add_u32 v6, v40, 9, v41
    v_and_b32 v41, 3, v40
    v_mfma_f32_32x32x16_bf16 v[48:63], v[136:139], a[136:139], v[48:63]
    ds_read_b64_tr_b16 v[216:217], v236 offset:12288
    ds_read_b64_tr_b16 v[218:219], v236 offset:13312
    ds_read_b64_tr_b16 v[220:221], v237 offset:12288
    s_add_u32 m0, s27, 117760
    s_nop 0
    buffer_load_dwordx4 v235, s[48:51], s36 offen lds
    v_lshlrev_b32 v41, 2, v41
    v_xor_b32 v41, v41, v3
    v_lshlrev_b32 v41, 4, v41
    v_lshl_add_u32 v10, v40, 9, v41
    v_mfma_f32_32x32x16_bf16 v[64:79], v[140:143], a[136:139], v[64:79]
    ds_read_b64_tr_b16 v[222:223], v237 offset:13312
    ds_read_b64_tr_b16 v[224:225], v238 offset:12288
    ds_read_b64_tr_b16 v[226:227], v238 offset:13312
    v_lshl_add_u32 v14, v40, 13, v41
    v_add_u32 v40, 6, v2
    v_add_u32 v40, s56, v40
    v_and_b32 v41, 15, v40
    v_mfma_f32_32x32x16_bf16 v[80:95], v[144:147], a[136:139], v[80:95]
    ds_read_b64_tr_b16 v[228:229], v239 offset:12288
    ds_read_b64_tr_b16 v[230:231], v239 offset:13312
    v_xor_b32 v41, v41, v3
    v_lshlrev_b32 v41, 4, v41
    v_lshl_add_u32 v7, v40, 9, v41
    v_and_b32 v41, 3, v40
    v_mfma_f32_32x32x16_bf16 v[240:255], v[148:151], a[136:139], v[240:255]
    v_lshlrev_b32 v41, 2, v41
    v_xor_b32 v41, v41, v3
    v_lshlrev_b32 v41, 4, v41
    v_lshl_add_u32 v11, v40, 9, v41
    v_mfma_f32_32x32x16_bf16 v[48:63], v[152:155], a[140:143], v[48:63]
    v_lshl_add_u32 v15, v40, 13, v41
    v_and_b32 v40, 1, v44
    v_lshl_add_u32 v40, v43, 1, v40
    v_add_u32 v40, 0, v40
    v_mfma_f32_32x32x16_bf16 v[64:79], v[156:159], a[140:143], v[64:79]
    v_lshlrev_b32 v41, 2, v42
    v_xor_b32 v40, v40, v41
    v_lshlrev_b32 v40, 4, v40
    v_lshrrev_b32 v41, 1, v44
    v_mfma_f32_32x32x16_bf16 v[80:95], v[160:163], a[140:143], v[80:95]
    v_lshl_add_u32 v40, v41, 3, v40
    v_lshl_add_u32 v41, v2, 3, v42
    v_lshl_add_u32 v45, v41, 9, v40
    v_add_u32 v28, 65536, v45
    v_mfma_f32_32x32x16_bf16 v[240:255], v[164:167], a[140:143], v[240:255]
    v_lshl_add_u32 v41, v2, 2, v42
    v_lshl_add_u32 v45, v41, 9, v40
    v_add_u32 v24, 65536, v45
    v_and_b32 v40, 1, v44
    s_waitcnt vmcnt(8) lgkmcnt(0)
    s_barrier
    s_mov_b32 s36, 1146880
    v_mfma_f32_32x32x16_bf16 v[48:63], v[168:171], a[144:147], v[48:63]
    ds_read_b64_tr_b16 v[104:105], v236 offset:16384
    ds_read_b64_tr_b16 v[106:107], v236 offset:17408
    ds_read_b64_tr_b16 v[108:109], v237 offset:16384
    v_lshl_add_u32 v40, v43, 1, v40
    v_add_u32 v40, 4, v40
    v_lshlrev_b32 v41, 2, v42
    v_xor_b32 v40, v40, v41
    v_mfma_f32_32x32x16_bf16 v[64:79], v[172:175], a[144:147], v[64:79]
    ds_read_b64_tr_b16 v[110:111], v237 offset:17408
    ds_read_b64_tr_b16 v[112:113], v238 offset:16384
    ds_read_b64_tr_b16 v[114:115], v238 offset:17408
    v_lshlrev_b32 v40, 4, v40
    v_lshrrev_b32 v41, 1, v44
    v_lshl_add_u32 v40, v41, 3, v40
    v_lshl_add_u32 v41, v2, 3, v42
    v_mfma_f32_32x32x16_bf16 v[80:95], v[176:179], a[144:147], v[80:95]
    ds_read_b64_tr_b16 v[116:117], v239 offset:16384
    ds_read_b64_tr_b16 v[118:119], v239 offset:17408
    ds_read_b64_tr_b16 v[120:121], v236 offset:20480
    s_add_u32 m0, s27, 65536
    s_nop 0
    buffer_load_dwordx4 v232, s[48:51], s36 offen lds
    v_lshl_add_u32 v45, v41, 9, v40
    v_add_u32 v29, 65536, v45
    v_lshl_add_u32 v41, v2, 2, v42
    v_lshl_add_u32 v45, v41, 9, v40
    v_mfma_f32_32x32x16_bf16 v[240:255], v[180:183], a[144:147], v[240:255]
    ds_read_b64_tr_b16 v[122:123], v236 offset:21504
    ds_read_b64_tr_b16 v[124:125], v237 offset:20480
    ds_read_b64_tr_b16 v[126:127], v237 offset:21504
    v_add_u32 v25, 65536, v45
    v_and_b32 v40, 1, v44
    v_lshl_add_u32 v40, v43, 1, v40
    v_add_u32 v40, 8, v40
    v_mfma_f32_32x32x16_bf16 v[48:63], v[184:187], a[148:151], v[48:63]
    ds_read_b64_tr_b16 v[128:129], v238 offset:20480
    ds_read_b64_tr_b16 v[130:131], v238 offset:21504
    ds_read_b64_tr_b16 v[132:133], v239 offset:20480
    s_add_u32 m0, s27, 66560
    s_nop 0
    buffer_load_dwordx4 v233, s[48:51], s36 offen lds
    v_lshlrev_b32 v41, 2, v42
    v_xor_b32 v40, v40, v41
    v_lshlrev_b32 v40, 4, v40
    v_lshrrev_b32 v41, 1, v44
    v_mfma_f32_32x32x16_bf16 v[64:79], v[188:191], a[148:151], v[64:79]
    ds_read_b64_tr_b16 v[134:135], v239 offset:21504
    ds_read_b64_tr_b16 v[136:137], v236 offset:24576
    ds_read_b64_tr_b16 v[138:139], v236 offset:25600
    v_lshl_add_u32 v40, v41, 3, v40
    v_lshl_add_u32 v41, v2, 3, v42
    v_lshl_add_u32 v45, v41, 9, v40
    v_add_u32 v30, 65536, v45
    v_mfma_f32_32x32x16_bf16 v[80:95], v[192:195], a[148:151], v[80:95]
    ds_read_b64_tr_b16 v[140:141], v237 offset:24576
    ds_read_b64_tr_b16 v[142:143], v237 offset:25600
    ds_read_b64_tr_b16 v[144:145], v238 offset:24576
    s_add_u32 m0, s27, 67584
    s_nop 0
    buffer_load_dwordx4 v234, s[48:51], s36 offen lds
    v_lshl_add_u32 v41, v2, 2, v42
    v_lshl_add_u32 v45, v41, 9, v40
    v_add_u32 v26, 65536, v45
    v_and_b32 v40, 1, v44
    v_mfma_f32_32x32x16_bf16 v[240:255], v[196:199], a[148:151], v[240:255]
    ds_read_b64_tr_b16 v[146:147], v238 offset:25600
    ds_read_b64_tr_b16 v[148:149], v239 offset:24576
    ds_read_b64_tr_b16 v[150:151], v239 offset:25600
    v_lshl_add_u32 v40, v43, 1, v40
    v_add_u32 v40, 12, v40
    v_lshlrev_b32 v41, 2, v42
    v_xor_b32 v40, v40, v41
    v_mfma_f32_32x32x16_bf16 v[48:63], v[200:203], a[152:155], v[48:63]
    ds_read_b64_tr_b16 v[152:153], v236 offset:28672
    ds_read_b64_tr_b16 v[154:155], v236 offset:29696
    ds_read_b64_tr_b16 v[156:157], v237 offset:28672
    s_add_u32 m0, s27, 68608
    s_nop 0
    buffer_load_dwordx4 v235, s[48:51], s36 offen lds
    v_lshlrev_b32 v40, 4, v40
    v_lshrrev_b32 v41, 1, v44
    v_lshl_add_u32 v40, v41, 3, v40
    v_lshl_add_u32 v41, v2, 3, v42
    v_mfma_f32_32x32x16_bf16 v[64:79], v[204:207], a[152:155], v[64:79]
    ds_read_b64_tr_b16 v[158:159], v237 offset:29696
    ds_read_b64_tr_b16 v[160:161], v238 offset:28672
    ds_read_b64_tr_b16 v[162:163], v238 offset:29696
    v_lshl_add_u32 v45, v41, 9, v40
    v_add_u32 v31, 65536, v45
    v_lshl_add_u32 v41, v2, 2, v42
    v_lshl_add_u32 v45, v41, 9, v40
    v_mfma_f32_32x32x16_bf16 v[80:95], v[208:211], a[152:155], v[80:95]
    ds_read_b64_tr_b16 v[164:165], v239 offset:28672
    ds_read_b64_tr_b16 v[166:167], v239 offset:29696
    v_add_u32 v27, 65536, v45
    v_add_u32 v40, 0, v2
    v_and_b32 v41, 15, v3
    v_xor_b32 v40, v40, v41
    v_mfma_f32_32x32x16_bf16 v[240:255], v[212:215], a[152:155], v[240:255]
    v_lshlrev_b32 v40, 4, v40
    v_lshl_add_u32 v16, v3, 9, v40
    v_add_u32 v40, 2, v2
    v_and_b32 v41, 15, v3
    v_mfma_f32_32x32x16_bf16 v[48:63], v[216:219], a[156:159], v[48:63]
    v_xor_b32 v40, v40, v41
    v_lshlrev_b32 v40, 4, v40
    v_lshl_add_u32 v17, v3, 9, v40
    v_add_u32 v40, 4, v2
    v_mfma_f32_32x32x16_bf16 v[64:79], v[220:223], a[156:159], v[64:79]
    v_and_b32 v41, 15, v3
    v_xor_b32 v40, v40, v41
    v_lshlrev_b32 v40, 4, v40
    v_lshl_add_u32 v18, v3, 9, v40
    v_mfma_f32_32x32x16_bf16 v[80:95], v[224:227], a[156:159], v[80:95]
    v_add_u32 v40, 6, v2
    v_and_b32 v41, 15, v3
    v_xor_b32 v40, v40, v41
    v_lshlrev_b32 v40, 4, v40
    v_mfma_f32_32x32x16_bf16 v[240:255], v[228:231], a[156:159], v[240:255]
    v_lshl_add_u32 v19, v3, 9, v40
    v_add_u32 v40, 8, v2
    v_and_b32 v41, 15, v3
    v_xor_b32 v40, v40, v41
    s_waitcnt vmcnt(8) lgkmcnt(0)
    s_barrier
    s_mov_b32 s36, 1376256
    v_mfma_f32_32x32x16_bf16 v[48:63], v[104:107], a[160:163], v[48:63]
    ds_read_b64_tr_b16 v[168:169], v236 offset:32768
    ds_read_b64_tr_b16 v[170:171], v236 offset:33792
    ds_read_b64_tr_b16 v[172:173], v237 offset:32768
    v_lshlrev_b32 v40, 4, v40
    v_lshl_add_u32 v20, v3, 9, v40
    v_add_u32 v40, 10, v2
    v_and_b32 v41, 15, v3
    v_mfma_f32_32x32x16_bf16 v[64:79], v[108:111], a[160:163], v[64:79]
    ds_read_b64_tr_b16 v[174:175], v237 offset:33792
    ds_read_b64_tr_b16 v[176:177], v238 offset:32768
    ds_read_b64_tr_b16 v[178:179], v238 offset:33792
    v_xor_b32 v40, v40, v41
    v_lshlrev_b32 v40, 4, v40
    v_lshl_add_u32 v21, v3, 9, v40
    v_add_u32 v40, 12, v2
    v_mfma_f32_32x32x16_bf16 v[80:95], v[112:115], a[160:163], v[80:95]
    ds_read_b64_tr_b16 v[180:181], v239 offset:32768
    ds_read_b64_tr_b16 v[182:183], v239 offset:33792
    ds_read_b64_tr_b16 v[184:185], v236 offset:36864
    s_add_u32 m0, s27, 81920
    s_nop 0
    buffer_load_dwordx4 v232, s[48:51], s36 offen lds
    v_and_b32 v41, 15, v3
    v_xor_b32 v40, v40, v41
    v_lshlrev_b32 v40, 4, v40
    v_lshl_add_u32 v22, v3, 9, v40
    v_mfma_f32_32x32x16_bf16 v[240:255], v[116:119], a[160:163], v[240:255]
    ds_read_b64_tr_b16 v[186:187], v236 offset:37888
    ds_read_b64_tr_b16 v[188:189], v237 offset:36864
    ds_read_b64_tr_b16 v[190:191], v237 offset:37888
    v_add_u32 v40, 14, v2
    v_and_b32 v41, 15, v3
    v_xor_b32 v40, v40, v41
    v_lshlrev_b32 v40, 4, v40
    v_mfma_f32_32x32x16_bf16 v[48:63], v[120:123], a[164:167], v[48:63]
    ds_read_b64_tr_b16 v[192:193], v238 offset:36864
    ds_read_b64_tr_b16 v[194:195], v238 offset:37888
    ds_read_b64_tr_b16 v[196:197], v239 offset:36864
    s_add_u32 m0, s27, 82944
    s_nop 0
    buffer_load_dwordx4 v233, s[48:51], s36 offen lds
    v_lshl_add_u32 v23, v3, 9, v40
    v_mfma_f32_32x32x16_bf16 v[64:79], v[124:127], a[164:167], v[64:79]
    ds_read_b64_tr_b16 v[198:199], v239 offset:37888
    ds_read_b64_tr_b16 v[200:201], v236 offset:40960
    ds_read_b64_tr_b16 v[202:203], v236 offset:41984
    v_mfma_f32_32x32x16_bf16 v[80:95], v[128:131], a[164:167], v[80:95]
    ds_read_b64_tr_b16 v[204:205], v237 offset:40960
    ds_read_b64_tr_b16 v[206:207], v237 offset:41984
    ds_read_b64_tr_b16 v[208:209], v238 offset:40960
    s_add_u32 m0, s27, 83968
    s_nop 0
    buffer_load_dwordx4 v234, s[48:51], s36 offen lds
    v_mfma_f32_32x32x16_bf16 v[240:255], v[132:135], a[164:167], v[240:255]
    ds_read_b64_tr_b16 v[210:211], v238 offset:41984
    ds_read_b64_tr_b16 v[212:213], v239 offset:40960
    ds_read_b64_tr_b16 v[214:215], v239 offset:41984
    v_mfma_f32_32x32x16_bf16 v[48:63], v[136:139], a[168:171], v[48:63]
    ds_read_b64_tr_b16 v[216:217], v236 offset:45056
    ds_read_b64_tr_b16 v[218:219], v236 offset:46080
    ds_read_b64_tr_b16 v[220:221], v237 offset:45056
    s_add_u32 m0, s27, 84992
    s_nop 0
    buffer_load_dwordx4 v235, s[48:51], s36 offen lds
    v_mfma_f32_32x32x16_bf16 v[64:79], v[140:143], a[168:171], v[64:79]
    ds_read_b64_tr_b16 v[222:223], v237 offset:46080
    ds_read_b64_tr_b16 v[224:225], v238 offset:45056
    ds_read_b64_tr_b16 v[226:227], v238 offset:46080
    v_mfma_f32_32x32x16_bf16 v[80:95], v[144:147], a[168:171], v[80:95]
    ds_read_b64_tr_b16 v[228:229], v239 offset:45056
    ds_read_b64_tr_b16 v[230:231], v239 offset:46080
    v_mfma_f32_32x32x16_bf16 v[240:255], v[148:151], a[168:171], v[240:255]
    v_mfma_f32_32x32x16_bf16 v[48:63], v[152:155], a[172:175], v[48:63]
    v_mfma_f32_32x32x16_bf16 v[64:79], v[156:159], a[172:175], v[64:79]
    v_mfma_f32_32x32x16_bf16 v[80:95], v[160:163], a[172:175], v[80:95]
    v_mfma_f32_32x32x16_bf16 v[240:255], v[164:167], a[172:175], v[240:255]
    s_waitcnt vmcnt(8) lgkmcnt(0)
    s_barrier
    s_mov_b32 s36, 0
    v_mfma_f32_32x32x16_bf16 v[48:63], v[168:171], a[176:179], v[48:63]
    ds_read_b64_tr_b16 v[104:105], v236 offset:49152
    ds_read_b64_tr_b16 v[106:107], v236 offset:50176
    ds_read_b64_tr_b16 v[108:109], v237 offset:49152
    v_mfma_f32_32x32x16_bf16 v[64:79], v[172:175], a[176:179], v[64:79]
    ds_read_b64_tr_b16 v[110:111], v237 offset:50176
    ds_read_b64_tr_b16 v[112:113], v238 offset:49152
    ds_read_b64_tr_b16 v[114:115], v238 offset:50176
    v_mfma_f32_32x32x16_bf16 v[80:95], v[176:179], a[176:179], v[80:95]
    ds_read_b64_tr_b16 v[116:117], v239 offset:49152
    ds_read_b64_tr_b16 v[118:119], v239 offset:50176
    ds_read_b64_tr_b16 v[120:121], v236 offset:53248
    s_add_u32 m0, s27, 98304
    s_nop 0
    buffer_load_dwordx4 v12, s[12:15], s36 offen lds
    v_mfma_f32_32x32x16_bf16 v[240:255], v[180:183], a[176:179], v[240:255]
    ds_read_b64_tr_b16 v[122:123], v236 offset:54272
    ds_read_b64_tr_b16 v[124:125], v237 offset:53248
    ds_read_b64_tr_b16 v[126:127], v237 offset:54272
    v_mfma_f32_32x32x16_bf16 v[48:63], v[184:187], a[180:183], v[48:63]
    ds_read_b64_tr_b16 v[128:129], v238 offset:53248
    ds_read_b64_tr_b16 v[130:131], v238 offset:54272
    ds_read_b64_tr_b16 v[132:133], v239 offset:53248
    s_add_u32 m0, s27, 99328
    s_nop 0
    buffer_load_dwordx4 v13, s[12:15], s36 offen lds
    v_mfma_f32_32x32x16_bf16 v[64:79], v[188:191], a[180:183], v[64:79]
    ds_read_b64_tr_b16 v[134:135], v239 offset:54272
    ds_read_b64_tr_b16 v[136:137], v236 offset:57344
    ds_read_b64_tr_b16 v[138:139], v236 offset:58368
    v_mfma_f32_32x32x16_bf16 v[80:95], v[192:195], a[180:183], v[80:95]
    ds_read_b64_tr_b16 v[140:141], v237 offset:57344
    ds_read_b64_tr_b16 v[142:143], v237 offset:58368
    ds_read_b64_tr_b16 v[144:145], v238 offset:57344
    s_add_u32 m0, s27, 100352
    s_nop 0
    buffer_load_dwordx4 v14, s[12:15], s36 offen lds
    v_mfma_f32_32x32x16_bf16 v[240:255], v[196:199], a[180:183], v[240:255]
    ds_read_b64_tr_b16 v[146:147], v238 offset:58368
    ds_read_b64_tr_b16 v[148:149], v239 offset:57344
    ds_read_b64_tr_b16 v[150:151], v239 offset:58368
    v_mfma_f32_32x32x16_bf16 v[48:63], v[200:203], a[184:187], v[48:63]
    ds_read_b64_tr_b16 v[152:153], v236 offset:61440
    ds_read_b64_tr_b16 v[154:155], v236 offset:62464
    ds_read_b64_tr_b16 v[156:157], v237 offset:61440
    s_add_u32 m0, s27, 101376
    s_nop 0
    buffer_load_dwordx4 v15, s[12:15], s36 offen lds
    v_mfma_f32_32x32x16_bf16 v[64:79], v[204:207], a[184:187], v[64:79]
    ds_read_b64_tr_b16 v[158:159], v237 offset:62464
    ds_read_b64_tr_b16 v[160:161], v238 offset:61440
    ds_read_b64_tr_b16 v[162:163], v238 offset:62464
    v_mfma_f32_32x32x16_bf16 v[80:95], v[208:211], a[184:187], v[80:95]
    ds_read_b64_tr_b16 v[164:165], v239 offset:61440
    ds_read_b64_tr_b16 v[166:167], v239 offset:62464
    v_mfma_f32_32x32x16_bf16 v[240:255], v[212:215], a[184:187], v[240:255]
    v_mfma_f32_32x32x16_bf16 v[48:63], v[216:219], a[188:191], v[48:63]
    v_mfma_f32_32x32x16_bf16 v[64:79], v[220:223], a[188:191], v[64:79]
    v_mfma_f32_32x32x16_bf16 v[80:95], v[224:227], a[188:191], v[80:95]
    v_mfma_f32_32x32x16_bf16 v[240:255], v[228:231], a[188:191], v[240:255]
    s_waitcnt vmcnt(8) lgkmcnt(0)
    s_barrier
    s_mov_b32 s36, 262144
    v_mfma_f32_32x32x16_bf16 v[48:63], v[104:107], a[192:195], v[48:63]
    ds_read_b64_tr_b16 v[168:169], v236 offset:0
    ds_read_b64_tr_b16 v[170:171], v236 offset:1024
    ds_read_b64_tr_b16 v[172:173], v237 offset:0
    v_mfma_f32_32x32x16_bf16 v[64:79], v[108:111], a[192:195], v[64:79]
    ds_read_b64_tr_b16 v[174:175], v237 offset:1024
    ds_read_b64_tr_b16 v[176:177], v238 offset:0
    ds_read_b64_tr_b16 v[178:179], v238 offset:1024
    v_mfma_f32_32x32x16_bf16 v[80:95], v[112:115], a[192:195], v[80:95]
    ds_read_b64_tr_b16 v[180:181], v239 offset:0
    ds_read_b64_tr_b16 v[182:183], v239 offset:1024
    ds_read_b64_tr_b16 v[184:185], v236 offset:4096
    s_add_u32 m0, s27, 114688
    s_nop 0
    buffer_load_dwordx4 v12, s[12:15], s36 offen lds
    v_mfma_f32_32x32x16_bf16 v[240:255], v[116:119], a[192:195], v[240:255]
    ds_read_b64_tr_b16 v[186:187], v236 offset:5120
    ds_read_b64_tr_b16 v[188:189], v237 offset:4096
    ds_read_b64_tr_b16 v[190:191], v237 offset:5120
    v_mfma_f32_32x32x16_bf16 v[48:63], v[120:123], a[196:199], v[48:63]
    ds_read_b64_tr_b16 v[192:193], v238 offset:4096
    ds_read_b64_tr_b16 v[194:195], v238 offset:5120
    ds_read_b64_tr_b16 v[196:197], v239 offset:4096
    s_add_u32 m0, s27, 115712
    s_nop 0
    buffer_load_dwordx4 v13, s[12:15], s36 offen lds
    v_mfma_f32_32x32x16_bf16 v[64:79], v[124:127], a[196:199], v[64:79]
    ds_read_b64_tr_b16 v[198:199], v239 offset:5120
    ds_read_b64_tr_b16 v[200:201], v236 offset:8192
    ds_read_b64_tr_b16 v[202:203], v236 offset:9216
    v_mfma_f32_32x32x16_bf16 v[80:95], v[128:131], a[196:199], v[80:95]
    ds_read_b64_tr_b16 v[204:205], v237 offset:8192
    ds_read_b64_tr_b16 v[206:207], v237 offset:9216
    ds_read_b64_tr_b16 v[208:209], v238 offset:8192
    s_add_u32 m0, s27, 116736
    s_nop 0
    buffer_load_dwordx4 v14, s[12:15], s36 offen lds
    v_mfma_f32_32x32x16_bf16 v[240:255], v[132:135], a[196:199], v[240:255]
    ds_read_b64_tr_b16 v[210:211], v238 offset:9216
    ds_read_b64_tr_b16 v[212:213], v239 offset:8192
    ds_read_b64_tr_b16 v[214:215], v239 offset:9216
    v_mfma_f32_32x32x16_bf16 v[48:63], v[136:139], a[200:203], v[48:63]
    ds_read_b64_tr_b16 v[216:217], v236 offset:12288
    ds_read_b64_tr_b16 v[218:219], v236 offset:13312
    ds_read_b64_tr_b16 v[220:221], v237 offset:12288
    s_add_u32 m0, s27, 117760
    s_nop 0
    buffer_load_dwordx4 v15, s[12:15], s36 offen lds
    v_mfma_f32_32x32x16_bf16 v[64:79], v[140:143], a[200:203], v[64:79]
    ds_read_b64_tr_b16 v[222:223], v237 offset:13312
    ds_read_b64_tr_b16 v[224:225], v238 offset:12288
    ds_read_b64_tr_b16 v[226:227], v238 offset:13312
    v_mfma_f32_32x32x16_bf16 v[80:95], v[144:147], a[200:203], v[80:95]
    ds_read_b64_tr_b16 v[228:229], v239 offset:12288
    ds_read_b64_tr_b16 v[230:231], v239 offset:13312
    v_mfma_f32_32x32x16_bf16 v[240:255], v[148:151], a[200:203], v[240:255]
    v_mfma_f32_32x32x16_bf16 v[48:63], v[152:155], a[204:207], v[48:63]
    v_mfma_f32_32x32x16_bf16 v[64:79], v[156:159], a[204:207], v[64:79]
    v_mfma_f32_32x32x16_bf16 v[80:95], v[160:163], a[204:207], v[80:95]
    v_mfma_f32_32x32x16_bf16 v[240:255], v[164:167], a[204:207], v[240:255]
    s_waitcnt vmcnt(8) lgkmcnt(0)
    s_barrier
    s_mov_b32 s36, 524288
    v_mfma_f32_32x32x16_bf16 v[48:63], v[168:171], a[208:211], v[48:63]
    ds_read_b64_tr_b16 v[104:105], v236 offset:16384
    ds_read_b64_tr_b16 v[106:107], v236 offset:17408
    ds_read_b64_tr_b16 v[108:109], v237 offset:16384
    v_mfma_f32_32x32x16_bf16 v[64:79], v[172:175], a[208:211], v[64:79]
    ds_read_b64_tr_b16 v[110:111], v237 offset:17408
    ds_read_b64_tr_b16 v[112:113], v238 offset:16384
    ds_read_b64_tr_b16 v[114:115], v238 offset:17408
    v_mfma_f32_32x32x16_bf16 v[80:95], v[176:179], a[208:211], v[80:95]
    ds_read_b64_tr_b16 v[116:117], v239 offset:16384
    ds_read_b64_tr_b16 v[118:119], v239 offset:17408
    ds_read_b64_tr_b16 v[120:121], v236 offset:20480
    s_add_u32 m0, s27, 65536
    s_nop 0
    buffer_load_dwordx4 v12, s[12:15], s36 offen lds
    v_mfma_f32_32x32x16_bf16 v[240:255], v[180:183], a[208:211], v[240:255]
    ds_read_b64_tr_b16 v[122:123], v236 offset:21504
    ds_read_b64_tr_b16 v[124:125], v237 offset:20480
    ds_read_b64_tr_b16 v[126:127], v237 offset:21504
    v_mfma_f32_32x32x16_bf16 v[48:63], v[184:187], a[212:215], v[48:63]
    ds_read_b64_tr_b16 v[128:129], v238 offset:20480
    ds_read_b64_tr_b16 v[130:131], v238 offset:21504
    ds_read_b64_tr_b16 v[132:133], v239 offset:20480
    s_add_u32 m0, s27, 66560
    s_nop 0
    buffer_load_dwordx4 v13, s[12:15], s36 offen lds
    v_mfma_f32_32x32x16_bf16 v[64:79], v[188:191], a[212:215], v[64:79]
    ds_read_b64_tr_b16 v[134:135], v239 offset:21504
    ds_read_b64_tr_b16 v[136:137], v236 offset:24576
    ds_read_b64_tr_b16 v[138:139], v236 offset:25600
    v_mfma_f32_32x32x16_bf16 v[80:95], v[192:195], a[212:215], v[80:95]
    ds_read_b64_tr_b16 v[140:141], v237 offset:24576
    ds_read_b64_tr_b16 v[142:143], v237 offset:25600
    ds_read_b64_tr_b16 v[144:145], v238 offset:24576
    s_add_u32 m0, s27, 67584
    s_nop 0
    buffer_load_dwordx4 v14, s[12:15], s36 offen lds
    v_mfma_f32_32x32x16_bf16 v[240:255], v[196:199], a[212:215], v[240:255]
    ds_read_b64_tr_b16 v[146:147], v238 offset:25600
    ds_read_b64_tr_b16 v[148:149], v239 offset:24576
    ds_read_b64_tr_b16 v[150:151], v239 offset:25600
    v_mfma_f32_32x32x16_bf16 v[48:63], v[200:203], a[216:219], v[48:63]
    ds_read_b64_tr_b16 v[152:153], v236 offset:28672
    ds_read_b64_tr_b16 v[154:155], v236 offset:29696
    ds_read_b64_tr_b16 v[156:157], v237 offset:28672
    s_add_u32 m0, s27, 68608
    s_nop 0
    buffer_load_dwordx4 v15, s[12:15], s36 offen lds
    v_mfma_f32_32x32x16_bf16 v[64:79], v[204:207], a[216:219], v[64:79]
    ds_read_b64_tr_b16 v[158:159], v237 offset:29696
    ds_read_b64_tr_b16 v[160:161], v238 offset:28672
    ds_read_b64_tr_b16 v[162:163], v238 offset:29696
    v_mfma_f32_32x32x16_bf16 v[80:95], v[208:211], a[216:219], v[80:95]
    ds_read_b64_tr_b16 v[164:165], v239 offset:28672
    ds_read_b64_tr_b16 v[166:167], v239 offset:29696
    v_mfma_f32_32x32x16_bf16 v[240:255], v[212:215], a[216:219], v[240:255]
    v_mfma_f32_32x32x16_bf16 v[48:63], v[216:219], a[220:223], v[48:63]
    v_mfma_f32_32x32x16_bf16 v[64:79], v[220:223], a[220:223], v[64:79]
    v_mfma_f32_32x32x16_bf16 v[80:95], v[224:227], a[220:223], v[80:95]
    v_mfma_f32_32x32x16_bf16 v[240:255], v[228:231], a[220:223], v[240:255]
    s_waitcnt vmcnt(8) lgkmcnt(0)
    s_barrier
    s_mov_b32 s36, 786432
    v_mfma_f32_32x32x16_bf16 v[48:63], v[104:107], a[224:227], v[48:63]
    ds_read_b64_tr_b16 v[168:169], v28 offset:32768
    ds_read_b64_tr_b16 v[170:171], v28 offset:34816
    ds_read_b64_tr_b16 v[172:173], v29 offset:32768
    v_mfma_f32_32x32x16_bf16 v[64:79], v[108:111], a[224:227], v[64:79]
    ds_read_b64_tr_b16 v[174:175], v29 offset:34816
    ds_read_b64_tr_b16 v[176:177], v30 offset:32768
    ds_read_b64_tr_b16 v[178:179], v30 offset:34816
    v_mfma_f32_32x32x16_bf16 v[80:95], v[112:115], a[224:227], v[80:95]
    ds_read_b64_tr_b16 v[180:181], v31 offset:32768
    ds_read_b64_tr_b16 v[182:183], v31 offset:34816
    ds_read_b64_tr_b16 v[184:185], v28 offset:33024
    s_add_u32 m0, s27, 81920
    s_nop 0
    buffer_load_dwordx4 v12, s[12:15], s36 offen lds
    v_mfma_f32_32x32x16_bf16 v[240:255], v[116:119], a[224:227], v[240:255]
    ds_read_b64_tr_b16 v[186:187], v28 offset:35072
    ds_read_b64_tr_b16 v[188:189], v29 offset:33024
    ds_read_b64_tr_b16 v[190:191], v29 offset:35072
    v_mfma_f32_32x32x16_bf16 v[48:63], v[120:123], a[228:231], v[48:63]
    ds_read_b64_tr_b16 v[192:193], v30 offset:33024
    ds_read_b64_tr_b16 v[194:195], v30 offset:35072
    ds_read_b64_tr_b16 v[196:197], v31 offset:33024
    s_add_u32 m0, s27, 82944
    s_nop 0
    buffer_load_dwordx4 v13, s[12:15], s36 offen lds
    v_mfma_f32_32x32x16_bf16 v[64:79], v[124:127], a[228:231], v[64:79]
    ds_read_b64_tr_b16 v[198:199], v31 offset:35072
    ds_read_b64_tr_b16 v[200:201], v28 offset:40960
    ds_read_b64_tr_b16 v[202:203], v28 offset:43008
    v_mfma_f32_32x32x16_bf16 v[80:95], v[128:131], a[228:231], v[80:95]
    ds_read_b64_tr_b16 v[204:205], v29 offset:40960
    ds_read_b64_tr_b16 v[206:207], v29 offset:43008
    ds_read_b64_tr_b16 v[208:209], v30 offset:40960
    s_add_u32 m0, s27, 83968
    s_nop 0
    buffer_load_dwordx4 v14, s[12:15], s36 offen lds
    v_mfma_f32_32x32x16_bf16 v[240:255], v[132:135], a[228:231], v[240:255]
    ds_read_b64_tr_b16 v[210:211], v30 offset:43008
    ds_read_b64_tr_b16 v[212:213], v31 offset:40960
    ds_read_b64_tr_b16 v[214:215], v31 offset:43008
    v_mfma_f32_32x32x16_bf16 v[48:63], v[136:139], a[232:235], v[48:63]
    ds_read_b64_tr_b16 v[216:217], v28 offset:41216
    ds_read_b64_tr_b16 v[218:219], v28 offset:43264
    ds_read_b64_tr_b16 v[220:221], v29 offset:41216
    s_add_u32 m0, s27, 84992
    s_nop 0
    buffer_load_dwordx4 v15, s[12:15], s36 offen lds
    v_mfma_f32_32x32x16_bf16 v[64:79], v[140:143], a[232:235], v[64:79]
    ds_read_b64_tr_b16 v[222:223], v29 offset:43264
    ds_read_b64_tr_b16 v[224:225], v30 offset:41216
    ds_read_b64_tr_b16 v[226:227], v30 offset:43264
    v_mfma_f32_32x32x16_bf16 v[80:95], v[144:147], a[232:235], v[80:95]
    ds_read_b64_tr_b16 v[228:229], v31 offset:41216
    ds_read_b64_tr_b16 v[230:231], v31 offset:43264
    v_mfma_f32_32x32x16_bf16 v[240:255], v[148:151], a[232:235], v[240:255]
    v_mfma_f32_32x32x16_bf16 v[48:63], v[152:155], a[236:239], v[48:63]
    v_mfma_f32_32x32x16_bf16 v[64:79], v[156:159], a[236:239], v[64:79]
    v_mfma_f32_32x32x16_bf16 v[80:95], v[160:163], a[236:239], v[80:95]
    v_mfma_f32_32x32x16_bf16 v[240:255], v[164:167], a[236:239], v[240:255]
    s_waitcnt vmcnt(8) lgkmcnt(0)
    s_barrier
    s_mov_b32 s36, 1048576
    v_mfma_f32_32x32x16_bf16 a[0:15], v[168:171], a[128:131], 0
    ds_read_b64_tr_b16 v[104:105], v28 offset:49152
    ds_read_b64_tr_b16 v[106:107], v28 offset:51200
    ds_read_b64_tr_b16 v[108:109], v29 offset:49152
    v_mfma_f32_32x32x16_bf16 a[16:31], v[172:175], a[128:131], 0
    ds_read_b64_tr_b16 v[110:111], v29 offset:51200
    ds_read_b64_tr_b16 v[112:113], v30 offset:49152
    ds_read_b64_tr_b16 v[114:115], v30 offset:51200
    v_mfma_f32_32x32x16_bf16 a[32:47], v[176:179], a[128:131], 0
    ds_read_b64_tr_b16 v[116:117], v31 offset:49152
    ds_read_b64_tr_b16 v[118:119], v31 offset:51200
    ds_read_b64_tr_b16 v[120:121], v28 offset:49408
    s_add_u32 m0, s27, 98304
    s_nop 0
    buffer_load_dwordx4 v12, s[12:15], s36 offen lds
    v_mfma_f32_32x32x16_bf16 a[48:63], v[180:183], a[128:131], 0
    ds_read_b64_tr_b16 v[122:123], v28 offset:51456
    ds_read_b64_tr_b16 v[124:125], v29 offset:49408
    ds_read_b64_tr_b16 v[126:127], v29 offset:51456
    v_mfma_f32_32x32x16_bf16 a[64:79], v[184:187], a[128:131], 0
    ds_read_b64_tr_b16 v[128:129], v30 offset:49408
    ds_read_b64_tr_b16 v[130:131], v30 offset:51456
    ds_read_b64_tr_b16 v[132:133], v31 offset:49408
    s_add_u32 m0, s27, 99328
    s_nop 0
    buffer_load_dwordx4 v13, s[12:15], s36 offen lds
    v_mfma_f32_32x32x16_bf16 a[80:95], v[188:191], a[128:131], 0
    ds_read_b64_tr_b16 v[134:135], v31 offset:51456
    ds_read_b64_tr_b16 v[136:137], v28 offset:57344
    ds_read_b64_tr_b16 v[138:139], v28 offset:59392
    v_mfma_f32_32x32x16_bf16 a[96:111], v[192:195], a[128:131], 0
    ds_read_b64_tr_b16 v[140:141], v29 offset:57344
    ds_read_b64_tr_b16 v[142:143], v29 offset:59392
    ds_read_b64_tr_b16 v[144:145], v30 offset:57344
    s_add_u32 m0, s27, 100352
    s_nop 0
    buffer_load_dwordx4 v14, s[12:15], s36 offen lds
    v_mfma_f32_32x32x16_bf16 a[112:127], v[196:199], a[128:131], 0
    ds_read_b64_tr_b16 v[146:147], v30 offset:59392
    ds_read_b64_tr_b16 v[148:149], v31 offset:57344
    ds_read_b64_tr_b16 v[150:151], v31 offset:59392
    v_mfma_f32_32x32x16_bf16 a[0:15], v[200:203], a[132:135], a[0:15]
    ds_read_b64_tr_b16 v[152:153], v28 offset:57600
    ds_read_b64_tr_b16 v[154:155], v28 offset:59648
    ds_read_b64_tr_b16 v[156:157], v29 offset:57600
    s_add_u32 m0, s27, 101376
    s_nop 0
    buffer_load_dwordx4 v15, s[12:15], s36 offen lds
    v_mfma_f32_32x32x16_bf16 a[16:31], v[204:207], a[132:135], a[16:31]
    ds_read_b64_tr_b16 v[158:159], v29 offset:59648
    ds_read_b64_tr_b16 v[160:161], v30 offset:57600
    ds_read_b64_tr_b16 v[162:163], v30 offset:59648
    v_mfma_f32_32x32x16_bf16 a[32:47], v[208:211], a[132:135], a[32:47]
    ds_read_b64_tr_b16 v[164:165], v31 offset:57600
    ds_read_b64_tr_b16 v[166:167], v31 offset:59648
    v_mfma_f32_32x32x16_bf16 a[48:63], v[212:215], a[132:135], a[48:63]
    v_mfma_f32_32x32x16_bf16 a[64:79], v[216:219], a[132:135], a[64:79]
    v_mfma_f32_32x32x16_bf16 a[80:95], v[220:223], a[132:135], a[80:95]
    v_mfma_f32_32x32x16_bf16 a[96:111], v[224:227], a[132:135], a[96:111]
    v_mfma_f32_32x32x16_bf16 a[112:127], v[228:231], a[132:135], a[112:127]
    s_waitcnt vmcnt(8) lgkmcnt(0)
    s_barrier
    s_mov_b32 s36, 1310720
    v_mfma_f32_32x32x16_bf16 a[0:15], v[104:107], a[136:139], a[0:15]
    ds_read_b64_tr_b16 v[168:169], v28 offset:0
    ds_read_b64_tr_b16 v[170:171], v28 offset:2048
    ds_read_b64_tr_b16 v[172:173], v29 offset:0
    s_mov_b32 s39, 0xc0135761
    s_mov_b32 s56, 0xbdd2d3e8
    v_mfma_f32_32x32x16_bf16 a[16:31], v[108:111], a[136:139], a[16:31]
    ds_read_b64_tr_b16 v[174:175], v29 offset:2048
    ds_read_b64_tr_b16 v[176:177], v30 offset:0
    ds_read_b64_tr_b16 v[178:179], v30 offset:2048
    v_mov_b32 v39, s39
    v_cvt_pk_bf16_f32 v232, v48, v49
    v_mfma_f32_32x32x16_bf16 a[32:47], v[112:115], a[136:139], a[32:47]
    ds_read_b64_tr_b16 v[180:181], v31 offset:0
    ds_read_b64_tr_b16 v[182:183], v31 offset:2048
    ds_read_b64_tr_b16 v[184:185], v28 offset:256
    s_add_u32 m0, s27, 114688
    s_nop 0
    buffer_load_dwordx4 v12, s[12:15], s36 offen lds
    v_cvt_pk_bf16_f32 v233, v50, v51
    v_cvt_pk_bf16_f32 v234, v52, v53
    v_mfma_f32_32x32x16_bf16 a[48:63], v[116:119], a[136:139], a[48:63]
    ds_read_b64_tr_b16 v[186:187], v28 offset:2304
    ds_read_b64_tr_b16 v[188:189], v29 offset:256
    ds_read_b64_tr_b16 v[190:191], v29 offset:2304
    v_cvt_pk_bf16_f32 v235, v54, v55
    v_lshlrev_b32 v48, 16, v232
    v_mfma_f32_32x32x16_bf16 a[64:79], v[120:123], a[136:139], a[64:79]
    ds_read_b64_tr_b16 v[192:193], v30 offset:256
    ds_read_b64_tr_b16 v[194:195], v30 offset:2304
    ds_read_b64_tr_b16 v[196:197], v31 offset:256
    s_add_u32 m0, s27, 115712
    s_nop 0
    buffer_load_dwordx4 v13, s[12:15], s36 offen lds
    v_and_b32 v49, s38, v232
    v_lshlrev_b32 v50, 16, v233
    v_mfma_f32_32x32x16_bf16 a[80:95], v[124:127], a[136:139], a[80:95]
    ds_read_b64_tr_b16 v[198:199], v31 offset:2304
    ds_read_b64_tr_b16 v[200:201], v28 offset:8192
    ds_read_b64_tr_b16 v[202:203], v28 offset:10240
    v_and_b32 v51, s38, v233
    v_lshlrev_b32 v52, 16, v234
    v_mfma_f32_32x32x16_bf16 a[96:111], v[128:131], a[136:139], a[96:111]
    ds_read_b64_tr_b16 v[204:205], v29 offset:8192
    ds_read_b64_tr_b16 v[206:207], v29 offset:10240
    ds_read_b64_tr_b16 v[208:209], v30 offset:8192
    s_add_u32 m0, s27, 116736
    s_nop 0
    buffer_load_dwordx4 v14, s[12:15], s36 offen lds
    v_and_b32 v53, s38, v234
    v_lshlrev_b32 v54, 16, v235
    v_mfma_f32_32x32x16_bf16 a[112:127], v[132:135], a[136:139], a[112:127]
    ds_read_b64_tr_b16 v[210:211], v30 offset:10240
    ds_read_b64_tr_b16 v[212:213], v31 offset:8192
    ds_read_b64_tr_b16 v[214:215], v31 offset:10240
    v_and_b32 v55, s38, v235
    v_mul_f32 v96, v48, v48
    v_mfma_f32_32x32x16_bf16 a[0:15], v[136:139], a[140:143], a[0:15]
    ds_read_b64_tr_b16 v[216:217], v28 offset:8448
    ds_read_b64_tr_b16 v[218:219], v28 offset:10496
    ds_read_b64_tr_b16 v[220:221], v29 offset:8448
    s_add_u32 m0, s27, 117760
    s_nop 0
    buffer_load_dwordx4 v15, s[12:15], s36 offen lds
    v_mul_f32 v97, v49, v49
    v_mul_f32 v98, v50, v50
    v_mfma_f32_32x32x16_bf16 a[16:31], v[140:143], a[140:143], a[16:31]
    ds_read_b64_tr_b16 v[222:223], v29 offset:10496
    ds_read_b64_tr_b16 v[224:225], v30 offset:8448
    ds_read_b64_tr_b16 v[226:227], v30 offset:10496
    v_mul_f32 v99, v51, v51
    v_mul_f32 v100, v52, v52
    v_mfma_f32_32x32x16_bf16 a[32:47], v[144:147], a[140:143], a[32:47]
    ds_read_b64_tr_b16 v[228:229], v31 offset:8448
    ds_read_b64_tr_b16 v[230:231], v31 offset:10496
    v_mul_f32 v101, v53, v53
    v_mul_f32 v102, v54, v54
    v_mfma_f32_32x32x16_bf16 a[48:63], v[148:151], a[140:143], a[48:63]
    s_mov_b32 s28, 0
    s_add_u32 m0, s27, 0
    s_nop 0
    buffer_load_dwordx4 v4, s[4:7], s28 offen lds
    v_mul_f32 v103, v55, v55
    v_fma_f32 v96, v96, s56, v39
    v_fma_f32 v97, v97, s56, v39
    v_fma_f32 v98, v98, s56, v39
    v_fma_f32 v99, v99, s56, v39
    v_mfma_f32_32x32x16_bf16 a[64:79], v[152:155], a[140:143], a[64:79]
    v_fma_f32 v100, v100, s56, v39
    v_fma_f32 v101, v101, s56, v39
    v_fma_f32 v102, v102, s56, v39
    v_fma_f32 v103, v103, s56, v39
    v_mul_f32 v96, v96, v48
    v_mfma_f32_32x32x16_bf16 a[80:95], v[156:159], a[140:143], a[80:95]
    s_add_u32 m0, s27, 1024
    s_nop 0
    buffer_load_dwordx4 v5, s[4:7], s28 offen lds
    v_mul_f32 v97, v97, v49
    v_mul_f32 v98, v98, v50
    v_mul_f32 v99, v99, v51
    v_mul_f32 v100, v100, v52
    v_mul_f32 v101, v101, v53
    v_mfma_f32_32x32x16_bf16 a[96:111], v[160:163], a[140:143], a[96:111]
    v_mul_f32 v102, v102, v54
    v_mul_f32 v103, v103, v55
    v_exp_f32 v96, v96
    v_exp_f32 v97, v97
    v_exp_f32 v98, v98
    v_mfma_f32_32x32x16_bf16 a[112:127], v[164:167], a[140:143], a[112:127]
    s_add_u32 m0, s27, 2048
    s_nop 0
    buffer_load_dwordx4 v6, s[4:7], s28 offen lds
    v_exp_f32 v99, v99
    v_exp_f32 v100, v100
    v_exp_f32 v101, v101
    v_exp_f32 v102, v102
    v_exp_f32 v103, v103
    s_waitcnt vmcnt(11) lgkmcnt(0)
    s_barrier
    s_mov_b32 s36, 1572864
    v_mfma_f32_32x32x16_bf16 a[0:15], v[168:171], a[144:147], a[0:15]
    ds_read_b64_tr_b16 v[104:105], v28 offset:16384
    ds_read_b64_tr_b16 v[106:107], v28 offset:18432
    ds_read_b64_tr_b16 v[108:109], v29 offset:16384
    v_add_f32 v96, 1.0, v96
    v_add_f32 v97, 1.0, v97
    v_mfma_f32_32x32x16_bf16 a[16:31], v[172:175], a[144:147], a[16:31]
    ds_read_b64_tr_b16 v[110:111], v29 offset:18432
    ds_read_b64_tr_b16 v[112:113], v30 offset:16384
    ds_read_b64_tr_b16 v[114:115], v30 offset:18432
    v_add_f32 v98, 1.0, v98
    v_add_f32 v99, 1.0, v99
    v_mfma_f32_32x32x16_bf16 a[32:47], v[176:179], a[144:147], a[32:47]
    ds_read_b64_tr_b16 v[116:117], v31 offset:16384
    ds_read_b64_tr_b16 v[118:119], v31 offset:18432
    ds_read_b64_tr_b16 v[120:121], v28 offset:16640
    s_add_u32 m0, s27, 65536
    s_nop 0
    buffer_load_dwordx4 v12, s[12:15], s36 offen lds
    v_add_f32 v100, 1.0, v100
    v_add_f32 v101, 1.0, v101
    v_mfma_f32_32x32x16_bf16 a[48:63], v[180:183], a[144:147], a[48:63]
    ds_read_b64_tr_b16 v[122:123], v28 offset:18688
    ds_read_b64_tr_b16 v[124:125], v29 offset:16640
    ds_read_b64_tr_b16 v[126:127], v29 offset:18688
    v_add_f32 v102, 1.0, v102
    v_add_f32 v103, 1.0, v103
    v_mfma_f32_32x32x16_bf16 a[64:79], v[184:187], a[144:147], a[64:79]
    ds_read_b64_tr_b16 v[128:129], v30 offset:16640
    ds_read_b64_tr_b16 v[130:131], v30 offset:18688
    ds_read_b64_tr_b16 v[132:133], v31 offset:16640
    s_add_u32 m0, s27, 66560
    s_nop 0
    buffer_load_dwordx4 v13, s[12:15], s36 offen lds
    v_rcp_f32 v96, v96
    v_rcp_f32 v97, v97
    v_mfma_f32_32x32x16_bf16 a[80:95], v[188:191], a[144:147], a[80:95]
    ds_read_b64_tr_b16 v[134:135], v31 offset:18688
    ds_read_b64_tr_b16 v[136:137], v28 offset:24576
    ds_read_b64_tr_b16 v[138:139], v28 offset:26624
    v_rcp_f32 v98, v98
    v_rcp_f32 v99, v99
    v_mfma_f32_32x32x16_bf16 a[96:111], v[192:195], a[144:147], a[96:111]
    ds_read_b64_tr_b16 v[140:141], v29 offset:24576
    ds_read_b64_tr_b16 v[142:143], v29 offset:26624
    ds_read_b64_tr_b16 v[144:145], v30 offset:24576
    s_add_u32 m0, s27, 67584
    s_nop 0
    buffer_load_dwordx4 v14, s[12:15], s36 offen lds
    v_rcp_f32 v100, v100
    v_rcp_f32 v101, v101
    v_mfma_f32_32x32x16_bf16 a[112:127], v[196:199], a[144:147], a[112:127]
    ds_read_b64_tr_b16 v[146:147], v30 offset:26624
    ds_read_b64_tr_b16 v[148:149], v31 offset:24576
    ds_read_b64_tr_b16 v[150:151], v31 offset:26624
    v_rcp_f32 v102, v102
    v_rcp_f32 v103, v103
    v_mfma_f32_32x32x16_bf16 a[0:15], v[200:203], a[148:151], a[0:15]
    ds_read_b64_tr_b16 v[152:153], v28 offset:24832
    ds_read_b64_tr_b16 v[154:155], v28 offset:26880
    ds_read_b64_tr_b16 v[156:157], v29 offset:24832
    s_add_u32 m0, s27, 68608
    s_nop 0
    buffer_load_dwordx4 v15, s[12:15], s36 offen lds
    v_mul_f32 v96, v48, v96
    v_mul_f32 v97, v49, v97
    v_mfma_f32_32x32x16_bf16 a[16:31], v[204:207], a[148:151], a[16:31]
    ds_read_b64_tr_b16 v[158:159], v29 offset:26880
    ds_read_b64_tr_b16 v[160:161], v30 offset:24832
    ds_read_b64_tr_b16 v[162:163], v30 offset:26880
    v_mul_f32 v98, v50, v98
    v_mul_f32 v99, v51, v99
    v_mfma_f32_32x32x16_bf16 a[32:47], v[208:211], a[148:151], a[32:47]
    ds_read_b64_tr_b16 v[164:165], v31 offset:24832
    ds_read_b64_tr_b16 v[166:167], v31 offset:26880
    v_mul_f32 v100, v52, v100
    v_mul_f32 v101, v53, v101
    v_mfma_f32_32x32x16_bf16 a[48:63], v[212:215], a[148:151], a[48:63]
    s_add_u32 m0, s27, 3072
    s_nop 0
    buffer_load_dwordx4 v7, s[4:7], s28 offen lds
    v_mul_f32 v102, v54, v102
    v_mul_f32 v103, v55, v103
    v_cvt_pk_bf16_f32 v48, v96, v97
    v_cvt_pk_bf16_f32 v49, v98, v99
    v_cvt_pk_bf16_f32 v50, v100, v101
    v_mfma_f32_32x32x16_bf16 a[64:79], v[216:219], a[148:151], a[64:79]
    v_cvt_pk_bf16_f32 v51, v102, v103
    s_nop 1
    v_permlane32_swap_b32 v48, v50
    v_permlane32_swap_b32 v49, v51
    v_cvt_pk_bf16_f32 v236, v56, v57
    v_mfma_f32_32x32x16_bf16 a[80:95], v[220:223], a[148:151], a[80:95]
    s_mov_b32 s28, 16384
    s_add_u32 m0, s27, 16384
    s_nop 0
    buffer_load_dwordx4 v4, s[4:7], s28 offen lds
    v_cvt_pk_bf16_f32 v237, v58, v59
    v_cvt_pk_bf16_f32 v238, v60, v61
    v_cvt_pk_bf16_f32 v239, v62, v63
    v_lshlrev_b32 v56, 16, v236
    v_and_b32 v57, s38, v236
    v_mfma_f32_32x32x16_bf16 a[96:111], v[224:227], a[148:151], a[96:111]
    v_lshlrev_b32 v58, 16, v237
    v_and_b32 v59, s38, v237
    v_lshlrev_b32 v60, 16, v238
    v_and_b32 v61, s38, v238
    v_lshlrev_b32 v62, 16, v239
    v_mfma_f32_32x32x16_bf16 a[112:127], v[228:231], a[148:151], a[112:127]
    s_add_u32 m0, s27, 17408
    s_nop 0
    buffer_load_dwordx4 v5, s[4:7], s28 offen lds
    v_and_b32 v63, s38, v239
    v_mul_f32 v96, v56, v56
    v_mul_f32 v97, v57, v57
    v_mul_f32 v98, v58, v58
    v_mul_f32 v99, v59, v59
    s_waitcnt vmcnt(14) lgkmcnt(0)
    s_barrier
    s_mov_b32 s36, 1835008
    v_mfma_f32_32x32x16_bf16 a[0:15], v[104:107], a[152:155], a[0:15]
    ds_read_b64_tr_b16 v[168:169], v28 offset:32768
    ds_read_b64_tr_b16 v[170:171], v28 offset:34816
    ds_read_b64_tr_b16 v[172:173], v29 offset:32768
    v_mul_f32 v100, v60, v60
    v_mul_f32 v101, v61, v61
    v_mfma_f32_32x32x16_bf16 a[16:31], v[108:111], a[152:155], a[16:31]
    ds_read_b64_tr_b16 v[174:175], v29 offset:34816
    ds_read_b64_tr_b16 v[176:177], v30 offset:32768
    ds_read_b64_tr_b16 v[178:179], v30 offset:34816
    v_mul_f32 v102, v62, v62
    v_mul_f32 v103, v63, v63
    v_mfma_f32_32x32x16_bf16 a[32:47], v[112:115], a[152:155], a[32:47]
    ds_read_b64_tr_b16 v[180:181], v31 offset:32768
    ds_read_b64_tr_b16 v[182:183], v31 offset:34816
    ds_read_b64_tr_b16 v[184:185], v28 offset:33024
    s_add_u32 m0, s27, 81920
    s_nop 0
    buffer_load_dwordx4 v12, s[12:15], s36 offen lds
    v_fma_f32 v96, v96, s56, v39
    v_fma_f32 v97, v97, s56, v39
    v_mfma_f32_32x32x16_bf16 a[48:63], v[116:119], a[152:155], a[48:63]
    ds_read_b64_tr_b16 v[186:187], v28 offset:35072
    ds_read_b64_tr_b16 v[188:189], v29 offset:33024
    ds_read_b64_tr_b16 v[190:191], v29 offset:35072
    v_fma_f32 v98, v98, s56, v39
    v_fma_f32 v99, v99, s56, v39
    v_mfma_f32_32x32x16_bf16 a[64:79], v[120:123], a[152:155], a[64:79]
    ds_read_b64_tr_b16 v[192:193], v30 offset:33024
    ds_read_b64_tr_b16 v[194:195], v30 offset:35072
    ds_read_b64_tr_b16 v[196:197], v31 offset:33024
    s_add_u32 m0, s27, 82944
    s_nop 0
    buffer_load_dwordx4 v13, s[12:15], s36 offen lds
    v_fma_f32 v100, v100, s56, v39
    v_fma_f32 v101, v101, s56, v39
    v_mfma_f32_32x32x16_bf16 a[80:95], v[124:127], a[152:155], a[80:95]
    ds_read_b64_tr_b16 v[198:199], v31 offset:35072
    ds_read_b64_tr_b16 v[200:201], v28 offset:40960
    ds_read_b64_tr_b16 v[202:203], v28 offset:43008
    v_fma_f32 v102, v102, s56, v39
    v_fma_f32 v103, v103, s56, v39
    v_mfma_f32_32x32x16_bf16 a[96:111], v[128:131], a[152:155], a[96:111]
    ds_read_b64_tr_b16 v[204:205], v29 offset:40960
    ds_read_b64_tr_b16 v[206:207], v29 offset:43008
    ds_read_b64_tr_b16 v[208:209], v30 offset:40960
    s_add_u32 m0, s27, 83968
    s_nop 0
    buffer_load_dwordx4 v14, s[12:15], s36 offen lds
    v_mul_f32 v96, v96, v56
    v_mul_f32 v97, v97, v57
    v_mfma_f32_32x32x16_bf16 a[112:127], v[132:135], a[152:155], a[112:127]
    ds_read_b64_tr_b16 v[210:211], v30 offset:43008
    ds_read_b64_tr_b16 v[212:213], v31 offset:40960
    ds_read_b64_tr_b16 v[214:215], v31 offset:43008
    v_mul_f32 v98, v98, v58
    v_mul_f32 v99, v99, v59
    v_mfma_f32_32x32x16_bf16 a[0:15], v[136:139], a[156:159], a[0:15]
    ds_read_b64_tr_b16 v[216:217], v28 offset:41216
    ds_read_b64_tr_b16 v[218:219], v28 offset:43264
    ds_read_b64_tr_b16 v[220:221], v29 offset:41216
    s_add_u32 m0, s27, 84992
    s_nop 0
    buffer_load_dwordx4 v15, s[12:15], s36 offen lds
    v_mul_f32 v100, v100, v60
    v_mul_f32 v101, v101, v61
    v_mfma_f32_32x32x16_bf16 a[16:31], v[140:143], a[156:159], a[16:31]
    ds_read_b64_tr_b16 v[222:223], v29 offset:43264
    ds_read_b64_tr_b16 v[224:225], v30 offset:41216
    ds_read_b64_tr_b16 v[226:227], v30 offset:43264
    v_mul_f32 v102, v102, v62
    v_mul_f32 v103, v103, v63
    v_mfma_f32_32x32x16_bf16 a[32:47], v[144:147], a[156:159], a[32:47]
    ds_read_b64_tr_b16 v[228:229], v31 offset:41216
    ds_read_b64_tr_b16 v[230:231], v31 offset:43264
    v_exp_f32 v96, v96
    v_exp_f32 v97, v97
    v_mfma_f32_32x32x16_bf16 a[48:63], v[148:151], a[156:159], a[48:63]
    s_add_u32 m0, s27, 18432
    s_nop 0
    buffer_load_dwordx4 v6, s[4:7], s28 offen lds
    v_exp_f32 v98, v98
    v_exp_f32 v99, v99
    v_exp_f32 v100, v100
    v_exp_f32 v101, v101
    v_exp_f32 v102, v102
    v_mfma_f32_32x32x16_bf16 a[64:79], v[152:155], a[156:159], a[64:79]
    v_exp_f32 v103, v103
    v_add_f32 v96, 1.0, v96
    v_add_f32 v97, 1.0, v97
    v_add_f32 v98, 1.0, v98
    v_add_f32 v99, 1.0, v99
    v_mfma_f32_32x32x16_bf16 a[80:95], v[156:159], a[156:159], a[80:95]
    s_add_u32 m0, s27, 19456
    s_nop 0
    buffer_load_dwordx4 v7, s[4:7], s28 offen lds
    v_add_f32 v100, 1.0, v100
    v_add_f32 v101, 1.0, v101
    v_add_f32 v102, 1.0, v102
    v_add_f32 v103, 1.0, v103
    v_rcp_f32 v96, v96
    v_mfma_f32_32x32x16_bf16 a[96:111], v[160:163], a[156:159], a[96:111]
    v_rcp_f32 v97, v97
    v_rcp_f32 v98, v98
    v_rcp_f32 v99, v99
    v_rcp_f32 v100, v100
    v_rcp_f32 v101, v101
    v_mfma_f32_32x32x16_bf16 a[112:127], v[164:167], a[156:159], a[112:127]
    s_mov_b32 s28, 32768
    s_add_u32 m0, s27, 32768
    s_nop 0
    buffer_load_dwordx4 v4, s[4:7], s28 offen lds
    v_rcp_f32 v102, v102
    v_rcp_f32 v103, v103
    v_mul_f32 v96, v56, v96
    v_mul_f32 v97, v57, v97
    v_mul_f32 v98, v58, v98
    s_waitcnt vmcnt(17) lgkmcnt(0)
    s_barrier
    s_mov_b32 s36, 2097152
    v_mfma_f32_32x32x16_bf16 a[0:15], v[168:171], a[160:163], a[0:15]
    ds_read_b64_tr_b16 v[104:105], v28 offset:49152
    ds_read_b64_tr_b16 v[106:107], v28 offset:51200
    ds_read_b64_tr_b16 v[108:109], v29 offset:49152
    v_mul_f32 v99, v59, v99
    v_mul_f32 v100, v60, v100
    v_mfma_f32_32x32x16_bf16 a[16:31], v[172:175], a[160:163], a[16:31]
    ds_read_b64_tr_b16 v[110:111], v29 offset:51200
    ds_read_b64_tr_b16 v[112:113], v30 offset:49152
    ds_read_b64_tr_b16 v[114:115], v30 offset:51200
    v_mul_f32 v101, v61, v101
    v_mul_f32 v102, v62, v102
    v_mfma_f32_32x32x16_bf16 a[32:47], v[176:179], a[160:163], a[32:47]
    ds_read_b64_tr_b16 v[116:117], v31 offset:49152
    ds_read_b64_tr_b16 v[118:119], v31 offset:51200
    ds_read_b64_tr_b16 v[120:121], v28 offset:49408
    s_add_u32 m0, s27, 98304
    s_nop 0
    buffer_load_dwordx4 v12, s[12:15], s36 offen lds
    v_mul_f32 v103, v63, v103
    v_cvt_pk_bf16_f32 v56, v96, v97
    v_mfma_f32_32x32x16_bf16 a[48:63], v[180:183], a[160:163], a[48:63]
    ds_read_b64_tr_b16 v[122:123], v28 offset:51456
    ds_read_b64_tr_b16 v[124:125], v29 offset:49408
    ds_read_b64_tr_b16 v[126:127], v29 offset:51456
    v_cvt_pk_bf16_f32 v57, v98, v99
    v_cvt_pk_bf16_f32 v58, v100, v101
    v_mfma_f32_32x32x16_bf16 a[64:79], v[184:187], a[160:163], a[64:79]
    ds_read_b64_tr_b16 v[128:129], v30 offset:49408
    ds_read_b64_tr_b16 v[130:131], v30 offset:51456
    ds_read_b64_tr_b16 v[132:133], v31 offset:49408
    s_add_u32 m0, s27, 99328
    s_nop 0
    buffer_load_dwordx4 v13, s[12:15], s36 offen lds
    v_cvt_pk_bf16_f32 v59, v102, v103
    s_nop 1
    v_mfma_f32_32x32x16_bf16 a[80:95], v[188:191], a[160:163], a[80:95]
    ds_read_b64_tr_b16 v[134:135], v31 offset:51456
    ds_read_b64_tr_b16 v[136:137], v28 offset:57344
    ds_read_b64_tr_b16 v[138:139], v28 offset:59392
    v_permlane32_swap_b32 v56, v58
    v_permlane32_swap_b32 v57, v59
    v_mfma_f32_32x32x16_bf16 a[96:111], v[192:195], a[160:163], a[96:111]
    ds_read_b64_tr_b16 v[140:141], v29 offset:57344
    ds_read_b64_tr_b16 v[142:143], v29 offset:59392
    ds_read_b64_tr_b16 v[144:145], v30 offset:57344
    s_add_u32 m0, s27, 100352
    s_nop 0
    buffer_load_dwordx4 v14, s[12:15], s36 offen lds
    v_cvt_pk_bf16_f32 v232, v64, v65
    v_cvt_pk_bf16_f32 v233, v66, v67
    v_mfma_f32_32x32x16_bf16 a[112:127], v[196:199], a[160:163], a[112:127]
    ds_read_b64_tr_b16 v[146:147], v30 offset:59392
    ds_read_b64_tr_b16 v[148:149], v31 offset:57344
    ds_read_b64_tr_b16 v[150:151], v31 offset:59392
    v_cvt_pk_bf16_f32 v234, v68, v69
    v_cvt_pk_bf16_f32 v235, v70, v71
    v_mfma_f32_32x32x16_bf16 a[0:15], v[200:203], a[164:167], a[0:15]
    ds_read_b64_tr_b16 v[152:153], v28 offset:57600
    ds_read_b64_tr_b16 v[154:155], v28 offset:59648
    ds_read_b64_tr_b16 v[156:157], v29 offset:57600
    s_add_u32 m0, s27, 101376
    s_nop 0
    buffer_load_dwordx4 v15, s[12:15], s36 offen lds
    v_lshlrev_b32 v64, 16, v232
    v_and_b32 v65, s38, v232
    v_mfma_f32_32x32x16_bf16 a[16:31], v[204:207], a[164:167], a[16:31]
    ds_read_b64_tr_b16 v[158:159], v29 offset:59648
    ds_read_b64_tr_b16 v[160:161], v30 offset:57600
    ds_read_b64_tr_b16 v[162:163], v30 offset:59648
    v_lshlrev_b32 v66, 16, v233
    v_and_b32 v67, s38, v233
    v_mfma_f32_32x32x16_bf16 a[32:47], v[208:211], a[164:167], a[32:47]
    ds_read_b64_tr_b16 v[164:165], v31 offset:57600
    ds_read_b64_tr_b16 v[166:167], v31 offset:59648
    v_lshlrev_b32 v68, 16, v234
    v_and_b32 v69, s38, v234
    v_mfma_f32_32x32x16_bf16 a[48:63], v[212:215], a[164:167], a[48:63]
    s_add_u32 m0, s27, 33792
    s_nop 0
    buffer_load_dwordx4 v5, s[4:7], s28 offen lds
    v_lshlrev_b32 v70, 16, v235
    v_and_b32 v71, s38, v235
    v_mul_f32 v96, v64, v64
    v_mul_f32 v97, v65, v65
    v_mul_f32 v98, v66, v66
    v_mfma_f32_32x32x16_bf16 a[64:79], v[216:219], a[164:167], a[64:79]
    v_mul_f32 v99, v67, v67
    v_mul_f32 v100, v68, v68
    v_mul_f32 v101, v69, v69
    v_mul_f32 v102, v70, v70
    v_mul_f32 v103, v71, v71
    v_mfma_f32_32x32x16_bf16 a[80:95], v[220:223], a[164:167], a[80:95]
    s_add_u32 m0, s27, 34816
    s_nop 0
    buffer_load_dwordx4 v6, s[4:7], s28 offen lds
    v_fma_f32 v96, v96, s56, v39
    v_fma_f32 v97, v97, s56, v39
    v_fma_f32 v98, v98, s56, v39
    v_fma_f32 v99, v99, s56, v39
    v_fma_f32 v100, v100, s56, v39
    v_mfma_f32_32x32x16_bf16 a[96:111], v[224:227], a[164:167], a[96:111]
    v_fma_f32 v101, v101, s56, v39
    v_fma_f32 v102, v102, s56, v39
    v_fma_f32 v103, v103, s56, v39
    v_mul_f32 v96, v96, v64
    v_mul_f32 v97, v97, v65
    v_mfma_f32_32x32x16_bf16 a[112:127], v[228:231], a[164:167], a[112:127]
    s_add_u32 m0, s27, 35840
    s_nop 0
    buffer_load_dwordx4 v7, s[4:7], s28 offen lds
    v_mul_f32 v98, v98, v66
    v_mul_f32 v99, v99, v67
    v_mul_f32 v100, v100, v68
    v_mul_f32 v101, v101, v69
    v_mul_f32 v102, v102, v70
    s_waitcnt vmcnt(17) lgkmcnt(0)
    s_barrier
    s_mov_b32 s36, 2359296
    v_mfma_f32_32x32x16_bf16 a[0:15], v[104:107], a[168:171], a[0:15]
    ds_read_b64_tr_b16 v[168:169], v28 offset:0
    ds_read_b64_tr_b16 v[170:171], v28 offset:2048
    ds_read_b64_tr_b16 v[172:173], v29 offset:0
    v_mul_f32 v103, v103, v71
    v_exp_f32 v96, v96
    v_mfma_f32_32x32x16_bf16 a[16:31], v[108:111], a[168:171], a[16:31]
    ds_read_b64_tr_b16 v[174:175], v29 offset:2048
    ds_read_b64_tr_b16 v[176:177], v30 offset:0
    ds_read_b64_tr_b16 v[178:179], v30 offset:2048
    v_exp_f32 v97, v97
    v_exp_f32 v98, v98
    v_mfma_f32_32x32x16_bf16 a[32:47], v[112:115], a[168:171], a[32:47]
    ds_read_b64_tr_b16 v[180:181], v31 offset:0
    ds_read_b64_tr_b16 v[182:183], v31 offset:2048
    ds_read_b64_tr_b16 v[184:185], v28 offset:256
    s_add_u32 m0, s27, 114688
    s_nop 0
    buffer_load_dwordx4 v12, s[12:15], s36 offen lds
    v_exp_f32 v99, v99
    v_exp_f32 v100, v100
    v_mfma_f32_32x32x16_bf16 a[48:63], v[116:119], a[168:171], a[48:63]
    ds_read_b64_tr_b16 v[186:187], v28 offset:2304
    ds_read_b64_tr_b16 v[188:189], v29 offset:256
    ds_read_b64_tr_b16 v[190:191], v29 offset:2304
    v_exp_f32 v101, v101
    v_exp_f32 v102, v102
    v_mfma_f32_32x32x16_bf16 a[64:79], v[120:123], a[168:171], a[64:79]
    ds_read_b64_tr_b16 v[192:193], v30 offset:256
    ds_read_b64_tr_b16 v[194:195], v30 offset:2304
    ds_read_b64_tr_b16 v[196:197], v31 offset:256
    s_add_u32 m0, s27, 115712
    s_nop 0
    buffer_load_dwordx4 v13, s[12:15], s36 offen lds
    v_exp_f32 v103, v103
    v_add_f32 v96, 1.0, v96
    v_mfma_f32_32x32x16_bf16 a[80:95], v[124:127], a[168:171], a[80:95]
    ds_read_b64_tr_b16 v[198:199], v31 offset:2304
    ds_read_b64_tr_b16 v[200:201], v28 offset:8192
    ds_read_b64_tr_b16 v[202:203], v28 offset:10240
    v_add_f32 v97, 1.0, v97
    v_add_f32 v98, 1.0, v98
    v_mfma_f32_32x32x16_bf16 a[96:111], v[128:131], a[168:171], a[96:111]
    ds_read_b64_tr_b16 v[204:205], v29 offset:8192
    ds_read_b64_tr_b16 v[206:207], v29 offset:10240
    ds_read_b64_tr_b16 v[208:209], v30 offset:8192
    s_add_u32 m0, s27, 116736
    s_nop 0
    buffer_load_dwordx4 v14, s[12:15], s36 offen lds
    v_add_f32 v99, 1.0, v99
    v_add_f32 v100, 1.0, v100
    v_mfma_f32_32x32x16_bf16 a[112:127], v[132:135], a[168:171], a[112:127]
    ds_read_b64_tr_b16 v[210:211], v30 offset:10240
    ds_read_b64_tr_b16 v[212:213], v31 offset:8192
    ds_read_b64_tr_b16 v[214:215], v31 offset:10240
    v_add_f32 v101, 1.0, v101
    v_add_f32 v102, 1.0, v102
    v_mfma_f32_32x32x16_bf16 a[0:15], v[136:139], a[172:175], a[0:15]
    ds_read_b64_tr_b16 v[216:217], v28 offset:8448
    ds_read_b64_tr_b16 v[218:219], v28 offset:10496
    ds_read_b64_tr_b16 v[220:221], v29 offset:8448
    s_add_u32 m0, s27, 117760
    s_nop 0
    buffer_load_dwordx4 v15, s[12:15], s36 offen lds
    v_add_f32 v103, 1.0, v103
    v_rcp_f32 v96, v96
    v_mfma_f32_32x32x16_bf16 a[16:31], v[140:143], a[172:175], a[16:31]
    ds_read_b64_tr_b16 v[222:223], v29 offset:10496
    ds_read_b64_tr_b16 v[224:225], v30 offset:8448
    ds_read_b64_tr_b16 v[226:227], v30 offset:10496
    v_rcp_f32 v97, v97
    v_rcp_f32 v98, v98
    v_mfma_f32_32x32x16_bf16 a[32:47], v[144:147], a[172:175], a[32:47]
    ds_read_b64_tr_b16 v[228:229], v31 offset:8448
    ds_read_b64_tr_b16 v[230:231], v31 offset:10496
    v_rcp_f32 v99, v99
    v_rcp_f32 v100, v100
    v_mfma_f32_32x32x16_bf16 a[48:63], v[148:151], a[172:175], a[48:63]
    s_mov_b32 s28, 49152
    s_add_u32 m0, s27, 49152
    s_nop 0
    buffer_load_dwordx4 v4, s[4:7], s28 offen lds
    v_rcp_f32 v101, v101
    v_rcp_f32 v102, v102
    v_rcp_f32 v103, v103
    v_mul_f32 v96, v64, v96
    v_mul_f32 v97, v65, v97
    v_mfma_f32_32x32x16_bf16 a[64:79], v[152:155], a[172:175], a[64:79]
    v_mul_f32 v98, v66, v98
    v_mul_f32 v99, v67, v99
    v_mul_f32 v100, v68, v100
    v_mul_f32 v101, v69, v101
    v_mul_f32 v102, v70, v102
    v_mfma_f32_32x32x16_bf16 a[80:95], v[156:159], a[172:175], a[80:95]
    s_add_u32 m0, s27, 50176
    s_nop 0
    buffer_load_dwordx4 v5, s[4:7], s28 offen lds
    v_mul_f32 v103, v71, v103
    v_cvt_pk_bf16_f32 v64, v96, v97
    v_cvt_pk_bf16_f32 v65, v98, v99
    v_cvt_pk_bf16_f32 v66, v100, v101
    v_cvt_pk_bf16_f32 v67, v102, v103
    v_mfma_f32_32x32x16_bf16 a[96:111], v[160:163], a[172:175], a[96:111]
    s_nop 1
    v_permlane32_swap_b32 v64, v66
    v_permlane32_swap_b32 v65, v67
    v_cvt_pk_bf16_f32 v236, v72, v73
    v_cvt_pk_bf16_f32 v237, v74, v75
    v_mfma_f32_32x32x16_bf16 a[112:127], v[164:167], a[172:175], a[112:127]
    s_add_u32 m0, s27, 51200
    s_nop 0
    buffer_load_dwordx4 v6, s[4:7], s28 offen lds
    v_cvt_pk_bf16_f32 v238, v76, v77
    v_cvt_pk_bf16_f32 v239, v78, v79
    v_lshlrev_b32 v72, 16, v236
    v_and_b32 v73, s38, v236
    v_lshlrev_b32 v74, 16, v237
    s_waitcnt vmcnt(17) lgkmcnt(0)
    s_barrier
    s_mov_b32 s36, 2621440
    v_mfma_f32_32x32x16_bf16 a[0:15], v[168:171], a[176:179], a[0:15]
    ds_read_b64_tr_b16 v[104:105], v28 offset:16384
    ds_read_b64_tr_b16 v[106:107], v28 offset:18432
    ds_read_b64_tr_b16 v[108:109], v29 offset:16384
    v_and_b32 v75, s38, v237
    v_lshlrev_b32 v76, 16, v238
    v_mfma_f32_32x32x16_bf16 a[16:31], v[172:175], a[176:179], a[16:31]
    ds_read_b64_tr_b16 v[110:111], v29 offset:18432
    ds_read_b64_tr_b16 v[112:113], v30 offset:16384
    ds_read_b64_tr_b16 v[114:115], v30 offset:18432
    v_and_b32 v77, s38, v238
    v_lshlrev_b32 v78, 16, v239
    v_mfma_f32_32x32x16_bf16 a[32:47], v[176:179], a[176:179], a[32:47]
    ds_read_b64_tr_b16 v[116:117], v31 offset:16384
    ds_read_b64_tr_b16 v[118:119], v31 offset:18432
    ds_read_b64_tr_b16 v[120:121], v28 offset:16640
    s_add_u32 m0, s27, 65536
    s_nop 0
    buffer_load_dwordx4 v12, s[12:15], s36 offen lds
    v_and_b32 v79, s38, v239
    v_mul_f32 v96, v72, v72
    v_mfma_f32_32x32x16_bf16 a[48:63], v[180:183], a[176:179], a[48:63]
    ds_read_b64_tr_b16 v[122:123], v28 offset:18688
    ds_read_b64_tr_b16 v[124:125], v29 offset:16640
    ds_read_b64_tr_b16 v[126:127], v29 offset:18688
    v_mul_f32 v97, v73, v73
    v_mul_f32 v98, v74, v74
    v_mfma_f32_32x32x16_bf16 a[64:79], v[184:187], a[176:179], a[64:79]
    ds_read_b64_tr_b16 v[128:129], v30 offset:16640
    ds_read_b64_tr_b16 v[130:131], v30 offset:18688
    ds_read_b64_tr_b16 v[132:133], v31 offset:16640
    s_add_u32 m0, s27, 66560
    s_nop 0
    buffer_load_dwordx4 v13, s[12:15], s36 offen lds
    v_mul_f32 v99, v75, v75
    v_mul_f32 v100, v76, v76
    v_mfma_f32_32x32x16_bf16 a[80:95], v[188:191], a[176:179], a[80:95]
    ds_read_b64_tr_b16 v[134:135], v31 offset:18688
    ds_read_b64_tr_b16 v[136:137], v28 offset:24576
    ds_read_b64_tr_b16 v[138:139], v28 offset:26624
    v_mul_f32 v101, v77, v77
    v_mul_f32 v102, v78, v78
    v_mfma_f32_32x32x16_bf16 a[96:111], v[192:195], a[176:179], a[96:111]
    ds_read_b64_tr_b16 v[140:141], v29 offset:24576
    ds_read_b64_tr_b16 v[142:143], v29 offset:26624
    ds_read_b64_tr_b16 v[144:145], v30 offset:24576
    s_add_u32 m0, s27, 67584
    s_nop 0
    buffer_load_dwordx4 v14, s[12:15], s36 offen lds
    v_mul_f32 v103, v79, v79
    v_fma_f32 v96, v96, s56, v39
    v_mfma_f32_32x32x16_bf16 a[112:127], v[196:199], a[176:179], a[112:127]
    ds_read_b64_tr_b16 v[146:147], v30 offset:26624
    ds_read_b64_tr_b16 v[148:149], v31 offset:24576
    ds_read_b64_tr_b16 v[150:151], v31 offset:26624
    v_fma_f32 v97, v97, s56, v39
    v_fma_f32 v98, v98, s56, v39
    v_mfma_f32_32x32x16_bf16 a[0:15], v[200:203], a[180:183], a[0:15]
    ds_read_b64_tr_b16 v[152:153], v28 offset:24832
    ds_read_b64_tr_b16 v[154:155], v28 offset:26880
    ds_read_b64_tr_b16 v[156:157], v29 offset:24832
    s_add_u32 m0, s27, 68608
    s_nop 0
    buffer_load_dwordx4 v15, s[12:15], s36 offen lds
    v_fma_f32 v99, v99, s56, v39
    v_fma_f32 v100, v100, s56, v39
    v_mfma_f32_32x32x16_bf16 a[16:31], v[204:207], a[180:183], a[16:31]
    ds_read_b64_tr_b16 v[158:159], v29 offset:26880
    ds_read_b64_tr_b16 v[160:161], v30 offset:24832
    ds_read_b64_tr_b16 v[162:163], v30 offset:26880
    v_fma_f32 v101, v101, s56, v39
    v_fma_f32 v102, v102, s56, v39
    v_mfma_f32_32x32x16_bf16 a[32:47], v[208:211], a[180:183], a[32:47]
    ds_read_b64_tr_b16 v[164:165], v31 offset:24832
    ds_read_b64_tr_b16 v[166:167], v31 offset:26880
    v_fma_f32 v103, v103, s56, v39
    v_mul_f32 v96, v96, v72
    v_mfma_f32_32x32x16_bf16 a[48:63], v[212:215], a[180:183], a[48:63]
    s_add_u32 m0, s27, 52224
    s_nop 0
    buffer_load_dwordx4 v7, s[4:7], s28 offen lds
    v_mul_f32 v97, v97, v73
    v_mul_f32 v98, v98, v74
    v_mul_f32 v99, v99, v75
    v_mul_f32 v100, v100, v76
    v_mul_f32 v101, v101, v77
    v_mfma_f32_32x32x16_bf16 a[64:79], v[216:219], a[180:183], a[64:79]
    v_mul_f32 v102, v102, v78
    v_mul_f32 v103, v103, v79
    v_exp_f32 v96, v96
    v_exp_f32 v97, v97
    v_exp_f32 v98, v98
    v_mfma_f32_32x32x16_bf16 a[80:95], v[220:223], a[180:183], a[80:95]
    v_exp_f32 v99, v99
    v_exp_f32 v100, v100
    v_exp_f32 v101, v101
    v_exp_f32 v102, v102
    v_exp_f32 v103, v103
    v_mfma_f32_32x32x16_bf16 a[96:111], v[224:227], a[180:183], a[96:111]
    v_add_f32 v96, 1.0, v96
    v_add_f32 v97, 1.0, v97
    v_add_f32 v98, 1.0, v98
    v_add_f32 v99, 1.0, v99
    v_add_f32 v100, 1.0, v100
    v_mfma_f32_32x32x16_bf16 a[112:127], v[228:231], a[180:183], a[112:127]
    v_add_f32 v101, 1.0, v101
    v_add_f32 v102, 1.0, v102
    v_add_f32 v103, 1.0, v103
    v_rcp_f32 v96, v96
    v_rcp_f32 v97, v97
    s_waitcnt vmcnt(15) lgkmcnt(0)
    s_barrier
    s_mov_b32 s36, 2883584
    v_mfma_f32_32x32x16_bf16 a[0:15], v[104:107], a[184:187], a[0:15]
    ds_read_b64_tr_b16 v[168:169], v28 offset:32768
    ds_read_b64_tr_b16 v[170:171], v28 offset:34816
    ds_read_b64_tr_b16 v[172:173], v29 offset:32768
    v_rcp_f32 v98, v98
    v_rcp_f32 v99, v99
    v_mfma_f32_32x32x16_bf16 a[16:31], v[108:111], a[184:187], a[16:31]
    ds_read_b64_tr_b16 v[174:175], v29 offset:34816
    ds_read_b64_tr_b16 v[176:177], v30 offset:32768
    ds_read_b64_tr_b16 v[178:179], v30 offset:34816
    v_rcp_f32 v100, v100
    v_rcp_f32 v101, v101
    v_mfma_f32_32x32x16_bf16 a[32:47], v[112:115], a[184:187], a[32:47]
    ds_read_b64_tr_b16 v[180:181], v31 offset:32768
    ds_read_b64_tr_b16 v[182:183], v31 offset:34816
    ds_read_b64_tr_b16 v[184:185], v28 offset:33024
    s_add_u32 m0, s27, 81920
    s_nop 0
    buffer_load_dwordx4 v12, s[12:15], s36 offen lds
    v_rcp_f32 v102, v102
    v_rcp_f32 v103, v103
    v_mfma_f32_32x32x16_bf16 a[48:63], v[116:119], a[184:187], a[48:63]
    ds_read_b64_tr_b16 v[186:187], v28 offset:35072
    ds_read_b64_tr_b16 v[188:189], v29 offset:33024
    ds_read_b64_tr_b16 v[190:191], v29 offset:35072
    v_mul_f32 v96, v72, v96
    v_mul_f32 v97, v73, v97
    v_mfma_f32_32x32x16_bf16 a[64:79], v[120:123], a[184:187], a[64:79]
    ds_read_b64_tr_b16 v[192:193], v30 offset:33024
    ds_read_b64_tr_b16 v[194:195], v30 offset:35072
    ds_read_b64_tr_b16 v[196:197], v31 offset:33024
    s_add_u32 m0, s27, 82944
    s_nop 0
    buffer_load_dwordx4 v13, s[12:15], s36 offen lds
    v_mul_f32 v98, v74, v98
    v_mul_f32 v99, v75, v99
    v_mfma_f32_32x32x16_bf16 a[80:95], v[124:127], a[184:187], a[80:95]
    ds_read_b64_tr_b16 v[198:199], v31 offset:35072
    ds_read_b64_tr_b16 v[200:201], v28 offset:40960
    ds_read_b64_tr_b16 v[202:203], v28 offset:43008
    v_mul_f32 v100, v76, v100
    v_mul_f32 v101, v77, v101
    v_mfma_f32_32x32x16_bf16 a[96:111], v[128:131], a[184:187], a[96:111]
    ds_read_b64_tr_b16 v[204:205], v29 offset:40960
    ds_read_b64_tr_b16 v[206:207], v29 offset:43008
    ds_read_b64_tr_b16 v[208:209], v30 offset:40960
    s_add_u32 m0, s27, 83968
    s_nop 0
    buffer_load_dwordx4 v14, s[12:15], s36 offen lds
    v_mul_f32 v102, v78, v102
    v_mul_f32 v103, v79, v103
    v_mfma_f32_32x32x16_bf16 a[112:127], v[132:135], a[184:187], a[112:127]
    ds_read_b64_tr_b16 v[210:211], v30 offset:43008
    ds_read_b64_tr_b16 v[212:213], v31 offset:40960
    ds_read_b64_tr_b16 v[214:215], v31 offset:43008
    v_cvt_pk_bf16_f32 v72, v96, v97
    v_cvt_pk_bf16_f32 v73, v98, v99
    v_mfma_f32_32x32x16_bf16 a[0:15], v[136:139], a[188:191], a[0:15]
    ds_read_b64_tr_b16 v[216:217], v28 offset:41216
    ds_read_b64_tr_b16 v[218:219], v28 offset:43264
    ds_read_b64_tr_b16 v[220:221], v29 offset:41216
    s_add_u32 m0, s27, 84992
    s_nop 0
    buffer_load_dwordx4 v15, s[12:15], s36 offen lds
    v_cvt_pk_bf16_f32 v74, v100, v101
    v_cvt_pk_bf16_f32 v75, v102, v103
    v_mfma_f32_32x32x16_bf16 a[16:31], v[140:143], a[188:191], a[16:31]
    ds_read_b64_tr_b16 v[222:223], v29 offset:43264
    ds_read_b64_tr_b16 v[224:225], v30 offset:41216
    ds_read_b64_tr_b16 v[226:227], v30 offset:43264
    s_nop 1
    v_permlane32_swap_b32 v72, v74
    v_mfma_f32_32x32x16_bf16 a[32:47], v[144:147], a[188:191], a[32:47]
    ds_read_b64_tr_b16 v[228:229], v31 offset:41216
    ds_read_b64_tr_b16 v[230:231], v31 offset:43264
    v_permlane32_swap_b32 v73, v75
    v_cvt_pk_bf16_f32 v232, v80, v81
    v_mfma_f32_32x32x16_bf16 a[48:63], v[148:151], a[188:191], a[48:63]
    v_cvt_pk_bf16_f32 v233, v82, v83
    v_cvt_pk_bf16_f32 v234, v84, v85
    v_cvt_pk_bf16_f32 v235, v86, v87
    v_lshlrev_b32 v80, 16, v232
    v_and_b32 v81, s38, v232
    v_mfma_f32_32x32x16_bf16 a[64:79], v[152:155], a[188:191], a[64:79]
    v_lshlrev_b32 v82, 16, v233
    v_and_b32 v83, s38, v233
    v_lshlrev_b32 v84, 16, v234
    v_and_b32 v85, s38, v234
    v_lshlrev_b32 v86, 16, v235
    v_mfma_f32_32x32x16_bf16 a[80:95], v[156:159], a[188:191], a[80:95]
    v_and_b32 v87, s38, v235
    v_mul_f32 v96, v80, v80
    v_mul_f32 v97, v81, v81
    v_mul_f32 v98, v82, v82
    v_mul_f32 v99, v83, v83
    v_mfma_f32_32x32x16_bf16 a[96:111], v[160:163], a[188:191], a[96:111]
    v_mul_f32 v100, v84, v84
    v_mul_f32 v101, v85, v85
    v_mul_f32 v102, v86, v86
    v_mul_f32 v103, v87, v87
    v_fma_f32 v96, v96, s56, v39
    v_mfma_f32_32x32x16_bf16 a[112:127], v[164:167], a[188:191], a[112:127]
    v_fma_f32 v97, v97, s56, v39
    v_fma_f32 v98, v98, s56, v39
    v_fma_f32 v99, v99, s56, v39
    v_fma_f32 v100, v100, s56, v39
    v_fma_f32 v101, v101, s56, v39
    s_waitcnt vmcnt(12) lgkmcnt(0)
    s_barrier
    s_mov_b32 s36, 3145728
    v_mfma_f32_32x32x16_bf16 a[0:15], v[168:171], a[192:195], a[0:15]
    ds_read_b64_tr_b16 v[104:105], v28 offset:49152
    ds_read_b64_tr_b16 v[106:107], v28 offset:51200
    ds_read_b64_tr_b16 v[108:109], v29 offset:49152
    v_fma_f32 v102, v102, s56, v39
    v_fma_f32 v103, v103, s56, v39
    v_mfma_f32_32x32x16_bf16 a[16:31], v[172:175], a[192:195], a[16:31]
    ds_read_b64_tr_b16 v[110:111], v29 offset:51200
    ds_read_b64_tr_b16 v[112:113], v30 offset:49152
    ds_read_b64_tr_b16 v[114:115], v30 offset:51200
    v_mul_f32 v96, v96, v80
    v_mul_f32 v97, v97, v81
    v_mfma_f32_32x32x16_bf16 a[32:47], v[176:179], a[192:195], a[32:47]
    ds_read_b64_tr_b16 v[116:117], v31 offset:49152
    ds_read_b64_tr_b16 v[118:119], v31 offset:51200
    ds_read_b64_tr_b16 v[120:121], v28 offset:49408
    s_add_u32 m0, s27, 98304
    s_nop 0
    buffer_load_dwordx4 v12, s[12:15], s36 offen lds
    v_mul_f32 v98, v98, v82
    v_mul_f32 v99, v99, v83
    v_mfma_f32_32x32x16_bf16 a[48:63], v[180:183], a[192:195], a[48:63]
    ds_read_b64_tr_b16 v[122:123], v28 offset:51456
    ds_read_b64_tr_b16 v[124:125], v29 offset:49408
    ds_read_b64_tr_b16 v[126:127], v29 offset:51456
    v_mul_f32 v100, v100, v84
    v_mul_f32 v101, v101, v85
    v_mfma_f32_32x32x16_bf16 a[64:79], v[184:187], a[192:195], a[64:79]
    ds_read_b64_tr_b16 v[128:129], v30 offset:49408
    ds_read_b64_tr_b16 v[130:131], v30 offset:51456
    ds_read_b64_tr_b16 v[132:133], v31 offset:49408
    s_add_u32 m0, s27, 99328
    s_nop 0
    buffer_load_dwordx4 v13, s[12:15], s36 offen lds
    v_mul_f32 v102, v102, v86
    v_mul_f32 v103, v103, v87
    v_mfma_f32_32x32x16_bf16 a[80:95], v[188:191], a[192:195], a[80:95]
    ds_read_b64_tr_b16 v[134:135], v31 offset:51456
    ds_read_b64_tr_b16 v[136:137], v28 offset:57344
    ds_read_b64_tr_b16 v[138:139], v28 offset:59392
    v_exp_f32 v96, v96
    v_exp_f32 v97, v97
    v_mfma_f32_32x32x16_bf16 a[96:111], v[192:195], a[192:195], a[96:111]
    ds_read_b64_tr_b16 v[140:141], v29 offset:57344
    ds_read_b64_tr_b16 v[142:143], v29 offset:59392
    ds_read_b64_tr_b16 v[144:145], v30 offset:57344
    s_add_u32 m0, s27, 100352
    s_nop 0
    buffer_load_dwordx4 v14, s[12:15], s36 offen lds
    v_exp_f32 v98, v98
    v_exp_f32 v99, v99
    v_mfma_f32_32x32x16_bf16 a[112:127], v[196:199], a[192:195], a[112:127]
    ds_read_b64_tr_b16 v[146:147], v30 offset:59392
    ds_read_b64_tr_b16 v[148:149], v31 offset:57344
    ds_read_b64_tr_b16 v[150:151], v31 offset:59392
    v_exp_f32 v100, v100
    v_exp_f32 v101, v101
    v_mfma_f32_32x32x16_bf16 a[0:15], v[200:203], a[196:199], a[0:15]
    ds_read_b64_tr_b16 v[152:153], v28 offset:57600
    ds_read_b64_tr_b16 v[154:155], v28 offset:59648
    ds_read_b64_tr_b16 v[156:157], v29 offset:57600
    s_add_u32 m0, s27, 101376
    s_nop 0
    buffer_load_dwordx4 v15, s[12:15], s36 offen lds
    v_exp_f32 v102, v102
    v_exp_f32 v103, v103
    v_mfma_f32_32x32x16_bf16 a[16:31], v[204:207], a[196:199], a[16:31]
    ds_read_b64_tr_b16 v[158:159], v29 offset:59648
    ds_read_b64_tr_b16 v[160:161], v30 offset:57600
    ds_read_b64_tr_b16 v[162:163], v30 offset:59648
    v_add_f32 v96, 1.0, v96
    v_add_f32 v97, 1.0, v97
    v_mfma_f32_32x32x16_bf16 a[32:47], v[208:211], a[196:199], a[32:47]
    ds_read_b64_tr_b16 v[164:165], v31 offset:57600
    ds_read_b64_tr_b16 v[166:167], v31 offset:59648
    v_add_f32 v98, 1.0, v98
    v_add_f32 v99, 1.0, v99
    v_mfma_f32_32x32x16_bf16 a[48:63], v[212:215], a[196:199], a[48:63]
    v_add_f32 v100, 1.0, v100
    v_add_f32 v101, 1.0, v101
    v_add_f32 v102, 1.0, v102
    v_add_f32 v103, 1.0, v103
    v_rcp_f32 v96, v96
    v_mfma_f32_32x32x16_bf16 a[64:79], v[216:219], a[196:199], a[64:79]
    v_rcp_f32 v97, v97
    v_rcp_f32 v98, v98
    v_rcp_f32 v99, v99
    v_rcp_f32 v100, v100
    v_rcp_f32 v101, v101
    v_mfma_f32_32x32x16_bf16 a[80:95], v[220:223], a[196:199], a[80:95]
    v_rcp_f32 v102, v102
    v_rcp_f32 v103, v103
    v_mul_f32 v96, v80, v96
    v_mul_f32 v97, v81, v97
    v_mul_f32 v98, v82, v98
    v_mfma_f32_32x32x16_bf16 a[96:111], v[224:227], a[196:199], a[96:111]
    v_mul_f32 v99, v83, v99
    v_mul_f32 v100, v84, v100
    v_mul_f32 v101, v85, v101
    v_mul_f32 v102, v86, v102
    v_mul_f32 v103, v87, v103
    v_mfma_f32_32x32x16_bf16 a[112:127], v[228:231], a[196:199], a[112:127]
    v_cvt_pk_bf16_f32 v80, v96, v97
    v_cvt_pk_bf16_f32 v81, v98, v99
    v_cvt_pk_bf16_f32 v82, v100, v101
    v_cvt_pk_bf16_f32 v83, v102, v103
    s_nop 1
    s_waitcnt vmcnt(9) lgkmcnt(0)
    s_barrier
    s_mov_b32 s36, 3407872
    v_mfma_f32_32x32x16_bf16 a[0:15], v[104:107], a[200:203], a[0:15]
    ds_read_b64_tr_b16 v[168:169], v28 offset:0
    ds_read_b64_tr_b16 v[170:171], v28 offset:2048
    ds_read_b64_tr_b16 v[172:173], v29 offset:0
    v_permlane32_swap_b32 v80, v82
    v_permlane32_swap_b32 v81, v83
    v_mfma_f32_32x32x16_bf16 a[16:31], v[108:111], a[200:203], a[16:31]
    ds_read_b64_tr_b16 v[174:175], v29 offset:2048
    ds_read_b64_tr_b16 v[176:177], v30 offset:0
    ds_read_b64_tr_b16 v[178:179], v30 offset:2048
    v_cvt_pk_bf16_f32 v236, v88, v89
    v_cvt_pk_bf16_f32 v237, v90, v91
    v_mfma_f32_32x32x16_bf16 a[32:47], v[112:115], a[200:203], a[32:47]
    ds_read_b64_tr_b16 v[180:181], v31 offset:0
    ds_read_b64_tr_b16 v[182:183], v31 offset:2048
    ds_read_b64_tr_b16 v[184:185], v28 offset:256
    s_add_u32 m0, s27, 114688
    s_nop 0
    buffer_load_dwordx4 v12, s[12:15], s36 offen lds
    v_cvt_pk_bf16_f32 v238, v92, v93
    v_cvt_pk_bf16_f32 v239, v94, v95
    v_mfma_f32_32x32x16_bf16 a[48:63], v[116:119], a[200:203], a[48:63]
    ds_read_b64_tr_b16 v[186:187], v28 offset:2304
    ds_read_b64_tr_b16 v[188:189], v29 offset:256
    ds_read_b64_tr_b16 v[190:191], v29 offset:2304
    v_lshlrev_b32 v88, 16, v236
    v_and_b32 v89, s38, v236
    v_mfma_f32_32x32x16_bf16 a[64:79], v[120:123], a[200:203], a[64:79]
    ds_read_b64_tr_b16 v[192:193], v30 offset:256
    ds_read_b64_tr_b16 v[194:195], v30 offset:2304
    ds_read_b64_tr_b16 v[196:197], v31 offset:256
    s_add_u32 m0, s27, 115712
    s_nop 0
    buffer_load_dwordx4 v13, s[12:15], s36 offen lds
    v_lshlrev_b32 v90, 16, v237
    v_and_b32 v91, s38, v237
    v_mfma_f32_32x32x16_bf16 a[80:95], v[124:127], a[200:203], a[80:95]
    ds_read_b64_tr_b16 v[198:199], v31 offset:2304
    ds_read_b64_tr_b16 v[200:201], v28 offset:8192
    ds_read_b64_tr_b16 v[202:203], v28 offset:10240
    v_lshlrev_b32 v92, 16, v238
    v_and_b32 v93, s38, v238
    v_mfma_f32_32x32x16_bf16 a[96:111], v[128:131], a[200:203], a[96:111]
    ds_read_b64_tr_b16 v[204:205], v29 offset:8192
    ds_read_b64_tr_b16 v[206:207], v29 offset:10240
    ds_read_b64_tr_b16 v[208:209], v30 offset:8192
    s_add_u32 m0, s27, 116736
    s_nop 0
    buffer_load_dwordx4 v14, s[12:15], s36 offen lds
    v_lshlrev_b32 v94, 16, v239
    v_and_b32 v95, s38, v239
    v_mfma_f32_32x32x16_bf16 a[112:127], v[132:135], a[200:203], a[112:127]
    ds_read_b64_tr_b16 v[210:211], v30 offset:10240
    ds_read_b64_tr_b16 v[212:213], v31 offset:8192
    ds_read_b64_tr_b16 v[214:215], v31 offset:10240
    v_mul_f32 v96, v88, v88
    v_mul_f32 v97, v89, v89
    v_mfma_f32_32x32x16_bf16 a[0:15], v[136:139], a[204:207], a[0:15]
    ds_read_b64_tr_b16 v[216:217], v28 offset:8448
    ds_read_b64_tr_b16 v[218:219], v28 offset:10496
    ds_read_b64_tr_b16 v[220:221], v29 offset:8448
    s_add_u32 m0, s27, 117760
    s_nop 0
    buffer_load_dwordx4 v15, s[12:15], s36 offen lds
    v_mul_f32 v98, v90, v90
    v_mul_f32 v99, v91, v91
    v_mfma_f32_32x32x16_bf16 a[16:31], v[140:143], a[204:207], a[16:31]
    ds_read_b64_tr_b16 v[222:223], v29 offset:10496
    ds_read_b64_tr_b16 v[224:225], v30 offset:8448
    ds_read_b64_tr_b16 v[226:227], v30 offset:10496
    v_mul_f32 v100, v92, v92
    v_mul_f32 v101, v93, v93
    v_mfma_f32_32x32x16_bf16 a[32:47], v[144:147], a[204:207], a[32:47]
    ds_read_b64_tr_b16 v[228:229], v31 offset:8448
    ds_read_b64_tr_b16 v[230:231], v31 offset:10496
    v_mul_f32 v102, v94, v94
    v_mul_f32 v103, v95, v95
    v_mfma_f32_32x32x16_bf16 a[48:63], v[148:151], a[204:207], a[48:63]
    v_fma_f32 v96, v96, s56, v39
    v_fma_f32 v97, v97, s56, v39
    v_fma_f32 v98, v98, s56, v39
    v_fma_f32 v99, v99, s56, v39
    v_fma_f32 v100, v100, s56, v39
    v_mfma_f32_32x32x16_bf16 a[64:79], v[152:155], a[204:207], a[64:79]
    v_fma_f32 v101, v101, s56, v39
    v_fma_f32 v102, v102, s56, v39
    v_fma_f32 v103, v103, s56, v39
    v_mul_f32 v96, v96, v88
    v_mul_f32 v97, v97, v89
    v_mfma_f32_32x32x16_bf16 a[80:95], v[156:159], a[204:207], a[80:95]
    v_mul_f32 v98, v98, v90
    v_mul_f32 v99, v99, v91
    v_mul_f32 v100, v100, v92
    v_mul_f32 v101, v101, v93
    v_mul_f32 v102, v102, v94
    v_mfma_f32_32x32x16_bf16 a[96:111], v[160:163], a[204:207], a[96:111]
    v_mul_f32 v103, v103, v95
    v_exp_f32 v96, v96
    v_exp_f32 v97, v97
    v_exp_f32 v98, v98
    v_exp_f32 v99, v99
    v_mfma_f32_32x32x16_bf16 a[112:127], v[164:167], a[204:207], a[112:127]
    v_exp_f32 v100, v100
    v_exp_f32 v101, v101
    v_exp_f32 v102, v102
    v_exp_f32 v103, v103
    v_add_f32 v96, 1.0, v96
    s_waitcnt vmcnt(8) lgkmcnt(0)
    s_barrier
    s_mov_b32 s29, 0
    v_mfma_f32_32x32x16_bf16 a[0:15], v[168:171], a[208:211], a[0:15]
    ds_read_b64_tr_b16 v[104:105], v28 offset:16384
    ds_read_b64_tr_b16 v[106:107], v28 offset:18432
    ds_read_b64_tr_b16 v[108:109], v29 offset:16384
    v_add_f32 v97, 1.0, v97
    v_add_f32 v98, 1.0, v98
    v_mfma_f32_32x32x16_bf16 a[16:31], v[172:175], a[208:211], a[16:31]
    ds_read_b64_tr_b16 v[110:111], v29 offset:18432
    ds_read_b64_tr_b16 v[112:113], v30 offset:16384
    ds_read_b64_tr_b16 v[114:115], v30 offset:18432
    v_add_f32 v99, 1.0, v99
    v_add_f32 v100, 1.0, v100
    v_mfma_f32_32x32x16_bf16 a[32:47], v[176:179], a[208:211], a[32:47]
    ds_read_b64_tr_b16 v[116:117], v31 offset:16384
    ds_read_b64_tr_b16 v[118:119], v31 offset:18432
    ds_read_b64_tr_b16 v[120:121], v28 offset:16640
    s_add_u32 m0, s27, 65536
    s_nop 0
    buffer_load_dwordx4 v8, s[8:11], s29 offen lds
    v_add_f32 v101, 1.0, v101
    v_add_f32 v102, 1.0, v102
    v_mfma_f32_32x32x16_bf16 a[48:63], v[180:183], a[208:211], a[48:63]
    ds_read_b64_tr_b16 v[122:123], v28 offset:18688
    ds_read_b64_tr_b16 v[124:125], v29 offset:16640
    ds_read_b64_tr_b16 v[126:127], v29 offset:18688
    v_add_f32 v103, 1.0, v103
    v_rcp_f32 v96, v96
    v_mfma_f32_32x32x16_bf16 a[64:79], v[184:187], a[208:211], a[64:79]
    ds_read_b64_tr_b16 v[128:129], v30 offset:16640
    ds_read_b64_tr_b16 v[130:131], v30 offset:18688
    ds_read_b64_tr_b16 v[132:133], v31 offset:16640
    s_add_u32 m0, s27, 66560
    s_nop 0
    buffer_load_dwordx4 v9, s[8:11], s29 offen lds
    v_rcp_f32 v97, v97
    v_rcp_f32 v98, v98
    v_mfma_f32_32x32x16_bf16 a[80:95], v[188:191], a[208:211], a[80:95]
    ds_read_b64_tr_b16 v[134:135], v31 offset:18688
    ds_read_b64_tr_b16 v[136:137], v28 offset:24576
    ds_read_b64_tr_b16 v[138:139], v28 offset:26624
    v_rcp_f32 v99, v99
    v_rcp_f32 v100, v100
    v_mfma_f32_32x32x16_bf16 a[96:111], v[192:195], a[208:211], a[96:111]
    ds_read_b64_tr_b16 v[140:141], v29 offset:24576
    ds_read_b64_tr_b16 v[142:143], v29 offset:26624
    ds_read_b64_tr_b16 v[144:145], v30 offset:24576
    s_add_u32 m0, s27, 67584
    s_nop 0
    buffer_load_dwordx4 v10, s[8:11], s29 offen lds
    v_rcp_f32 v101, v101
    v_rcp_f32 v102, v102
    v_mfma_f32_32x32x16_bf16 a[112:127], v[196:199], a[208:211], a[112:127]
    ds_read_b64_tr_b16 v[146:147], v30 offset:26624
    ds_read_b64_tr_b16 v[148:149], v31 offset:24576
    ds_read_b64_tr_b16 v[150:151], v31 offset:26624
    v_rcp_f32 v103, v103
    v_mul_f32 v96, v88, v96
    v_mfma_f32_32x32x16_bf16 a[0:15], v[200:203], a[212:215], a[0:15]
    ds_read_b64_tr_b16 v[152:153], v28 offset:24832
    ds_read_b64_tr_b16 v[154:155], v28 offset:26880
    ds_read_b64_tr_b16 v[156:157], v29 offset:24832
    s_add_u32 m0, s27, 68608
    s_nop 0
    buffer_load_dwordx4 v11, s[8:11], s29 offen lds
    v_mul_f32 v97, v89, v97
    v_mul_f32 v98, v90, v98
    v_mfma_f32_32x32x16_bf16 a[16:31], v[204:207], a[212:215], a[16:31]
    ds_read_b64_tr_b16 v[158:159], v29 offset:26880
    ds_read_b64_tr_b16 v[160:161], v30 offset:24832
    ds_read_b64_tr_b16 v[162:163], v30 offset:26880
    v_mul_f32 v99, v91, v99
    v_mul_f32 v100, v92, v100
    v_mfma_f32_32x32x16_bf16 a[32:47], v[208:211], a[212:215], a[32:47]
    ds_read_b64_tr_b16 v[164:165], v31 offset:24832
    ds_read_b64_tr_b16 v[166:167], v31 offset:26880
    v_mul_f32 v101, v93, v101
    v_mul_f32 v102, v94, v102
    v_mfma_f32_32x32x16_bf16 a[48:63], v[212:215], a[212:215], a[48:63]
    v_mul_f32 v103, v95, v103
    v_cvt_pk_bf16_f32 v88, v96, v97
    v_cvt_pk_bf16_f32 v89, v98, v99
    v_cvt_pk_bf16_f32 v90, v100, v101
    v_cvt_pk_bf16_f32 v91, v102, v103
    v_mfma_f32_32x32x16_bf16 a[64:79], v[216:219], a[212:215], a[64:79]
    s_nop 1
    v_permlane32_swap_b32 v88, v90
    v_permlane32_swap_b32 v89, v91
    v_cvt_pk_bf16_f32 v232, v240, v241
    v_cvt_pk_bf16_f32 v233, v242, v243
    v_mfma_f32_32x32x16_bf16 a[80:95], v[220:223], a[212:215], a[80:95]
    v_cvt_pk_bf16_f32 v234, v244, v245
    v_cvt_pk_bf16_f32 v235, v246, v247
    v_lshlrev_b32 v240, 16, v232
    v_and_b32 v241, s38, v232
    v_lshlrev_b32 v242, 16, v233
    v_mfma_f32_32x32x16_bf16 a[96:111], v[224:227], a[212:215], a[96:111]
    v_and_b32 v243, s38, v233
    v_lshlrev_b32 v244, 16, v234
    v_and_b32 v245, s38, v234
    v_lshlrev_b32 v246, 16, v235
    v_and_b32 v247, s38, v235
    v_mfma_f32_32x32x16_bf16 a[112:127], v[228:231], a[212:215], a[112:127]
    v_mul_f32 v96, v240, v240
    v_mul_f32 v97, v241, v241
    v_mul_f32 v98, v242, v242
    v_mul_f32 v99, v243, v243
    v_mul_f32 v100, v244, v244
    s_waitcnt vmcnt(8) lgkmcnt(0)
    s_barrier
    s_mov_b32 s29, 16384
    v_mfma_f32_32x32x16_bf16 a[0:15], v[104:107], a[216:219], a[0:15]
    ds_read_b64_tr_b16 v[168:169], v28 offset:32768
    ds_read_b64_tr_b16 v[170:171], v28 offset:34816
    ds_read_b64_tr_b16 v[172:173], v29 offset:32768
    v_mul_f32 v101, v245, v245
    v_mul_f32 v102, v246, v246
    v_mfma_f32_32x32x16_bf16 a[16:31], v[108:111], a[216:219], a[16:31]
    ds_read_b64_tr_b16 v[174:175], v29 offset:34816
    ds_read_b64_tr_b16 v[176:177], v30 offset:32768
    ds_read_b64_tr_b16 v[178:179], v30 offset:34816
    v_mul_f32 v103, v247, v247
    v_fma_f32 v96, v96, s56, v39
    v_mfma_f32_32x32x16_bf16 a[32:47], v[112:115], a[216:219], a[32:47]
    ds_read_b64_tr_b16 v[180:181], v31 offset:32768
    ds_read_b64_tr_b16 v[182:183], v31 offset:34816
    ds_read_b64_tr_b16 v[184:185], v28 offset:33024
    s_add_u32 m0, s27, 81920
    s_nop 0
    buffer_load_dwordx4 v8, s[8:11], s29 offen lds
    v_fma_f32 v97, v97, s56, v39
    v_fma_f32 v98, v98, s56, v39
    v_mfma_f32_32x32x16_bf16 a[48:63], v[116:119], a[216:219], a[48:63]
    ds_read_b64_tr_b16 v[186:187], v28 offset:35072
    ds_read_b64_tr_b16 v[188:189], v29 offset:33024
    ds_read_b64_tr_b16 v[190:191], v29 offset:35072
    v_fma_f32 v99, v99, s56, v39
    v_fma_f32 v100, v100, s56, v39
    v_mfma_f32_32x32x16_bf16 a[64:79], v[120:123], a[216:219], a[64:79]
    ds_read_b64_tr_b16 v[192:193], v30 offset:33024
    ds_read_b64_tr_b16 v[194:195], v30 offset:35072
    ds_read_b64_tr_b16 v[196:197], v31 offset:33024
    s_add_u32 m0, s27, 82944
    s_nop 0
    buffer_load_dwordx4 v9, s[8:11], s29 offen lds
    v_fma_f32 v101, v101, s56, v39
    v_fma_f32 v102, v102, s56, v39
    v_mfma_f32_32x32x16_bf16 a[80:95], v[124:127], a[216:219], a[80:95]
    ds_read_b64_tr_b16 v[198:199], v31 offset:35072
    ds_read_b64_tr_b16 v[200:201], v28 offset:40960
    ds_read_b64_tr_b16 v[202:203], v28 offset:43008
    v_fma_f32 v103, v103, s56, v39
    v_mul_f32 v96, v96, v240
    v_mfma_f32_32x32x16_bf16 a[96:111], v[128:131], a[216:219], a[96:111]
    ds_read_b64_tr_b16 v[204:205], v29 offset:40960
    ds_read_b64_tr_b16 v[206:207], v29 offset:43008
    ds_read_b64_tr_b16 v[208:209], v30 offset:40960
    s_add_u32 m0, s27, 83968
    s_nop 0
    buffer_load_dwordx4 v10, s[8:11], s29 offen lds
    v_mul_f32 v97, v97, v241
    v_mul_f32 v98, v98, v242
    v_mfma_f32_32x32x16_bf16 a[112:127], v[132:135], a[216:219], a[112:127]
    ds_read_b64_tr_b16 v[210:211], v30 offset:43008
    ds_read_b64_tr_b16 v[212:213], v31 offset:40960
    ds_read_b64_tr_b16 v[214:215], v31 offset:43008
    v_mul_f32 v99, v99, v243
    v_mul_f32 v100, v100, v244
    v_mfma_f32_32x32x16_bf16 a[0:15], v[136:139], a[220:223], a[0:15]
    ds_read_b64_tr_b16 v[216:217], v28 offset:41216
    ds_read_b64_tr_b16 v[218:219], v28 offset:43264
    ds_read_b64_tr_b16 v[220:221], v29 offset:41216
    s_add_u32 m0, s27, 84992
    s_nop 0
    buffer_load_dwordx4 v11, s[8:11], s29 offen lds
    v_mul_f32 v101, v101, v245
    v_mul_f32 v102, v102, v246
    v_mfma_f32_32x32x16_bf16 a[16:31], v[140:143], a[220:223], a[16:31]
    ds_read_b64_tr_b16 v[222:223], v29 offset:43264
    ds_read_b64_tr_b16 v[224:225], v30 offset:41216
    ds_read_b64_tr_b16 v[226:227], v30 offset:43264
    v_mul_f32 v103, v103, v247
    v_exp_f32 v96, v96
    v_mfma_f32_32x32x16_bf16 a[32:47], v[144:147], a[220:223], a[32:47]
    ds_read_b64_tr_b16 v[228:229], v31 offset:41216
    ds_read_b64_tr_b16 v[230:231], v31 offset:43264
    v_exp_f32 v97, v97
    v_exp_f32 v98, v98
    v_mfma_f32_32x32x16_bf16 a[48:63], v[148:151], a[220:223], a[48:63]
    v_exp_f32 v99, v99
    v_exp_f32 v100, v100
    v_exp_f32 v101, v101
    v_exp_f32 v102, v102
    v_exp_f32 v103, v103
    v_mfma_f32_32x32x16_bf16 a[64:79], v[152:155], a[220:223], a[64:79]
    v_add_f32 v96, 1.0, v96
    v_add_f32 v97, 1.0, v97
    v_add_f32 v98, 1.0, v98
    v_add_f32 v99, 1.0, v99
    v_add_f32 v100, 1.0, v100
    v_mfma_f32_32x32x16_bf16 a[80:95], v[156:159], a[220:223], a[80:95]
    v_add_f32 v101, 1.0, v101
    v_add_f32 v102, 1.0, v102
    v_add_f32 v103, 1.0, v103
    v_rcp_f32 v96, v96
    v_rcp_f32 v97, v97
    v_mfma_f32_32x32x16_bf16 a[96:111], v[160:163], a[220:223], a[96:111]
    v_rcp_f32 v98, v98
    v_rcp_f32 v99, v99
    v_rcp_f32 v100, v100
    v_rcp_f32 v101, v101
    v_rcp_f32 v102, v102
    v_mfma_f32_32x32x16_bf16 a[112:127], v[164:167], a[220:223], a[112:127]
    v_rcp_f32 v103, v103
    v_mul_f32 v96, v240, v96
    v_mul_f32 v97, v241, v97
    v_mul_f32 v98, v242, v98
    v_mul_f32 v99, v243, v99
    s_waitcnt vmcnt(8) lgkmcnt(0)
    s_barrier
    s_mov_b32 s29, 32768
    v_mfma_f32_32x32x16_bf16 a[0:15], v[168:171], a[224:227], a[0:15]
    ds_read_b64_tr_b16 v[104:105], v28 offset:49152
    ds_read_b64_tr_b16 v[106:107], v28 offset:51200
    ds_read_b64_tr_b16 v[108:109], v29 offset:49152
    v_mul_f32 v100, v244, v100
    v_mul_f32 v101, v245, v101
    v_mfma_f32_32x32x16_bf16 a[16:31], v[172:175], a[224:227], a[16:31]
    ds_read_b64_tr_b16 v[110:111], v29 offset:51200
    ds_read_b64_tr_b16 v[112:113], v30 offset:49152
    ds_read_b64_tr_b16 v[114:115], v30 offset:51200
    v_mul_f32 v102, v246, v102
    v_mul_f32 v103, v247, v103
    v_mfma_f32_32x32x16_bf16 a[32:47], v[176:179], a[224:227], a[32:47]
    ds_read_b64_tr_b16 v[116:117], v31 offset:49152
    ds_read_b64_tr_b16 v[118:119], v31 offset:51200
    ds_read_b64_tr_b16 v[120:121], v28 offset:49408
    s_add_u32 m0, s27, 98304
    s_nop 0
    buffer_load_dwordx4 v8, s[8:11], s29 offen lds
    v_cvt_pk_bf16_f32 v240, v96, v97
    v_cvt_pk_bf16_f32 v241, v98, v99
    v_mfma_f32_32x32x16_bf16 a[48:63], v[180:183], a[224:227], a[48:63]
    ds_read_b64_tr_b16 v[122:123], v28 offset:51456
    ds_read_b64_tr_b16 v[124:125], v29 offset:49408
    ds_read_b64_tr_b16 v[126:127], v29 offset:51456
    v_cvt_pk_bf16_f32 v242, v100, v101
    v_cvt_pk_bf16_f32 v243, v102, v103
    v_mfma_f32_32x32x16_bf16 a[64:79], v[184:187], a[224:227], a[64:79]
    ds_read_b64_tr_b16 v[128:129], v30 offset:49408
    ds_read_b64_tr_b16 v[130:131], v30 offset:51456
    ds_read_b64_tr_b16 v[132:133], v31 offset:49408
    s_add_u32 m0, s27, 99328
    s_nop 0
    buffer_load_dwordx4 v9, s[8:11], s29 offen lds
    s_nop 1
    v_permlane32_swap_b32 v240, v242
    v_mfma_f32_32x32x16_bf16 a[80:95], v[188:191], a[224:227], a[80:95]
    ds_read_b64_tr_b16 v[134:135], v31 offset:51456
    ds_read_b64_tr_b16 v[136:137], v28 offset:57344
    ds_read_b64_tr_b16 v[138:139], v28 offset:59392
    v_permlane32_swap_b32 v241, v243
    v_mfma_f32_32x32x16_bf16 a[96:111], v[192:195], a[224:227], a[96:111]
    ds_read_b64_tr_b16 v[140:141], v29 offset:57344
    ds_read_b64_tr_b16 v[142:143], v29 offset:59392
    ds_read_b64_tr_b16 v[144:145], v30 offset:57344
    s_add_u32 m0, s27, 100352
    s_nop 0
    buffer_load_dwordx4 v10, s[8:11], s29 offen lds
    v_mfma_f32_32x32x16_bf16 a[112:127], v[196:199], a[224:227], a[112:127]
    ds_read_b64_tr_b16 v[146:147], v30 offset:59392
    ds_read_b64_tr_b16 v[148:149], v31 offset:57344
    ds_read_b64_tr_b16 v[150:151], v31 offset:59392
    v_mfma_f32_32x32x16_bf16 a[0:15], v[200:203], a[228:231], a[0:15]
    ds_read_b64_tr_b16 v[152:153], v28 offset:57600
    ds_read_b64_tr_b16 v[154:155], v28 offset:59648
    ds_read_b64_tr_b16 v[156:157], v29 offset:57600
    s_add_u32 m0, s27, 101376
    s_nop 0
    buffer_load_dwordx4 v11, s[8:11], s29 offen lds
    v_mfma_f32_32x32x16_bf16 a[16:31], v[204:207], a[228:231], a[16:31]
    ds_read_b64_tr_b16 v[158:159], v29 offset:59648
    ds_read_b64_tr_b16 v[160:161], v30 offset:57600
    ds_read_b64_tr_b16 v[162:163], v30 offset:59648
    v_mfma_f32_32x32x16_bf16 a[32:47], v[208:211], a[228:231], a[32:47]
    ds_read_b64_tr_b16 v[164:165], v31 offset:57600
    ds_read_b64_tr_b16 v[166:167], v31 offset:59648
    v_mfma_f32_32x32x16_bf16 a[48:63], v[212:215], a[228:231], a[48:63]
    v_mfma_f32_32x32x16_bf16 a[64:79], v[216:219], a[228:231], a[64:79]
    v_mfma_f32_32x32x16_bf16 a[80:95], v[220:223], a[228:231], a[80:95]
    v_mfma_f32_32x32x16_bf16 a[96:111], v[224:227], a[228:231], a[96:111]
    v_mfma_f32_32x32x16_bf16 a[112:127], v[228:231], a[228:231], a[112:127]
    s_waitcnt vmcnt(63) lgkmcnt(0)
    s_barrier
    v_mfma_f32_32x32x16_bf16 a[0:15], v[104:107], a[232:235], a[0:15]
    v_mfma_f32_32x32x16_bf16 a[16:31], v[108:111], a[232:235], a[16:31]
    v_mfma_f32_32x32x16_bf16 a[32:47], v[112:115], a[232:235], a[32:47]
    v_mfma_f32_32x32x16_bf16 a[48:63], v[116:119], a[232:235], a[48:63]
    v_mfma_f32_32x32x16_bf16 a[64:79], v[120:123], a[232:235], a[64:79]
    v_mfma_f32_32x32x16_bf16 a[80:95], v[124:127], a[232:235], a[80:95]
    v_mfma_f32_32x32x16_bf16 a[96:111], v[128:131], a[232:235], a[96:111]
    v_mfma_f32_32x32x16_bf16 a[112:127], v[132:135], a[232:235], a[112:127]
    v_mfma_f32_32x32x16_bf16 a[0:15], v[136:139], a[236:239], a[0:15]
    v_mfma_f32_32x32x16_bf16 a[16:31], v[140:143], a[236:239], a[16:31]
    v_mfma_f32_32x32x16_bf16 a[32:47], v[144:147], a[236:239], a[32:47]
    v_mfma_f32_32x32x16_bf16 a[48:63], v[148:151], a[236:239], a[48:63]
    v_mfma_f32_32x32x16_bf16 a[64:79], v[152:155], a[236:239], a[64:79]
    v_mfma_f32_32x32x16_bf16 a[80:95], v[156:159], a[236:239], a[80:95]
    v_mfma_f32_32x32x16_bf16 a[96:111], v[160:163], a[236:239], a[96:111]
    v_mfma_f32_32x32x16_bf16 a[112:127], v[164:167], a[236:239], a[112:127]
    buffer_store_dwordx4 v[48:51], v33, s[52:55], 0 offen offset:0 sc0 sc1
    buffer_store_dwordx4 v[56:59], v33, s[52:55], 0 offen offset:32 sc0 sc1
    buffer_store_dwordx4 v[64:67], v33, s[52:55], 0 offen offset:64 sc0 sc1
    buffer_store_dwordx4 v[72:75], v33, s[52:55], 0 offen offset:96 sc0 sc1
    buffer_store_dwordx4 v[80:83], v33, s[52:55], 0 offen offset:128 sc0 sc1
    buffer_store_dwordx4 v[88:91], v33, s[52:55], 0 offen offset:160 sc0 sc1
    buffer_store_dwordx4 v[240:243], v33, s[52:55], 0 offen offset:192 sc0 sc1
    s_nop 15
    s_nop 7
    v_accvgpr_read_b32 v104, a0
    v_accvgpr_read_b32 v105, a1
    v_accvgpr_read_b32 v106, a2
    v_accvgpr_read_b32 v107, a3
    v_accvgpr_read_b32 v108, a4
    v_accvgpr_read_b32 v109, a5
    v_accvgpr_read_b32 v110, a6
    v_accvgpr_read_b32 v111, a7
    v_accvgpr_read_b32 v112, a8
    v_accvgpr_read_b32 v113, a9
    v_accvgpr_read_b32 v114, a10
    v_accvgpr_read_b32 v115, a11
    v_accvgpr_read_b32 v116, a12
    v_accvgpr_read_b32 v117, a13
    v_accvgpr_read_b32 v118, a14
    v_accvgpr_read_b32 v119, a15
    v_mul_f32 v104, s31, v104
    v_mul_f32 v105, s31, v105
    v_mul_f32 v106, s31, v106
    v_mul_f32 v107, s31, v107
    v_mul_f32 v108, s31, v108
    v_mul_f32 v109, s31, v109
    v_mul_f32 v110, s31, v110
    v_mul_f32 v111, s31, v111
    v_mul_f32 v112, s31, v112
    v_mul_f32 v113, s31, v113
    v_mul_f32 v114, s31, v114
    v_mul_f32 v115, s31, v115
    v_mul_f32 v116, s31, v116
    v_mul_f32 v117, s31, v117
    v_mul_f32 v118, s31, v118
    v_mul_f32 v119, s31, v119
    v_cvt_pk_bf16_f32 v120, v104, v105
    v_cvt_pk_bf16_f32 v121, v106, v107
    v_cvt_pk_bf16_f32 v122, v108, v109
    v_cvt_pk_bf16_f32 v123, v110, v111
    v_cvt_pk_bf16_f32 v124, v112, v113
    v_cvt_pk_bf16_f32 v125, v114, v115
    v_cvt_pk_bf16_f32 v126, v116, v117
    v_cvt_pk_bf16_f32 v127, v118, v119
    v_accvgpr_write_b32 a128, v120
    v_accvgpr_write_b32 a129, v121
    v_accvgpr_write_b32 a130, v122
    v_accvgpr_write_b32 a131, v123
    v_accvgpr_write_b32 a132, v124
    v_accvgpr_write_b32 a133, v125
    v_accvgpr_write_b32 a134, v126
    v_accvgpr_write_b32 a135, v127
    v_accvgpr_write_b32 a0, 0
    v_accvgpr_write_b32 a1, 0
    v_accvgpr_write_b32 a2, 0
    v_accvgpr_write_b32 a3, 0
    v_accvgpr_write_b32 a4, 0
    v_accvgpr_write_b32 a5, 0
    v_accvgpr_write_b32 a6, 0
    v_accvgpr_write_b32 a7, 0
    v_accvgpr_write_b32 a8, 0
    v_accvgpr_write_b32 a9, 0
    v_accvgpr_write_b32 a10, 0
    v_accvgpr_write_b32 a11, 0
    v_accvgpr_write_b32 a12, 0
    v_accvgpr_write_b32 a13, 0
    v_accvgpr_write_b32 a14, 0
    v_accvgpr_write_b32 a15, 0
    v_accvgpr_read_b32 v104, a16
    v_accvgpr_read_b32 v105, a17
    v_accvgpr_read_b32 v106, a18
    v_accvgpr_read_b32 v107, a19
    v_accvgpr_read_b32 v108, a20
    v_accvgpr_read_b32 v109, a21
    v_accvgpr_read_b32 v110, a22
    v_accvgpr_read_b32 v111, a23
    v_accvgpr_read_b32 v112, a24
    v_accvgpr_read_b32 v113, a25
    v_accvgpr_read_b32 v114, a26
    v_accvgpr_read_b32 v115, a27
    v_accvgpr_read_b32 v116, a28
    v_accvgpr_read_b32 v117, a29
    v_accvgpr_read_b32 v118, a30
    v_accvgpr_read_b32 v119, a31
    v_mul_f32 v104, s31, v104
    v_mul_f32 v105, s31, v105
    v_mul_f32 v106, s31, v106
    v_mul_f32 v107, s31, v107
    v_mul_f32 v108, s31, v108
    v_mul_f32 v109, s31, v109
    v_mul_f32 v110, s31, v110
    v_mul_f32 v111, s31, v111
    v_mul_f32 v112, s31, v112
    v_mul_f32 v113, s31, v113
    v_mul_f32 v114, s31, v114
    v_mul_f32 v115, s31, v115
    v_mul_f32 v116, s31, v116
    v_mul_f32 v117, s31, v117
    v_mul_f32 v118, s31, v118
    v_mul_f32 v119, s31, v119
    v_cvt_pk_bf16_f32 v120, v104, v105
    v_cvt_pk_bf16_f32 v121, v106, v107
    v_cvt_pk_bf16_f32 v122, v108, v109
    v_cvt_pk_bf16_f32 v123, v110, v111
    v_cvt_pk_bf16_f32 v124, v112, v113
    v_cvt_pk_bf16_f32 v125, v114, v115
    v_cvt_pk_bf16_f32 v126, v116, v117
    v_cvt_pk_bf16_f32 v127, v118, v119
    v_accvgpr_write_b32 a136, v120
    v_accvgpr_write_b32 a137, v121
    v_accvgpr_write_b32 a138, v122
    v_accvgpr_write_b32 a139, v123
    v_accvgpr_write_b32 a140, v124
    v_accvgpr_write_b32 a141, v125
    v_accvgpr_write_b32 a142, v126
    v_accvgpr_write_b32 a143, v127
    v_accvgpr_write_b32 a16, 0
    v_accvgpr_write_b32 a17, 0
    v_accvgpr_write_b32 a18, 0
    v_accvgpr_write_b32 a19, 0
    v_accvgpr_write_b32 a20, 0
    v_accvgpr_write_b32 a21, 0
    v_accvgpr_write_b32 a22, 0
    v_accvgpr_write_b32 a23, 0
    v_accvgpr_write_b32 a24, 0
    v_accvgpr_write_b32 a25, 0
    v_accvgpr_write_b32 a26, 0
    v_accvgpr_write_b32 a27, 0
    v_accvgpr_write_b32 a28, 0
    v_accvgpr_write_b32 a29, 0
    v_accvgpr_write_b32 a30, 0
    v_accvgpr_write_b32 a31, 0
    v_accvgpr_read_b32 v104, a32
    v_accvgpr_read_b32 v105, a33
    v_accvgpr_read_b32 v106, a34
    v_accvgpr_read_b32 v107, a35
    v_accvgpr_read_b32 v108, a36
    v_accvgpr_read_b32 v109, a37
    v_accvgpr_read_b32 v110, a38
    v_accvgpr_read_b32 v111, a39
    v_accvgpr_read_b32 v112, a40
    v_accvgpr_read_b32 v113, a41
    v_accvgpr_read_b32 v114, a42
    v_accvgpr_read_b32 v115, a43
    v_accvgpr_read_b32 v116, a44
    v_accvgpr_read_b32 v117, a45
    v_accvgpr_read_b32 v118, a46
    v_accvgpr_read_b32 v119, a47
    v_mul_f32 v104, s31, v104
    v_mul_f32 v105, s31, v105
    v_mul_f32 v106, s31, v106
    v_mul_f32 v107, s31, v107
    v_mul_f32 v108, s31, v108
    v_mul_f32 v109, s31, v109
    v_mul_f32 v110, s31, v110
    v_mul_f32 v111, s31, v111
    v_mul_f32 v112, s31, v112
    v_mul_f32 v113, s31, v113
    v_mul_f32 v114, s31, v114
    v_mul_f32 v115, s31, v115
    v_mul_f32 v116, s31, v116
    v_mul_f32 v117, s31, v117
    v_mul_f32 v118, s31, v118
    v_mul_f32 v119, s31, v119
    v_cvt_pk_bf16_f32 v120, v104, v105
    v_cvt_pk_bf16_f32 v121, v106, v107
    v_cvt_pk_bf16_f32 v122, v108, v109
    v_cvt_pk_bf16_f32 v123, v110, v111
    v_cvt_pk_bf16_f32 v124, v112, v113
    v_cvt_pk_bf16_f32 v125, v114, v115
    v_cvt_pk_bf16_f32 v126, v116, v117
    v_cvt_pk_bf16_f32 v127, v118, v119
    v_accvgpr_write_b32 a144, v120
    v_accvgpr_write_b32 a145, v121
    v_accvgpr_write_b32 a146, v122
    v_accvgpr_write_b32 a147, v123
    v_accvgpr_write_b32 a148, v124
    v_accvgpr_write_b32 a149, v125
    v_accvgpr_write_b32 a150, v126
    v_accvgpr_write_b32 a151, v127
    v_accvgpr_write_b32 a32, 0
    v_accvgpr_write_b32 a33, 0
    v_accvgpr_write_b32 a34, 0
    v_accvgpr_write_b32 a35, 0
    v_accvgpr_write_b32 a36, 0
    v_accvgpr_write_b32 a37, 0
    v_accvgpr_write_b32 a38, 0
    v_accvgpr_write_b32 a39, 0
    v_accvgpr_write_b32 a40, 0
    v_accvgpr_write_b32 a41, 0
    v_accvgpr_write_b32 a42, 0
    v_accvgpr_write_b32 a43, 0
    v_accvgpr_write_b32 a44, 0
    v_accvgpr_write_b32 a45, 0
    v_accvgpr_write_b32 a46, 0
    v_accvgpr_write_b32 a47, 0
    v_accvgpr_read_b32 v104, a48
    v_accvgpr_read_b32 v105, a49
    v_accvgpr_read_b32 v106, a50
    v_accvgpr_read_b32 v107, a51
    v_accvgpr_read_b32 v108, a52
    v_accvgpr_read_b32 v109, a53
    v_accvgpr_read_b32 v110, a54
    v_accvgpr_read_b32 v111, a55
    v_accvgpr_read_b32 v112, a56
    v_accvgpr_read_b32 v113, a57
    v_accvgpr_read_b32 v114, a58
    v_accvgpr_read_b32 v115, a59
    v_accvgpr_read_b32 v116, a60
    v_accvgpr_read_b32 v117, a61
    v_accvgpr_read_b32 v118, a62
    v_accvgpr_read_b32 v119, a63
    v_mul_f32 v104, s31, v104
    v_mul_f32 v105, s31, v105
    v_mul_f32 v106, s31, v106
    v_mul_f32 v107, s31, v107
    v_mul_f32 v108, s31, v108
    v_mul_f32 v109, s31, v109
    v_mul_f32 v110, s31, v110
    v_mul_f32 v111, s31, v111
    v_mul_f32 v112, s31, v112
    v_mul_f32 v113, s31, v113
    v_mul_f32 v114, s31, v114
    v_mul_f32 v115, s31, v115
    v_mul_f32 v116, s31, v116
    v_mul_f32 v117, s31, v117
    v_mul_f32 v118, s31, v118
    v_mul_f32 v119, s31, v119
    v_cvt_pk_bf16_f32 v120, v104, v105
    v_cvt_pk_bf16_f32 v121, v106, v107
    v_cvt_pk_bf16_f32 v122, v108, v109
    v_cvt_pk_bf16_f32 v123, v110, v111
    v_cvt_pk_bf16_f32 v124, v112, v113
    v_cvt_pk_bf16_f32 v125, v114, v115
    v_cvt_pk_bf16_f32 v126, v116, v117
    v_cvt_pk_bf16_f32 v127, v118, v119
    v_accvgpr_write_b32 a152, v120
    v_accvgpr_write_b32 a153, v121
    v_accvgpr_write_b32 a154, v122
    v_accvgpr_write_b32 a155, v123
    v_accvgpr_write_b32 a156, v124
    v_accvgpr_write_b32 a157, v125
    v_accvgpr_write_b32 a158, v126
    v_accvgpr_write_b32 a159, v127
    v_accvgpr_write_b32 a48, 0
    v_accvgpr_write_b32 a49, 0
    v_accvgpr_write_b32 a50, 0
    v_accvgpr_write_b32 a51, 0
    v_accvgpr_write_b32 a52, 0
    v_accvgpr_write_b32 a53, 0
    v_accvgpr_write_b32 a54, 0
    v_accvgpr_write_b32 a55, 0
    v_accvgpr_write_b32 a56, 0
    v_accvgpr_write_b32 a57, 0
    v_accvgpr_write_b32 a58, 0
    v_accvgpr_write_b32 a59, 0
    v_accvgpr_write_b32 a60, 0
    v_accvgpr_write_b32 a61, 0
    v_accvgpr_write_b32 a62, 0
    v_accvgpr_write_b32 a63, 0
    v_accvgpr_read_b32 v104, a64
    v_accvgpr_read_b32 v105, a65
    v_accvgpr_read_b32 v106, a66
    v_accvgpr_read_b32 v107, a67
    v_accvgpr_read_b32 v108, a68
    v_accvgpr_read_b32 v109, a69
    v_accvgpr_read_b32 v110, a70
    v_accvgpr_read_b32 v111, a71
    v_accvgpr_read_b32 v112, a72
    v_accvgpr_read_b32 v113, a73
    v_accvgpr_read_b32 v114, a74
    v_accvgpr_read_b32 v115, a75
    v_accvgpr_read_b32 v116, a76
    v_accvgpr_read_b32 v117, a77
    v_accvgpr_read_b32 v118, a78
    v_accvgpr_read_b32 v119, a79
    v_mul_f32 v104, s31, v104
    v_mul_f32 v105, s31, v105
    v_mul_f32 v106, s31, v106
    v_mul_f32 v107, s31, v107
    v_mul_f32 v108, s31, v108
    v_mul_f32 v109, s31, v109
    v_mul_f32 v110, s31, v110
    v_mul_f32 v111, s31, v111
    v_mul_f32 v112, s31, v112
    v_mul_f32 v113, s31, v113
    v_mul_f32 v114, s31, v114
    v_mul_f32 v115, s31, v115
    v_mul_f32 v116, s31, v116
    v_mul_f32 v117, s31, v117
    v_mul_f32 v118, s31, v118
    v_mul_f32 v119, s31, v119
    v_cvt_pk_bf16_f32 v120, v104, v105
    v_cvt_pk_bf16_f32 v121, v106, v107
    v_cvt_pk_bf16_f32 v122, v108, v109
    v_cvt_pk_bf16_f32 v123, v110, v111
    v_cvt_pk_bf16_f32 v124, v112, v113
    v_cvt_pk_bf16_f32 v125, v114, v115
    v_cvt_pk_bf16_f32 v126, v116, v117
    v_cvt_pk_bf16_f32 v127, v118, v119
    v_accvgpr_write_b32 a160, v120
    v_accvgpr_write_b32 a161, v121
    v_accvgpr_write_b32 a162, v122
    v_accvgpr_write_b32 a163, v123
    v_accvgpr_write_b32 a164, v124
    v_accvgpr_write_b32 a165, v125
    v_accvgpr_write_b32 a166, v126
    v_accvgpr_write_b32 a167, v127
    v_accvgpr_write_b32 a64, 0
    v_accvgpr_write_b32 a65, 0
    v_accvgpr_write_b32 a66, 0
    v_accvgpr_write_b32 a67, 0
    v_accvgpr_write_b32 a68, 0
    v_accvgpr_write_b32 a69, 0
    v_accvgpr_write_b32 a70, 0
    v_accvgpr_write_b32 a71, 0
    v_accvgpr_write_b32 a72, 0
    v_accvgpr_write_b32 a73, 0
    v_accvgpr_write_b32 a74, 0
    v_accvgpr_write_b32 a75, 0
    v_accvgpr_write_b32 a76, 0
    v_accvgpr_write_b32 a77, 0
    v_accvgpr_write_b32 a78, 0
    v_accvgpr_write_b32 a79, 0
    v_accvgpr_read_b32 v104, a80
    v_accvgpr_read_b32 v105, a81
    v_accvgpr_read_b32 v106, a82
    v_accvgpr_read_b32 v107, a83
    v_accvgpr_read_b32 v108, a84
    v_accvgpr_read_b32 v109, a85
    v_accvgpr_read_b32 v110, a86
    v_accvgpr_read_b32 v111, a87
    v_accvgpr_read_b32 v112, a88
    v_accvgpr_read_b32 v113, a89
    v_accvgpr_read_b32 v114, a90
    v_accvgpr_read_b32 v115, a91
    v_accvgpr_read_b32 v116, a92
    v_accvgpr_read_b32 v117, a93
    v_accvgpr_read_b32 v118, a94
    v_accvgpr_read_b32 v119, a95
    v_mul_f32 v104, s31, v104
    v_mul_f32 v105, s31, v105
    v_mul_f32 v106, s31, v106
    v_mul_f32 v107, s31, v107
    v_mul_f32 v108, s31, v108
    v_mul_f32 v109, s31, v109
    v_mul_f32 v110, s31, v110
    v_mul_f32 v111, s31, v111
    v_mul_f32 v112, s31, v112
    v_mul_f32 v113, s31, v113
    v_mul_f32 v114, s31, v114
    v_mul_f32 v115, s31, v115
    v_mul_f32 v116, s31, v116
    v_mul_f32 v117, s31, v117
    v_mul_f32 v118, s31, v118
    v_mul_f32 v119, s31, v119
    v_cvt_pk_bf16_f32 v120, v104, v105
    v_cvt_pk_bf16_f32 v121, v106, v107
    v_cvt_pk_bf16_f32 v122, v108, v109
    v_cvt_pk_bf16_f32 v123, v110, v111
    v_cvt_pk_bf16_f32 v124, v112, v113
    v_cvt_pk_bf16_f32 v125, v114, v115
    v_cvt_pk_bf16_f32 v126, v116, v117
    v_cvt_pk_bf16_f32 v127, v118, v119
    v_accvgpr_write_b32 a168, v120
    v_accvgpr_write_b32 a169, v121
    v_accvgpr_write_b32 a170, v122
    v_accvgpr_write_b32 a171, v123
    v_accvgpr_write_b32 a172, v124
    v_accvgpr_write_b32 a173, v125
    v_accvgpr_write_b32 a174, v126
    v_accvgpr_write_b32 a175, v127
    v_accvgpr_write_b32 a80, 0
    v_accvgpr_write_b32 a81, 0
    v_accvgpr_write_b32 a82, 0
    v_accvgpr_write_b32 a83, 0
    v_accvgpr_write_b32 a84, 0
    v_accvgpr_write_b32 a85, 0
    v_accvgpr_write_b32 a86, 0
    v_accvgpr_write_b32 a87, 0
    v_accvgpr_write_b32 a88, 0
    v_accvgpr_write_b32 a89, 0
    v_accvgpr_write_b32 a90, 0
    v_accvgpr_write_b32 a91, 0
    v_accvgpr_write_b32 a92, 0
    v_accvgpr_write_b32 a93, 0
    v_accvgpr_write_b32 a94, 0
    v_accvgpr_write_b32 a95, 0
    v_accvgpr_read_b32 v104, a96
    v_accvgpr_read_b32 v105, a97
    v_accvgpr_read_b32 v106, a98
    v_accvgpr_read_b32 v107, a99
    v_accvgpr_read_b32 v108, a100
    v_accvgpr_read_b32 v109, a101
    v_accvgpr_read_b32 v110, a102
    v_accvgpr_read_b32 v111, a103
    v_accvgpr_read_b32 v112, a104
    v_accvgpr_read_b32 v113, a105
    v_accvgpr_read_b32 v114, a106
    v_accvgpr_read_b32 v115, a107
    v_accvgpr_read_b32 v116, a108
    v_accvgpr_read_b32 v117, a109
    v_accvgpr_read_b32 v118, a110
    v_accvgpr_read_b32 v119, a111
    v_mul_f32 v104, s31, v104
    v_mul_f32 v105, s31, v105
    v_mul_f32 v106, s31, v106
    v_mul_f32 v107, s31, v107
    v_mul_f32 v108, s31, v108
    v_mul_f32 v109, s31, v109
    v_mul_f32 v110, s31, v110
    v_mul_f32 v111, s31, v111
    v_mul_f32 v112, s31, v112
    v_mul_f32 v113, s31, v113
    v_mul_f32 v114, s31, v114
    v_mul_f32 v115, s31, v115
    v_mul_f32 v116, s31, v116
    v_mul_f32 v117, s31, v117
    v_mul_f32 v118, s31, v118
    v_mul_f32 v119, s31, v119
    v_cvt_pk_bf16_f32 v120, v104, v105
    v_cvt_pk_bf16_f32 v121, v106, v107
    v_cvt_pk_bf16_f32 v122, v108, v109
    v_cvt_pk_bf16_f32 v123, v110, v111
    v_cvt_pk_bf16_f32 v124, v112, v113
    v_cvt_pk_bf16_f32 v125, v114, v115
    v_cvt_pk_bf16_f32 v126, v116, v117
    v_cvt_pk_bf16_f32 v127, v118, v119
    v_accvgpr_write_b32 a176, v120
    v_accvgpr_write_b32 a177, v121
    v_accvgpr_write_b32 a178, v122
    v_accvgpr_write_b32 a179, v123
    v_accvgpr_write_b32 a180, v124
    v_accvgpr_write_b32 a181, v125
    v_accvgpr_write_b32 a182, v126
    v_accvgpr_write_b32 a183, v127
    v_accvgpr_write_b32 a96, 0
    v_accvgpr_write_b32 a97, 0
    v_accvgpr_write_b32 a98, 0
    v_accvgpr_write_b32 a99, 0
    v_accvgpr_write_b32 a100, 0
    v_accvgpr_write_b32 a101, 0
    v_accvgpr_write_b32 a102, 0
    v_accvgpr_write_b32 a103, 0
    v_accvgpr_write_b32 a104, 0
    v_accvgpr_write_b32 a105, 0
    v_accvgpr_write_b32 a106, 0
    v_accvgpr_write_b32 a107, 0
    v_accvgpr_write_b32 a108, 0
    v_accvgpr_write_b32 a109, 0
    v_accvgpr_write_b32 a110, 0
    v_accvgpr_write_b32 a111, 0
    v_accvgpr_read_b32 v104, a112
    v_accvgpr_read_b32 v105, a113
    v_accvgpr_read_b32 v106, a114
    v_accvgpr_read_b32 v107, a115
    v_accvgpr_read_b32 v108, a116
    v_accvgpr_read_b32 v109, a117
    v_accvgpr_read_b32 v110, a118
    v_accvgpr_read_b32 v111, a119
    v_accvgpr_read_b32 v112, a120
    v_accvgpr_read_b32 v113, a121
    v_accvgpr_read_b32 v114, a122
    v_accvgpr_read_b32 v115, a123
    v_accvgpr_read_b32 v116, a124
    v_accvgpr_read_b32 v117, a125
    v_accvgpr_read_b32 v118, a126
    v_accvgpr_read_b32 v119, a127
    v_mul_f32 v104, s31, v104
    v_mul_f32 v105, s31, v105
    v_mul_f32 v106, s31, v106
    v_mul_f32 v107, s31, v107
    v_mul_f32 v108, s31, v108
    v_mul_f32 v109, s31, v109
    v_mul_f32 v110, s31, v110
    v_mul_f32 v111, s31, v111
    v_mul_f32 v112, s31, v112
    v_mul_f32 v113, s31, v113
    v_mul_f32 v114, s31, v114
    v_mul_f32 v115, s31, v115
    v_mul_f32 v116, s31, v116
    v_mul_f32 v117, s31, v117
    v_mul_f32 v118, s31, v118
    v_mul_f32 v119, s31, v119
    v_cvt_pk_bf16_f32 v120, v104, v105
    v_cvt_pk_bf16_f32 v121, v106, v107
    v_cvt_pk_bf16_f32 v122, v108, v109
    v_cvt_pk_bf16_f32 v123, v110, v111
    v_cvt_pk_bf16_f32 v124, v112, v113
    v_cvt_pk_bf16_f32 v125, v114, v115
    v_cvt_pk_bf16_f32 v126, v116, v117
    v_cvt_pk_bf16_f32 v127, v118, v119
    v_accvgpr_write_b32 a184, v120
    v_accvgpr_write_b32 a185, v121
    v_accvgpr_write_b32 a186, v122
    v_accvgpr_write_b32 a187, v123
    v_accvgpr_write_b32 a188, v124
    v_accvgpr_write_b32 a189, v125
    v_accvgpr_write_b32 a190, v126
    v_accvgpr_write_b32 a191, v127
    v_accvgpr_write_b32 a112, 0
    v_accvgpr_write_b32 a113, 0
    v_accvgpr_write_b32 a114, 0
    v_accvgpr_write_b32 a115, 0
    v_accvgpr_write_b32 a116, 0
    v_accvgpr_write_b32 a117, 0
    v_accvgpr_write_b32 a118, 0
    v_accvgpr_write_b32 a119, 0
    v_accvgpr_write_b32 a120, 0
    v_accvgpr_write_b32 a121, 0
    v_accvgpr_write_b32 a122, 0
    v_accvgpr_write_b32 a123, 0
    v_accvgpr_write_b32 a124, 0
    v_accvgpr_write_b32 a125, 0
    v_accvgpr_write_b32 a126, 0
    v_accvgpr_write_b32 a127, 0
    s_waitcnt vmcnt(31)
    s_barrier
    ds_read_b128 v[104:107], v16 offset:0
    ds_read_b128 v[108:111], v17 offset:0
    ds_read_b128 v[112:115], v18 offset:0
    ds_read_b128 v[116:119], v19 offset:0
    ds_read_b128 v[120:123], v20 offset:0
    ds_read_b128 v[124:127], v21 offset:0
    ds_read_b128 v[128:131], v22 offset:0
    ds_read_b128 v[132:135], v23 offset:0
    ds_read_b128 v[136:139], v16 offset:256
    ds_read_b128 v[140:143], v17 offset:256
    ds_read_b128 v[144:147], v18 offset:256
    ds_read_b128 v[148:151], v19 offset:256
    ds_read_b128 v[152:155], v20 offset:256
    ds_read_b128 v[156:159], v21 offset:256
    ds_read_b128 v[160:163], v22 offset:256
    ds_read_b128 v[164:167], v23 offset:256
    s_waitcnt lgkmcnt(15)
    v_mfma_f32_32x32x16_bf16 v[48:63], v[104:107], a[128:131], 0
    s_waitcnt lgkmcnt(14)
    v_mfma_f32_32x32x16_bf16 v[48:63], v[108:111], a[132:135], v[48:63]
    s_waitcnt lgkmcnt(13)
    v_mfma_f32_32x32x16_bf16 v[48:63], v[112:115], a[136:139], v[48:63]
    s_waitcnt lgkmcnt(12)
    v_mfma_f32_32x32x16_bf16 v[48:63], v[116:119], a[140:143], v[48:63]
    s_waitcnt lgkmcnt(11)
    v_mfma_f32_32x32x16_bf16 v[48:63], v[120:123], a[144:147], v[48:63]
    s_waitcnt lgkmcnt(10)
    v_mfma_f32_32x32x16_bf16 v[48:63], v[124:127], a[148:151], v[48:63]
    s_waitcnt lgkmcnt(9)
    v_mfma_f32_32x32x16_bf16 v[48:63], v[128:131], a[152:155], v[48:63]
    s_waitcnt lgkmcnt(8)
    v_mfma_f32_32x32x16_bf16 v[48:63], v[132:135], a[156:159], v[48:63]
    s_waitcnt lgkmcnt(7)
    v_mfma_f32_32x32x16_bf16 v[48:63], v[136:139], a[160:163], v[48:63]
    s_waitcnt lgkmcnt(6)
    v_mfma_f32_32x32x16_bf16 v[48:63], v[140:143], a[164:167], v[48:63]
    s_waitcnt lgkmcnt(5)
    v_mfma_f32_32x32x16_bf16 v[48:63], v[144:147], a[168:171], v[48:63]
    s_waitcnt lgkmcnt(4)
    v_mfma_f32_32x32x16_bf16 v[48:63], v[148:151], a[172:175], v[48:63]
    s_waitcnt lgkmcnt(3)
    v_mfma_f32_32x32x16_bf16 v[48:63], v[152:155], a[176:179], v[48:63]
    s_waitcnt lgkmcnt(2)
    v_mfma_f32_32x32x16_bf16 v[48:63], v[156:159], a[180:183], v[48:63]
    s_waitcnt lgkmcnt(1)
    v_mfma_f32_32x32x16_bf16 v[48:63], v[160:163], a[184:187], v[48:63]
    s_waitcnt lgkmcnt(0)
    v_mfma_f32_32x32x16_bf16 v[48:63], v[164:167], a[188:191], v[48:63]
    s_waitcnt vmcnt(15)
    s_barrier
    s_mov_b32 s28, 65536
    s_add_u32 m0, s27, 0
    s_nop 0
    buffer_load_dwordx4 v4, s[4:7], s28 offen lds
    s_add_u32 m0, s27, 1024
    s_nop 0
    buffer_load_dwordx4 v5, s[4:7], s28 offen lds
    s_add_u32 m0, s27, 2048
    s_nop 0
    buffer_load_dwordx4 v6, s[4:7], s28 offen lds
    s_add_u32 m0, s27, 3072
    s_nop 0
    buffer_load_dwordx4 v7, s[4:7], s28 offen lds
    ds_read_b128 v[104:107], v16 offset:16384
    ds_read_b128 v[108:111], v17 offset:16384
    ds_read_b128 v[112:115], v18 offset:16384
    ds_read_b128 v[116:119], v19 offset:16384
    ds_read_b128 v[120:123], v20 offset:16384
    ds_read_b128 v[124:127], v21 offset:16384
    ds_read_b128 v[128:131], v22 offset:16384
    ds_read_b128 v[132:135], v23 offset:16384
    ds_read_b128 v[136:139], v16 offset:16640
    ds_read_b128 v[140:143], v17 offset:16640
    ds_read_b128 v[144:147], v18 offset:16640
    ds_read_b128 v[148:151], v19 offset:16640
    ds_read_b128 v[152:155], v20 offset:16640
    ds_read_b128 v[156:159], v21 offset:16640
    ds_read_b128 v[160:163], v22 offset:16640
    ds_read_b128 v[164:167], v23 offset:16640
    s_nop 7
    v_max3_f32 v35, v48, v49, v50
    v_max3_f32 v35, v35, v51, v52
    v_max3_f32 v35, v35, v53, v54
    v_max3_f32 v35, v35, v55, v56
    v_max3_f32 v35, v35, v57, v58
    v_max3_f32 v35, v35, v59, v60
    v_max3_f32 v35, v35, v61, v62
    v_max_f32 v35, v35, v63
    v_mov_b32 v40, v35
    s_nop 1
    v_permlane32_swap_b32 v40, v35
    s_nop 1
    v_max_f32 v36, v40, v35
    v_sub_f32 v48, v48, v36
    v_sub_f32 v80, 0, v36
    v_sub_f32 v49, v49, v36
    v_sub_f32 v81, 0, v36
    v_sub_f32 v50, v50, v36
    v_sub_f32 v82, 0, v36
    v_sub_f32 v51, v51, v36
    v_sub_f32 v83, 0, v36
    v_sub_f32 v52, v52, v36
    v_sub_f32 v84, 0, v36
    v_sub_f32 v53, v53, v36
    v_sub_f32 v85, 0, v36
    v_sub_f32 v54, v54, v36
    v_sub_f32 v86, 0, v36
    v_sub_f32 v55, v55, v36
    v_sub_f32 v87, 0, v36
    v_sub_f32 v56, v56, v36
    v_sub_f32 v88, 0, v36
    v_sub_f32 v57, v57, v36
    v_sub_f32 v89, 0, v36
    v_sub_f32 v58, v58, v36
    v_sub_f32 v90, 0, v36
    v_sub_f32 v59, v59, v36
    v_sub_f32 v91, 0, v36
    v_sub_f32 v60, v60, v36
    v_sub_f32 v92, 0, v36
    v_sub_f32 v61, v61, v36
    v_sub_f32 v93, 0, v36
    v_sub_f32 v62, v62, v36
    v_sub_f32 v94, 0, v36
    v_sub_f32 v63, v63, v36
    v_sub_f32 v95, 0, v36
    v_mov_b32 v34, 0
    s_mov_b32 s28, 81920
    s_mov_b32 s29, 49152
    s_mov_b32 s30, 0
L_attn_loop:
    s_waitcnt vmcnt(15) lgkmcnt(0)
    s_barrier
    v_mfma_f32_32x32x16_bf16 v[64:79], v[104:107], a[128:131], v[80:95]
    ds_read_b64_tr_b16 v[168:169], v24 offset:0
    ds_read_b64_tr_b16 v[170:171], v24 offset:4096
    v_exp_f32 v48, v48
    v_mfma_f32_32x32x16_bf16 v[64:79], v[108:111], a[132:135], v[64:79]
    ds_read_b64_tr_b16 v[172:173], v25 offset:0
    ds_read_b64_tr_b16 v[174:175], v25 offset:4096
    v_exp_f32 v49, v49
    v_mfma_f32_32x32x16_bf16 v[64:79], v[112:115], a[136:139], v[64:79]
    ds_read_b64_tr_b16 v[176:177], v26 offset:0
    ds_read_b64_tr_b16 v[178:179], v26 offset:4096
    v_exp_f32 v50, v50
    v_cvt_pk_bf16_f32 v96, v48, v49
    s_add_u32 m0, s27, 114688
    v_mfma_f32_32x32x16_bf16 v[64:79], v[116:119], a[140:143], v[64:79]
    buffer_load_dwordx4 v8, s[8:11], s29 offen lds
    ds_read_b64_tr_b16 v[180:181], v27 offset:0
    ds_read_b64_tr_b16 v[182:183], v27 offset:4096
    v_exp_f32 v51, v51
    v_mfma_f32_32x32x16_bf16 v[64:79], v[120:123], a[144:147], v[64:79]
    ds_read_b64_tr_b16 v[184:185], v24 offset:256
    ds_read_b64_tr_b16 v[186:187], v24 offset:4352
    v_exp_f32 v52, v52
    v_cvt_pk_bf16_f32 v97, v50, v51
    v_mfma_f32_32x32x16_bf16 v[64:79], v[124:127], a[148:151], v[64:79]
    ds_read_b64_tr_b16 v[188:189], v25 offset:256
    ds_read_b64_tr_b16 v[190:191], v25 offset:4352
    v_exp_f32 v53, v53
    v_mfma_f32_32x32x16_bf16 v[64:79], v[128:131], a[152:155], v[64:79]
    ds_read_b64_tr_b16 v[192:193], v26 offset:256
    ds_read_b64_tr_b16 v[194:195], v26 offset:4352
    v_exp_f32 v54, v54
    v_cvt_pk_bf16_f32 v98, v52, v53
    s_add_u32 m0, s27, 115712
    v_mfma_f32_32x32x16_bf16 v[64:79], v[132:135], a[156:159], v[64:79]
    buffer_load_dwordx4 v9, s[8:11], s29 offen lds
    ds_read_b64_tr_b16 v[196:197], v27 offset:256
    ds_read_b64_tr_b16 v[198:199], v27 offset:4352
    v_exp_f32 v55, v55
    v_mfma_f32_32x32x16_bf16 v[64:79], v[136:139], a[160:163], v[64:79]
    ds_read_b64_tr_b16 v[200:201], v24 offset:8192
    ds_read_b64_tr_b16 v[202:203], v24 offset:12288
    v_exp_f32 v56, v56
    v_cvt_pk_bf16_f32 v99, v54, v55
    v_mfma_f32_32x32x16_bf16 v[64:79], v[140:143], a[164:167], v[64:79]
    ds_read_b64_tr_b16 v[204:205], v25 offset:8192
    ds_read_b64_tr_b16 v[206:207], v25 offset:12288
    v_exp_f32 v57, v57
    v_mfma_f32_32x32x16_bf16 v[64:79], v[144:147], a[168:171], v[64:79]
    ds_read_b64_tr_b16 v[208:209], v26 offset:8192
    ds_read_b64_tr_b16 v[210:211], v26 offset:12288
    v_exp_f32 v58, v58
    v_cvt_pk_bf16_f32 v100, v56, v57
    s_add_u32 m0, s27, 116736
    v_mfma_f32_32x32x16_bf16 v[64:79], v[148:151], a[172:175], v[64:79]
    buffer_load_dwordx4 v10, s[8:11], s29 offen lds
    ds_read_b64_tr_b16 v[212:213], v27 offset:8192
    ds_read_b64_tr_b16 v[214:215], v27 offset:12288
    v_exp_f32 v59, v59
    v_mfma_f32_32x32x16_bf16 v[64:79], v[152:155], a[176:179], v[64:79]
    ds_read_b64_tr_b16 v[216:217], v24 offset:8448
    ds_read_b64_tr_b16 v[218:219], v24 offset:12544
    v_exp_f32 v60, v60
    v_cvt_pk_bf16_f32 v101, v58, v59
    v_mfma_f32_32x32x16_bf16 v[64:79], v[156:159], a[180:183], v[64:79]
    ds_read_b64_tr_b16 v[220:221], v25 offset:8448
    ds_read_b64_tr_b16 v[222:223], v25 offset:12544
    v_exp_f32 v61, v61
    v_mfma_f32_32x32x16_bf16 v[64:79], v[160:163], a[184:187], v[64:79]
    ds_read_b64_tr_b16 v[224:225], v26 offset:8448
    ds_read_b64_tr_b16 v[226:227], v26 offset:12544
    v_exp_f32 v62, v62
    v_cvt_pk_bf16_f32 v102, v60, v61
    s_add_u32 m0, s27, 117760
    v_mfma_f32_32x32x16_bf16 v[64:79], v[164:167], a[188:191], v[64:79]
    buffer_load_dwordx4 v11, s[8:11], s29 offen lds
    ds_read_b64_tr_b16 v[228:229], v27 offset:8448
    ds_read_b64_tr_b16 v[230:231], v27 offset:12544
    v_exp_f32 v63, v63
    s_waitcnt lgkmcnt(15)
    v_mfma_f32_32x32x16_bf16 a[0:15], v[168:171], v[96:99], a[0:15]
    v_cvt_pk_bf16_f32 v103, v62, v63
    ds_read_b128 v[104:107], v16 offset:32768
    ds_read_b128 v[108:111], v17 offset:32768
    v_add_f32 v34, v34, v48
    v_mfma_f32_32x32x16_bf16 a[16:31], v[172:175], v[96:99], a[16:31]
    ds_read_b128 v[112:115], v18 offset:32768
    ds_read_b128 v[116:119], v19 offset:32768
    v_add_f32 v34, v34, v49
    v_mfma_f32_32x32x16_bf16 a[32:47], v[176:179], v[96:99], a[32:47]
    ds_read_b128 v[120:123], v20 offset:32768
    ds_read_b128 v[124:127], v21 offset:32768
    v_add_f32 v34, v34, v50
    v_mfma_f32_32x32x16_bf16 a[48:63], v[180:183], v[96:99], a[48:63]
    ds_read_b128 v[128:131], v22 offset:32768
    ds_read_b128 v[132:135], v23 offset:32768
    v_add_f32 v34, v34, v51
    v_mfma_f32_32x32x16_bf16 a[64:79], v[184:187], v[96:99], a[64:79]
    ds_read_b128 v[136:139], v16 offset:33024
    ds_read_b128 v[140:143], v17 offset:33024
    v_add_f32 v34, v34, v52
    v_mfma_f32_32x32x16_bf16 a[80:95], v[188:191], v[96:99], a[80:95]
    ds_read_b128 v[144:147], v18 offset:33024
    ds_read_b128 v[148:151], v19 offset:33024
    v_add_f32 v34, v34, v53
    v_max3_f32 v35, v64, v65, v66
    v_mfma_f32_32x32x16_bf16 a[96:111], v[192:195], v[96:99], a[96:111]
    ds_read_b128 v[152:155], v20 offset:33024
    ds_read_b128 v[156:159], v21 offset:33024
    v_add_f32 v34, v34, v54
    v_max3_f32 v35, v35, v67, v68
    v_mfma_f32_32x32x16_bf16 a[112:127], v[196:199], v[96:99], a[112:127]
    ds_read_b128 v[160:163], v22 offset:33024
    ds_read_b128 v[164:167], v23 offset:33024
    v_add_f32 v34, v34, v55
    v_max3_f32 v35, v35, v69, v70
    s_waitcnt lgkmcnt(15)
    v_mfma_f32_32x32x16_bf16 a[0:15], v[200:203], v[100:103], a[0:15]
    v_add_f32 v34, v34, v56
    v_max3_f32 v35, v35, v71, v72
    s_add_u32 m0, s27, 16384
    v_mfma_f32_32x32x16_bf16 a[16:31], v[204:207], v[100:103], a[16:31]
    buffer_load_dwordx4 v4, s[4:7], s28 offen lds
    v_add_f32 v34, v34, v57
    v_max3_f32 v35, v35, v73, v74
    v_mfma_f32_32x32x16_bf16 a[32:47], v[208:211], v[100:103], a[32:47]
    v_add_f32 v34, v34, v58
    v_max3_f32 v35, v35, v75, v76
    s_add_u32 m0, s27, 17408
    v_mfma_f32_32x32x16_bf16 a[48:63], v[212:215], v[100:103], a[48:63]
    buffer_load_dwordx4 v5, s[4:7], s28 offen lds
    v_add_f32 v34, v34, v59
    v_max3_f32 v35, v35, v77, v78
    v_mfma_f32_32x32x16_bf16 a[64:79], v[216:219], v[100:103], a[64:79]
    v_add_f32 v34, v34, v60
    v_max_f32 v35, v35, v79
    s_add_u32 m0, s27, 18432
    v_mfma_f32_32x32x16_bf16 a[80:95], v[220:223], v[100:103], a[80:95]
    buffer_load_dwordx4 v6, s[4:7], s28 offen lds
    v_add_f32 v34, v34, v61
    v_cmp_lt_f32 vcc, s37, v35
    v_mfma_f32_32x32x16_bf16 a[96:111], v[224:227], v[100:103], a[96:111]
    v_add_f32 v34, v34, v62
    s_add_u32 m0, s27, 19456
    v_mfma_f32_32x32x16_bf16 a[112:127], v[228:231], v[100:103], a[112:127]
    buffer_load_dwordx4 v7, s[4:7], s28 offen lds
    v_add_f32 v34, v34, v63
    s_add_u32 s28, s28, 16384
    s_add_u32 s29, s29, 16384
    s_cbranch_vccnz L_attn_rare0
L_attn_back0:
    s_waitcnt vmcnt(15) lgkmcnt(0)
    s_barrier
    v_mfma_f32_32x32x16_bf16 v[48:63], v[104:107], a[128:131], v[80:95]
    ds_read_b64_tr_b16 v[168:169], v24 offset:16384
    ds_read_b64_tr_b16 v[170:171], v24 offset:20480
    v_exp_f32 v64, v64
    v_mfma_f32_32x32x16_bf16 v[48:63], v[108:111], a[132:135], v[48:63]
    ds_read_b64_tr_b16 v[172:173], v25 offset:16384
    ds_read_b64_tr_b16 v[174:175], v25 offset:20480
    v_exp_f32 v65, v65
    v_mfma_f32_32x32x16_bf16 v[48:63], v[112:115], a[136:139], v[48:63]
    ds_read_b64_tr_b16 v[176:177], v26 offset:16384
    ds_read_b64_tr_b16 v[178:179], v26 offset:20480
    v_exp_f32 v66, v66
    v_cvt_pk_bf16_f32 v96, v64, v65
    s_add_u32 m0, s27, 65536
    v_mfma_f32_32x32x16_bf16 v[48:63], v[116:119], a[140:143], v[48:63]
    buffer_load_dwordx4 v8, s[8:11], s29 offen lds
    ds_read_b64_tr_b16 v[180:181], v27 offset:16384
    ds_read_b64_tr_b16 v[182:183], v27 offset:20480
    v_exp_f32 v67, v67
    v_mfma_f32_32x32x16_bf16 v[48:63], v[120:123], a[144:147], v[48:63]
    ds_read_b64_tr_b16 v[184:185], v24 offset:16640
    ds_read_b64_tr_b16 v[186:187], v24 offset:20736
    v_exp_f32 v68, v68
    v_cvt_pk_bf16_f32 v97, v66, v67
    v_mfma_f32_32x32x16_bf16 v[48:63], v[124:127], a[148:151], v[48:63]
    ds_read_b64_tr_b16 v[188:189], v25 offset:16640
    ds_read_b64_tr_b16 v[190:191], v25 offset:20736
    v_exp_f32 v69, v69
    v_mfma_f32_32x32x16_bf16 v[48:63], v[128:131], a[152:155], v[48:63]
    ds_read_b64_tr_b16 v[192:193], v26 offset:16640
    ds_read_b64_tr_b16 v[194:195], v26 offset:20736
    v_exp_f32 v70, v70
    v_cvt_pk_bf16_f32 v98, v68, v69
    s_add_u32 m0, s27, 66560
    v_mfma_f32_32x32x16_bf16 v[48:63], v[132:135], a[156:159], v[48:63]
    buffer_load_dwordx4 v9, s[8:11], s29 offen lds
    ds_read_b64_tr_b16 v[196:197], v27 offset:16640
    ds_read_b64_tr_b16 v[198:199], v27 offset:20736
    v_exp_f32 v71, v71
    v_mfma_f32_32x32x16_bf16 v[48:63], v[136:139], a[160:163], v[48:63]
    ds_read_b64_tr_b16 v[200:201], v24 offset:24576
    ds_read_b64_tr_b16 v[202:203], v24 offset:28672
    v_exp_f32 v72, v72
    v_cvt_pk_bf16_f32 v99, v70, v71
    v_mfma_f32_32x32x16_bf16 v[48:63], v[140:143], a[164:167], v[48:63]
    ds_read_b64_tr_b16 v[204:205], v25 offset:24576
    ds_read_b64_tr_b16 v[206:207], v25 offset:28672
    v_exp_f32 v73, v73
    v_mfma_f32_32x32x16_bf16 v[48:63], v[144:147], a[168:171], v[48:63]
    ds_read_b64_tr_b16 v[208:209], v26 offset:24576
    ds_read_b64_tr_b16 v[210:211], v26 offset:28672
    v_exp_f32 v74, v74
    v_cvt_pk_bf16_f32 v100, v72, v73
    s_add_u32 m0, s27, 67584
    v_mfma_f32_32x32x16_bf16 v[48:63], v[148:151], a[172:175], v[48:63]
    buffer_load_dwordx4 v10, s[8:11], s29 offen lds
    ds_read_b64_tr_b16 v[212:213], v27 offset:24576
    ds_read_b64_tr_b16 v[214:215], v27 offset:28672
    v_exp_f32 v75, v75
    v_mfma_f32_32x32x16_bf16 v[48:63], v[152:155], a[176:179], v[48:63]
    ds_read_b64_tr_b16 v[216:217], v24 offset:24832
    ds_read_b64_tr_b16 v[218:219], v24 offset:28928
    v_exp_f32 v76, v76
    v_cvt_pk_bf16_f32 v101, v74, v75
    v_mfma_f32_32x32x16_bf16 v[48:63], v[156:159], a[180:183], v[48:63]
    ds_read_b64_tr_b16 v[220:221], v25 offset:24832
    ds_read_b64_tr_b16 v[222:223], v25 offset:28928
    v_exp_f32 v77, v77
    v_mfma_f32_32x32x16_bf16 v[48:63], v[160:163], a[184:187], v[48:63]
    ds_read_b64_tr_b16 v[224:225], v26 offset:24832
    ds_read_b64_tr_b16 v[226:227], v26 offset:28928
    v_exp_f32 v78, v78
    v_cvt_pk_bf16_f32 v102, v76, v77
    s_add_u32 m0, s27, 68608
    v_mfma_f32_32x32x16_bf16 v[48:63], v[164:167], a[188:191], v[48:63]
    buffer_load_dwordx4 v11, s[8:11], s29 offen lds
    ds_read_b64_tr_b16 v[228:229], v27 offset:24832
    ds_read_b64_tr_b16 v[230:231], v27 offset:28928
    v_exp_f32 v79, v79
    s_waitcnt lgkmcnt(15)
    v_mfma_f32_32x32x16_bf16 a[0:15], v[168:171], v[96:99], a[0:15]
    v_cvt_pk_bf16_f32 v103, v78, v79
    ds_read_b128 v[104:107], v16 offset:49152
    ds_read_b128 v[108:111], v17 offset:49152
    v_add_f32 v34, v34, v64
    v_mfma_f32_32x32x16_bf16 a[16:31], v[172:175], v[96:99], a[16:31]
    ds_read_b128 v[112:115], v18 offset:49152
    ds_read_b128 v[116:119], v19 offset:49152
    v_add_f32 v34, v34, v65
    v_mfma_f32_32x32x16_bf16 a[32:47], v[176:179], v[96:99], a[32:47]
    ds_read_b128 v[120:123], v20 offset:49152
    ds_read_b128 v[124:127], v21 offset:49152
    v_add_f32 v34, v34, v66
    v_mfma_f32_32x32x16_bf16 a[48:63], v[180:183], v[96:99], a[48:63]
    ds_read_b128 v[128:131], v22 offset:49152
    ds_read_b128 v[132:135], v23 offset:49152
    v_add_f32 v34, v34, v67
    v_mfma_f32_32x32x16_bf16 a[64:79], v[184:187], v[96:99], a[64:79]
    ds_read_b128 v[136:139], v16 offset:49408
    ds_read_b128 v[140:143], v17 offset:49408
    v_add_f32 v34, v34, v68
    v_mfma_f32_32x32x16_bf16 a[80:95], v[188:191], v[96:99], a[80:95]
    ds_read_b128 v[144:147], v18 offset:49408
    ds_read_b128 v[148:151], v19 offset:49408
    v_add_f32 v34, v34, v69
    v_max3_f32 v35, v48, v49, v50
    v_mfma_f32_32x32x16_bf16 a[96:111], v[192:195], v[96:99], a[96:111]
    ds_read_b128 v[152:155], v20 offset:49408
    ds_read_b128 v[156:159], v21 offset:49408
    v_add_f32 v34, v34, v70
    v_max3_f32 v35, v35, v51, v52
    v_mfma_f32_32x32x16_bf16 a[112:127], v[196:199], v[96:99], a[112:127]
    ds_read_b128 v[160:163], v22 offset:49408
    ds_read_b128 v[164:167], v23 offset:49408
    v_add_f32 v34, v34, v71
    v_max3_f32 v35, v35, v53, v54
    s_waitcnt lgkmcnt(15)
    v_mfma_f32_32x32x16_bf16 a[0:15], v[200:203], v[100:103], a[0:15]
    v_add_f32 v34, v34, v72
    v_max3_f32 v35, v35, v55, v56
    s_add_u32 m0, s27, 32768
    v_mfma_f32_32x32x16_bf16 a[16:31], v[204:207], v[100:103], a[16:31]
    buffer_load_dwordx4 v4, s[4:7], s28 offen lds
    v_add_f32 v34, v34, v73
    v_max3_f32 v35, v35, v57, v58
    v_mfma_f32_32x32x16_bf16 a[32:47], v[208:211], v[100:103], a[32:47]
    v_add_f32 v34, v34, v74
    v_max3_f32 v35, v35, v59, v60
    s_add_u32 m0, s27, 33792
    v_mfma_f32_32x32x16_bf16 a[48:63], v[212:215], v[100:103], a[48:63]
    buffer_load_dwordx4 v5, s[4:7], s28 offen lds
    v_add_f32 v34, v34, v75
    v_max3_f32 v35, v35, v61, v62
    v_mfma_f32_32x32x16_bf16 a[64:79], v[216:219], v[100:103], a[64:79]
    v_add_f32 v34, v34, v76
    v_max_f32 v35, v35, v63
    s_add_u32 m0, s27, 34816
    v_mfma_f32_32x32x16_bf16 a[80:95], v[220:223], v[100:103], a[80:95]
    buffer_load_dwordx4 v6, s[4:7], s28 offen lds
    v_add_f32 v34, v34, v77
    v_cmp_lt_f32 vcc, s37, v35
    v_mfma_f32_32x32x16_bf16 a[96:111], v[224:227], v[100:103], a[96:111]
    v_add_f32 v34, v34, v78
    s_add_u32 m0, s27, 35840
    v_mfma_f32_32x32x16_bf16 a[112:127], v[228:231], v[100:103], a[112:127]
    buffer_load_dwordx4 v7, s[4:7], s28 offen lds
    v_add_f32 v34, v34, v79
    s_add_u32 s28, s28, 16384
    s_add_u32 s29, s29, 16384
    s_cbranch_vccnz L_attn_rare1
L_attn_back1:
    s_waitcnt vmcnt(15) lgkmcnt(0)
    s_barrier
    v_mfma_f32_32x32x16_bf16 v[64:79], v[104:107], a[128:131], v[80:95]
    ds_read_b64_tr_b16 v[168:169], v24 offset:32768
    ds_read_b64_tr_b16 v[170:171], v24 offset:36864
    v_exp_f32 v48, v48
    v_mfma_f32_32x32x16_bf16 v[64:79], v[108:111], a[132:135], v[64:79]
    ds_read_b64_tr_b16 v[172:173], v25 offset:32768
    ds_read_b64_tr_b16 v[174:175], v25 offset:36864
    v_exp_f32 v49, v49
    v_mfma_f32_32x32x16_bf16 v[64:79], v[112:115], a[136:139], v[64:79]
    ds_read_b64_tr_b16 v[176:177], v26 offset:32768
    ds_read_b64_tr_b16 v[178:179], v26 offset:36864
    v_exp_f32 v50, v50
    v_cvt_pk_bf16_f32 v96, v48, v49
    s_add_u32 m0, s27, 81920
    v_mfma_f32_32x32x16_bf16 v[64:79], v[116:119], a[140:143], v[64:79]
    buffer_load_dwordx4 v8, s[8:11], s29 offen lds
    ds_read_b64_tr_b16 v[180:181], v27 offset:32768
    ds_read_b64_tr_b16 v[182:183], v27 offset:36864
    v_exp_f32 v51, v51
    v_mfma_f32_32x32x16_bf16 v[64:79], v[120:123], a[144:147], v[64:79]
    ds_read_b64_tr_b16 v[184:185], v24 offset:33024
    ds_read_b64_tr_b16 v[186:187], v24 offset:37120
    v_exp_f32 v52, v52
    v_cvt_pk_bf16_f32 v97, v50, v51
    v_mfma_f32_32x32x16_bf16 v[64:79], v[124:127], a[148:151], v[64:79]
    ds_read_b64_tr_b16 v[188:189], v25 offset:33024
    ds_read_b64_tr_b16 v[190:191], v25 offset:37120
    v_exp_f32 v53, v53
    v_mfma_f32_32x32x16_bf16 v[64:79], v[128:131], a[152:155], v[64:79]
    ds_read_b64_tr_b16 v[192:193], v26 offset:33024
    ds_read_b64_tr_b16 v[194:195], v26 offset:37120
    v_exp_f32 v54, v54
    v_cvt_pk_bf16_f32 v98, v52, v53
    s_add_u32 m0, s27, 82944
    v_mfma_f32_32x32x16_bf16 v[64:79], v[132:135], a[156:159], v[64:79]
    buffer_load_dwordx4 v9, s[8:11], s29 offen lds
    ds_read_b64_tr_b16 v[196:197], v27 offset:33024
    ds_read_b64_tr_b16 v[198:199], v27 offset:37120
    v_exp_f32 v55, v55
    v_mfma_f32_32x32x16_bf16 v[64:79], v[136:139], a[160:163], v[64:79]
    ds_read_b64_tr_b16 v[200:201], v24 offset:40960
    ds_read_b64_tr_b16 v[202:203], v24 offset:45056
    v_exp_f32 v56, v56
    v_cvt_pk_bf16_f32 v99, v54, v55
    v_mfma_f32_32x32x16_bf16 v[64:79], v[140:143], a[164:167], v[64:79]
    ds_read_b64_tr_b16 v[204:205], v25 offset:40960
    ds_read_b64_tr_b16 v[206:207], v25 offset:45056
    v_exp_f32 v57, v57
    v_mfma_f32_32x32x16_bf16 v[64:79], v[144:147], a[168:171], v[64:79]
    ds_read_b64_tr_b16 v[208:209], v26 offset:40960
    ds_read_b64_tr_b16 v[210:211], v26 offset:45056
    v_exp_f32 v58, v58
    v_cvt_pk_bf16_f32 v100, v56, v57
    s_add_u32 m0, s27, 83968
    v_mfma_f32_32x32x16_bf16 v[64:79], v[148:151], a[172:175], v[64:79]
    buffer_load_dwordx4 v10, s[8:11], s29 offen lds
    ds_read_b64_tr_b16 v[212:213], v27 offset:40960
    ds_read_b64_tr_b16 v[214:215], v27 offset:45056
    v_exp_f32 v59, v59
    v_mfma_f32_32x32x16_bf16 v[64:79], v[152:155], a[176:179], v[64:79]
    ds_read_b64_tr_b16 v[216:217], v24 offset:41216
    ds_read_b64_tr_b16 v[218:219], v24 offset:45312
    v_exp_f32 v60, v60
    v_cvt_pk_bf16_f32 v101, v58, v59
    v_mfma_f32_32x32x16_bf16 v[64:79], v[156:159], a[180:183], v[64:79]
    ds_read_b64_tr_b16 v[220:221], v25 offset:41216
    ds_read_b64_tr_b16 v[222:223], v25 offset:45312
    v_exp_f32 v61, v61
    v_mfma_f32_32x32x16_bf16 v[64:79], v[160:163], a[184:187], v[64:79]
    ds_read_b64_tr_b16 v[224:225], v26 offset:41216
    ds_read_b64_tr_b16 v[226:227], v26 offset:45312
    v_exp_f32 v62, v62
    v_cvt_pk_bf16_f32 v102, v60, v61
    s_add_u32 m0, s27, 84992
    v_mfma_f32_32x32x16_bf16 v[64:79], v[164:167], a[188:191], v[64:79]
    buffer_load_dwordx4 v11, s[8:11], s29 offen lds
    ds_read_b64_tr_b16 v[228:229], v27 offset:41216
    ds_read_b64_tr_b16 v[230:231], v27 offset:45312
    v_exp_f32 v63, v63
    s_waitcnt lgkmcnt(15)
    v_mfma_f32_32x32x16_bf16 a[0:15], v[168:171], v[96:99], a[0:15]
    v_cvt_pk_bf16_f32 v103, v62, v63
    ds_read_b128 v[104:107], v16 offset:0
    ds_read_b128 v[108:111], v17 offset:0
    v_add_f32 v34, v34, v48
    v_mfma_f32_32x32x16_bf16 a[16:31], v[172:175], v[96:99], a[16:31]
    ds_read_b128 v[112:115], v18 offset:0
    ds_read_b128 v[116:119], v19 offset:0
    v_add_f32 v34, v34, v49
    v_mfma_f32_32x32x16_bf16 a[32:47], v[176:179], v[96:99], a[32:47]
    ds_read_b128 v[120:123], v20 offset:0
    ds_read_b128 v[124:127], v21 offset:0
    v_add_f32 v34, v34, v50
    v_mfma_f32_32x32x16_bf16 a[48:63], v[180:183], v[96:99], a[48:63]
    ds_read_b128 v[128:131], v22 offset:0
    ds_read_b128 v[132:135], v23 offset:0
    v_add_f32 v34, v34, v51
    v_mfma_f32_32x32x16_bf16 a[64:79], v[184:187], v[96:99], a[64:79]
    ds_read_b128 v[136:139], v16 offset:256
    ds_read_b128 v[140:143], v17 offset:256
    v_add_f32 v34, v34, v52
    v_mfma_f32_32x32x16_bf16 a[80:95], v[188:191], v[96:99], a[80:95]
    ds_read_b128 v[144:147], v18 offset:256
    ds_read_b128 v[148:151], v19 offset:256
    v_add_f32 v34, v34, v53
    v_max3_f32 v35, v64, v65, v66
    v_mfma_f32_32x32x16_bf16 a[96:111], v[192:195], v[96:99], a[96:111]
    ds_read_b128 v[152:155], v20 offset:256
    ds_read_b128 v[156:159], v21 offset:256
    v_add_f32 v34, v34, v54
    v_max3_f32 v35, v35, v67, v68
    v_mfma_f32_32x32x16_bf16 a[112:127], v[196:199], v[96:99], a[112:127]
    ds_read_b128 v[160:163], v22 offset:256
    ds_read_b128 v[164:167], v23 offset:256
    v_add_f32 v34, v34, v55
    v_max3_f32 v35, v35, v69, v70
    s_waitcnt lgkmcnt(15)
    v_mfma_f32_32x32x16_bf16 a[0:15], v[200:203], v[100:103], a[0:15]
    v_add_f32 v34, v34, v56
    v_max3_f32 v35, v35, v71, v72
    s_add_u32 m0, s27, 49152
    v_mfma_f32_32x32x16_bf16 a[16:31], v[204:207], v[100:103], a[16:31]
    buffer_load_dwordx4 v4, s[4:7], s28 offen lds
    v_add_f32 v34, v34, v57
    v_max3_f32 v35, v35, v73, v74
    v_mfma_f32_32x32x16_bf16 a[32:47], v[208:211], v[100:103], a[32:47]
    v_add_f32 v34, v34, v58
    v_max3_f32 v35, v35, v75, v76
    s_add_u32 m0, s27, 50176
    v_mfma_f32_32x32x16_bf16 a[48:63], v[212:215], v[100:103], a[48:63]
    buffer_load_dwordx4 v5, s[4:7], s28 offen lds
    v_add_f32 v34, v34, v59
    v_max3_f32 v35, v35, v77, v78
    v_mfma_f32_32x32x16_bf16 a[64:79], v[216:219], v[100:103], a[64:79]
    v_add_f32 v34, v34, v60
    v_max_f32 v35, v35, v79
    s_add_u32 m0, s27, 51200
    v_mfma_f32_32x32x16_bf16 a[80:95], v[220:223], v[100:103], a[80:95]
    buffer_load_dwordx4 v6, s[4:7], s28 offen lds
    v_add_f32 v34, v34, v61
    v_cmp_lt_f32 vcc, s37, v35
    v_mfma_f32_32x32x16_bf16 a[96:111], v[224:227], v[100:103], a[96:111]
    v_add_f32 v34, v34, v62
    s_add_u32 m0, s27, 52224
    v_mfma_f32_32x32x16_bf16 a[112:127], v[228:231], v[100:103], a[112:127]
    buffer_load_dwordx4 v7, s[4:7], s28 offen lds
    v_add_f32 v34, v34, v63
    s_add_u32 s28, s28, 16384
    s_add_u32 s29, s29, 16384
    s_cbranch_vccnz L_attn_rare2
L_attn_back2:
    s_waitcnt vmcnt(15) lgkmcnt(0)
    s_barrier
    v_mfma_f32_32x32x16_bf16 v[48:63], v[104:107], a[128:131], v[80:95]
    ds_read_b64_tr_b16 v[168:169], v24 offset:49152
    ds_read_b64_tr_b16 v[170:171], v24 offset:53248
    v_exp_f32 v64, v64
    v_mfma_f32_32x32x16_bf16 v[48:63], v[108:111], a[132:135], v[48:63]
    ds_read_b64_tr_b16 v[172:173], v25 offset:49152
    ds_read_b64_tr_b16 v[174:175], v25 offset:53248
    v_exp_f32 v65, v65
    v_mfma_f32_32x32x16_bf16 v[48:63], v[112:115], a[136:139], v[48:63]
    ds_read_b64_tr_b16 v[176:177], v26 offset:49152
    ds_read_b64_tr_b16 v[178:179], v26 offset:53248
    v_exp_f32 v66, v66
    v_cvt_pk_bf16_f32 v96, v64, v65
    s_add_u32 m0, s27, 98304
    v_mfma_f32_32x32x16_bf16 v[48:63], v[116:119], a[140:143], v[48:63]
    buffer_load_dwordx4 v8, s[8:11], s29 offen lds
    ds_read_b64_tr_b16 v[180:181], v27 offset:49152
    ds_read_b64_tr_b16 v[182:183], v27 offset:53248
    v_exp_f32 v67, v67
    v_mfma_f32_32x32x16_bf16 v[48:63], v[120:123], a[144:147], v[48:63]
    ds_read_b64_tr_b16 v[184:185], v24 offset:49408
    ds_read_b64_tr_b16 v[186:187], v24 offset:53504
    v_exp_f32 v68, v68
    v_cvt_pk_bf16_f32 v97, v66, v67
    v_mfma_f32_32x32x16_bf16 v[48:63], v[124:127], a[148:151], v[48:63]
    ds_read_b64_tr_b16 v[188:189], v25 offset:49408
    ds_read_b64_tr_b16 v[190:191], v25 offset:53504
    v_exp_f32 v69, v69
    v_mfma_f32_32x32x16_bf16 v[48:63], v[128:131], a[152:155], v[48:63]
    ds_read_b64_tr_b16 v[192:193], v26 offset:49408
    ds_read_b64_tr_b16 v[194:195], v26 offset:53504
    v_exp_f32 v70, v70
    v_cvt_pk_bf16_f32 v98, v68, v69
    s_add_u32 m0, s27, 99328
    v_mfma_f32_32x32x16_bf16 v[48:63], v[132:135], a[156:159], v[48:63]
    buffer_load_dwordx4 v9, s[8:11], s29 offen lds
    ds_read_b64_tr_b16 v[196:197], v27 offset:49408
    ds_read_b64_tr_b16 v[198:199], v27 offset:53504
    v_exp_f32 v71, v71
    v_mfma_f32_32x32x16_bf16 v[48:63], v[136:139], a[160:163], v[48:63]
    ds_read_b64_tr_b16 v[200:201], v24 offset:57344
    ds_read_b64_tr_b16 v[202:203], v24 offset:61440
    v_exp_f32 v72, v72
    v_cvt_pk_bf16_f32 v99, v70, v71
    v_mfma_f32_32x32x16_bf16 v[48:63], v[140:143], a[164:167], v[48:63]
    ds_read_b64_tr_b16 v[204:205], v25 offset:57344
    ds_read_b64_tr_b16 v[206:207], v25 offset:61440
    v_exp_f32 v73, v73
    v_mfma_f32_32x32x16_bf16 v[48:63], v[144:147], a[168:171], v[48:63]
    ds_read_b64_tr_b16 v[208:209], v26 offset:57344
    ds_read_b64_tr_b16 v[210:211], v26 offset:61440
    v_exp_f32 v74, v74
    v_cvt_pk_bf16_f32 v100, v72, v73
    s_add_u32 m0, s27, 100352
    v_mfma_f32_32x32x16_bf16 v[48:63], v[148:151], a[172:175], v[48:63]
    buffer_load_dwordx4 v10, s[8:11], s29 offen lds
    ds_read_b64_tr_b16 v[212:213], v27 offset:57344
    ds_read_b64_tr_b16 v[214:215], v27 offset:61440
    v_exp_f32 v75, v75
    v_mfma_f32_32x32x16_bf16 v[48:63], v[152:155], a[176:179], v[48:63]
    ds_read_b64_tr_b16 v[216:217], v24 offset:57600
    ds_read_b64_tr_b16 v[218:219], v24 offset:61696
    v_exp_f32 v76, v76
    v_cvt_pk_bf16_f32 v101, v74, v75
    v_mfma_f32_32x32x16_bf16 v[48:63], v[156:159], a[180:183], v[48:63]
    ds_read_b64_tr_b16 v[220:221], v25 offset:57600
    ds_read_b64_tr_b16 v[222:223], v25 offset:61696
    v_exp_f32 v77, v77
    v_mfma_f32_32x32x16_bf16 v[48:63], v[160:163], a[184:187], v[48:63]
    ds_read_b64_tr_b16 v[224:225], v26 offset:57600
    ds_read_b64_tr_b16 v[226:227], v26 offset:61696
    v_exp_f32 v78, v78
    v_cvt_pk_bf16_f32 v102, v76, v77
    s_add_u32 m0, s27, 101376
    v_mfma_f32_32x32x16_bf16 v[48:63], v[164:167], a[188:191], v[48:63]
    buffer_load_dwordx4 v11, s[8:11], s29 offen lds
    ds_read_b64_tr_b16 v[228:229], v27 offset:57600
    ds_read_b64_tr_b16 v[230:231], v27 offset:61696
    v_exp_f32 v79, v79
    s_waitcnt lgkmcnt(15)
    v_mfma_f32_32x32x16_bf16 a[0:15], v[168:171], v[96:99], a[0:15]
    v_cvt_pk_bf16_f32 v103, v78, v79
    ds_read_b128 v[104:107], v16 offset:16384
    ds_read_b128 v[108:111], v17 offset:16384
    v_add_f32 v34, v34, v64
    v_mfma_f32_32x32x16_bf16 a[16:31], v[172:175], v[96:99], a[16:31]
    ds_read_b128 v[112:115], v18 offset:16384
    ds_read_b128 v[116:119], v19 offset:16384
    v_add_f32 v34, v34, v65
    v_mfma_f32_32x32x16_bf16 a[32:47], v[176:179], v[96:99], a[32:47]
    ds_read_b128 v[120:123], v20 offset:16384
    ds_read_b128 v[124:127], v21 offset:16384
    v_add_f32 v34, v34, v66
    v_mfma_f32_32x32x16_bf16 a[48:63], v[180:183], v[96:99], a[48:63]
    ds_read_b128 v[128:131], v22 offset:16384
    ds_read_b128 v[132:135], v23 offset:16384
    v_add_f32 v34, v34, v67
    v_mfma_f32_32x32x16_bf16 a[64:79], v[184:187], v[96:99], a[64:79]
    ds_read_b128 v[136:139], v16 offset:16640
    ds_read_b128 v[140:143], v17 offset:16640
    v_add_f32 v34, v34, v68
    v_mfma_f32_32x32x16_bf16 a[80:95], v[188:191], v[96:99], a[80:95]
    ds_read_b128 v[144:147], v18 offset:16640
    ds_read_b128 v[148:151], v19 offset:16640
    v_add_f32 v34, v34, v69
    v_max3_f32 v35, v48, v49, v50
    v_mfma_f32_32x32x16_bf16 a[96:111], v[192:195], v[96:99], a[96:111]
    ds_read_b128 v[152:155], v20 offset:16640
    ds_read_b128 v[156:159], v21 offset:16640
    v_add_f32 v34, v34, v70
    v_max3_f32 v35, v35, v51, v52
    v_mfma_f32_32x32x16_bf16 a[112:127], v[196:199], v[96:99], a[112:127]
    ds_read_b128 v[160:163], v22 offset:16640
    ds_read_b128 v[164:167], v23 offset:16640
    v_add_f32 v34, v34, v71
    v_max3_f32 v35, v35, v53, v54
    s_waitcnt lgkmcnt(15)
    v_mfma_f32_32x32x16_bf16 a[0:15], v[200:203], v[100:103], a[0:15]
    v_add_f32 v34, v34, v72
    v_max3_f32 v35, v35, v55, v56
    s_add_u32 m0, s27, 0
    v_mfma_f32_32x32x16_bf16 a[16:31], v[204:207], v[100:103], a[16:31]
    buffer_load_dwordx4 v4, s[4:7], s28 offen lds
    v_add_f32 v34, v34, v73
    v_max3_f32 v35, v35, v57, v58
    v_mfma_f32_32x32x16_bf16 a[32:47], v[208:211], v[100:103], a[32:47]
    v_add_f32 v34, v34, v74
    v_max3_f32 v35, v35, v59, v60
    s_add_u32 m0, s27, 1024
    v_mfma_f32_32x32x16_bf16 a[48:63], v[212:215], v[100:103], a[48:63]
    buffer_load_dwordx4 v5, s[4:7], s28 offen lds
    v_add_f32 v34, v34, v75
    v_max3_f32 v35, v35, v61, v62
    v_mfma_f32_32x32x16_bf16 a[64:79], v[216:219], v[100:103], a[64:79]
    v_add_f32 v34, v34, v76
    v_max_f32 v35, v35, v63
    s_add_u32 m0, s27, 2048
    v_mfma_f32_32x32x16_bf16 a[80:95], v[220:223], v[100:103], a[80:95]
    buffer_load_dwordx4 v6, s[4:7], s28 offen lds
    v_add_f32 v34, v34, v77
    v_cmp_lt_f32 vcc, s37, v35
    v_mfma_f32_32x32x16_bf16 a[96:111], v[224:227], v[100:103], a[96:111]
    v_add_f32 v34, v34, v78
    s_add_u32 m0, s27, 3072
    v_mfma_f32_32x32x16_bf16 a[112:127], v[228:231], v[100:103], a[112:127]
    buffer_load_dwordx4 v7, s[4:7], s28 offen lds
    v_add_f32 v34, v34, v79
    s_add_u32 s28, s28, 16384
    s_add_u32 s29, s29, 16384
    s_cbranch_vccnz L_attn_rare3
L_attn_back3:
    s_add_u32 s30, s30, 1
    s_cmp_le_u32 s30, 5
    s_cbranch_scc1 L_attn_hook
    s_cmp_lt_u32 s30, 15
    s_cbranch_scc1 L_attn_loop
    s_cmp_eq_u32 s30, 15
    s_cbranch_scc1 L_attn_hookB
    s_waitcnt vmcnt(0)
    s_barrier
    v_mov_b32 v40, v34
    v_mov_b32 v4, v236
    v_mov_b32 v5, v237
    v_mov_b32 v6, v238
    v_mov_b32 v7, v239
    v_permlane32_swap_b32 v40, v34
    s_nop 1
    v_add_f32 v34, v40, v34
    v_rcp_f32 v37, v34
    s_mov_b32 s28, 28672
    s_add_u32 m0, s27, 98304
    s_nop 0
    buffer_load_dwordx4 v4, s[16:19], s28 offen lds
    s_add_u32 m0, s27, 99328
    s_nop 0
    buffer_load_dwordx4 v5, s[16:19], s28 offen lds
    s_add_u32 m0, s27, 100352
    s_nop 0
    buffer_load_dwordx4 v6, s[16:19], s28 offen lds
    s_add_u32 m0, s27, 101376
    s_nop 0
    buffer_load_dwordx4 v7, s[16:19], s28 offen lds
    s_mov_b32 s28, 43008
    s_add_u32 m0, s27, 114688
    s_nop 0
    buffer_load_dwordx4 v4, s[16:19], s28 offen lds
    s_add_u32 m0, s27, 115712
    s_nop 0
    buffer_load_dwordx4 v5, s[16:19], s28 offen lds
    s_add_u32 m0, s27, 116736
    s_nop 0
    buffer_load_dwordx4 v6, s[16:19], s28 offen lds
    s_add_u32 m0, s27, 117760
    s_nop 0
    buffer_load_dwordx4 v7, s[16:19], s28 offen lds
    v_readfirstlane_b32 s33, v254
    s_cmp_ge_u32 s33, 256
    s_cbranch_scc1 L_attn_bok
L_attn_bpoll:
    s_sleep 8
    global_load_dword v254, v255, s[62:63] sc0 sc1
    s_waitcnt vmcnt(0)
    v_readfirstlane_b32 s33, v254
    s_cmp_lt_u32 s33, 256
    s_cbranch_scc1 L_attn_bpoll
L_attn_bok:
    s_add_u32 s12, s42, 0
    s_addc_u32 s13, s43, 0
    s_mov_b32 s14, 8388608
    s_mov_b32 s15, 0x20000
    s_add_u32 s20, s46, 2097152
    s_addc_u32 s21, s47, 0
    s_mov_b32 s22, 3670016
    s_mov_b32 s23, 0x20000
    s_add_u32 s48, s46, 33554432
    s_addc_u32 s49, s47, 0
    s_mov_b32 s50, 3670016
    s_mov_b32 s51, 0x20000
    s_add_u32 s52, s44, 0
    s_addc_u32 s53, s45, 0
    s_mov_b32 s54, 4096
    s_mov_b32 s55, 0x20000
    s_mul_i32 s32, s25, 1835008
    s_add_u32 s32, s32, 50331648
    s_add_u32 s8, s46, s32
    s_addc_u32 s9, s47, 0
    s_mov_b32 s10, 1835008
    s_mov_b32 s11, 0x20000
    s_lshl_b32 s31, s26, 7
    s_bfe_u32 s32, s2, 0x20001
    s_lshl_b32 s32, s32, 2
    s_bfe_u32 s33, s2, 0x20003
    s_add_u32 s32, s32, s33
    s_lshl_b32 s29, s32, 7
    s_and_b32 s32, s2, 1
    s_lshl_b32 s32, s32, 3
    s_lshr_b32 s33, s2, 5
    s_add_u32 s32, s32, s33
    s_mul_i32 s30, s32, 56
    s_lshl_b32 s32, s32, 18
    s_add_u32 s32, s32, 10485760
    s_add_u32 s4, s46, s32
    s_addc_u32 s5, s47, 0
    s_mov_b32 s6, 262144
    s_mov_b32 s7, 0x20000
    s_mov_b32 s65, 0
    s_lshr_b32 s66, s2, 3
    s_lshl_b32 s67, s66, 13
    s_lshl_b32 s66, s66, 7
    v_and_b32 v224, 63, v0
    v_lshrrev_b32 v232, 5, v224
    s_mov_b32 s63, s24
    s_mov_b32 s64, 0
    s_mul_i32 s56, s24, 32
    v_lshrrev_b32 v225, 3, v224
    v_and_b32 v226, 7, v224
    s_mov_b32 s57, 4096
    v_add_u32 v227, 0, v225
    v_add_u32 v227, s56, v227
    v_bfe_u32 v228, v227, 1, 3
    v_xor_b32 v228, v228, v226
    v_lshlrev_b32 v228, 4, v228
    v_add_u32 v227, s29, v227
    v_mul_lo_u32 v227, v227, s57
    v_add_u32 v233, v227, v228
    v_add_u32 v227, 8, v225
    v_add_u32 v227, s56, v227
    v_bfe_u32 v228, v227, 1, 3
    v_xor_b32 v228, v228, v226
    v_lshlrev_b32 v228, 4, v228
    v_add_u32 v227, s29, v227
    v_mul_lo_u32 v227, v227, s57
    v_add_u32 v234, v227, v228
    v_add_u32 v227, 16, v225
    v_add_u32 v227, s56, v227
    v_bfe_u32 v228, v227, 1, 3
    v_xor_b32 v228, v228, v226
    v_lshlrev_b32 v228, 4, v228
    v_add_u32 v227, s29, v227
    v_mul_lo_u32 v227, v227, s57
    v_add_u32 v235, v227, v228
    v_add_u32 v227, 24, v225
    v_add_u32 v227, s56, v227
    v_bfe_u32 v228, v227, 1, 3
    v_xor_b32 v228, v228, v226
    v_lshlrev_b32 v228, 4, v228
    v_add_u32 v227, s29, v227
    v_mul_lo_u32 v227, v227, s57
    v_add_u32 v236, v227, v228
    s_mul_i32 s56, s24, 16
    v_lshrrev_b32 v225, 3, v224
    v_and_b32 v226, 7, v224
    s_mov_b32 s57, 128
    s_lshl_b32 s58, s65, 1
    v_add_u32 v227, 0, v225
    v_add_u32 v227, s56, v227
    v_bfe_u32 v228, v227, 1, 1
    v_lshlrev_b32 v228, 2, v228
    v_xor_b32 v228, v228, v226
    v_lshlrev_b32 v228, 4, v228
    v_mul_lo_u32 v227, v227, s57
    v_add3_u32 v237, v227, v228, s58
    v_add_u32 v227, 8, v225
    v_add_u32 v227, s56, v227
    v_bfe_u32 v228, v227, 1, 1
    v_lshlrev_b32 v228, 2, v228
    v_xor_b32 v228, v228, v226
    v_lshlrev_b32 v228, 4, v228
    v_mul_lo_u32 v227, v227, s57
    v_add3_u32 v238, v227, v228, s58
    s_mul_i32 s60, s24, 4096
    s_mul_i32 s61, s24, 2048
    s_add_u32 s61, s61, 16384
    v_and_b32 v225, 31, v224
    s_mul_i32 s56, s63, 32
    v_add_u32 v225, s56, v225
    v_bfe_u32 v226, v225, 1, 3
    v_add_u32 v227, 0, v232
    v_xor_b32 v227, v227, v226
    v_lshlrev_b32 v227, 4, v227
    v_mul_u32_u24 v228, 128, v225
    v_add_u32 v239, v227, v228
    v_add_u32 v227, 2, v232
    v_xor_b32 v227, v227, v226
    v_lshlrev_b32 v227, 4, v227
    v_mul_u32_u24 v228, 128, v225
    v_add_u32 v240, v227, v228
    v_add_u32 v227, 4, v232
    v_xor_b32 v227, v227, v226
    v_lshlrev_b32 v227, 4, v227
    v_mul_u32_u24 v228, 128, v225
    v_add_u32 v241, v227, v228
    v_add_u32 v227, 6, v232
    v_xor_b32 v227, v227, v226
    v_lshlrev_b32 v227, 4, v227
    v_mul_u32_u24 v228, 128, v225
    v_add_u32 v242, v227, v228
    v_bfe_u32 v229, v224, 2, 2
    v_bfe_u32 v230, v224, 4, 1
    v_and_b32 v231, 3, v224
    v_bfe_u32 v226, v229, 1, 1
    v_lshlrev_b32 v226, 2, v226
    s_mul_i32 s56, s64, 2
    v_lshrrev_b32 v227, 1, v231
    v_lshl_add_u32 v227, v230, 1, v227
    s_add_u32 s57, s56, 0
    s_lshl_b32 s57, s57, 2
    v_add_u32 v227, s57, v227
    v_xor_b32 v227, v227, v226
    v_lshlrev_b32 v227, 4, v227
    v_and_b32 v228, 1, v231
    v_lshl_add_u32 v227, v228, 3, v227
    v_lshl_add_u32 v228, v232, 3, v229
    v_mul_u32_u24 v228, 128, v228
    v_add_u32 v227, v227, v228
    v_add_u32 v243, 16384, v227
    v_lshrrev_b32 v227, 1, v231
    v_lshl_add_u32 v227, v230, 1, v227
    s_add_u32 s57, s56, 1
    s_lshl_b32 s57, s57, 2
    v_add_u32 v227, s57, v227
    v_xor_b32 v227, v227, v226
    v_lshlrev_b32 v227, 4, v227
    v_and_b32 v228, 1, v231
    v_lshl_add_u32 v227, v228, 3, v227
    v_lshl_add_u32 v228, v232, 3, v229
    v_mul_u32_u24 v228, 128, v228
    v_add_u32 v227, v227, v228
    v_add_u32 v244, 16384, v227
    s_mov_b32 s58, s66
    s_mov_b32 s59, s67
    s_add_u32 m0, s60, 0
    s_nop 0
    buffer_load_dwordx4 v233, s[12:15], s58 offen lds
    s_add_u32 m0, s60, 1024
    s_nop 0
    buffer_load_dwordx4 v234, s[12:15], s58 offen lds
    s_add_u32 m0, s60, 2048
    s_nop 0
    buffer_load_dwordx4 v235, s[12:15], s58 offen lds
    s_add_u32 m0, s60, 3072
    s_nop 0
    buffer_load_dwordx4 v236, s[12:15], s58 offen lds
    s_add_u32 m0, s61, 0
    s_nop 0
    buffer_load_dwordx4 v237, s[4:7], s59 offen lds
    s_add_u32 m0, s61, 1024
    s_nop 0
    buffer_load_dwordx4 v238, s[4:7], s59 offen lds
    s_add_u32 s58, s58, 128
    s_add_u32 s59, s59, 8192
    s_and_b32 s58, s58, 4095
    s_and_b32 s59, s59, 262143
    s_add_u32 m0, s60, 24576
    s_nop 0
    buffer_load_dwordx4 v233, s[12:15], s58 offen lds
    s_add_u32 m0, s60, 25600
    s_nop 0
    buffer_load_dwordx4 v234, s[12:15], s58 offen lds
    s_add_u32 m0, s60, 26624
    s_nop 0
    buffer_load_dwordx4 v235, s[12:15], s58 offen lds
    s_add_u32 m0, s60, 27648
    s_nop 0
    buffer_load_dwordx4 v236, s[12:15], s58 offen lds
    s_add_u32 m0, s61, 24576
    s_nop 0
    buffer_load_dwordx4 v237, s[4:7], s59 offen lds
    s_add_u32 m0, s61, 25600
    s_nop 0
    buffer_load_dwordx4 v238, s[4:7], s59 offen lds
    s_add_u32 s58, s58, 128
    s_add_u32 s59, s59, 8192
    s_and_b32 s58, s58, 4095
    s_and_b32 s59, s59, 262143
    s_add_u32 m0, s60, 49152
    s_nop 0
    buffer_load_dwordx4 v233, s[12:15], s58 offen lds
    s_add_u32 m0, s60, 50176
    s_nop 0
    buffer_load_dwordx4 v234, s[12:15], s58 offen lds
    s_add_u32 m0, s60, 51200
    s_nop 0
    buffer_load_dwordx4 v235, s[12:15], s58 offen lds
    s_add_u32 m0, s60, 52224
    s_nop 0
    buffer_load_dwordx4 v236, s[12:15], s58 offen lds
    s_add_u32 m0, s61, 49152
    s_nop 0
    buffer_load_dwordx4 v237, s[4:7], s59 offen lds
    s_add_u32 m0, s61, 50176
    s_nop 0
    buffer_load_dwordx4 v238, s[4:7], s59 offen lds
    s_add_u32 s58, s58, 128
    s_add_u32 s59, s59, 8192
    s_and_b32 s58, s58, 4095
    s_and_b32 s59, s59, 262143
    s_add_u32 m0, s60, 73728
    s_nop 0
    buffer_load_dwordx4 v233, s[12:15], s58 offen lds
    s_add_u32 m0, s60, 74752
    s_nop 0
    buffer_load_dwordx4 v234, s[12:15], s58 offen lds
    s_add_u32 m0, s60, 75776
    s_nop 0
    buffer_load_dwordx4 v235, s[12:15], s58 offen lds
    s_add_u32 m0, s60, 76800
    s_nop 0
    buffer_load_dwordx4 v236, s[12:15], s58 offen lds
    s_add_u32 m0, s61, 73728
    s_nop 0
    buffer_load_dwordx4 v237, s[4:7], s59 offen lds
    s_add_u32 m0, s61, 74752
    s_nop 0
    buffer_load_dwordx4 v238, s[4:7], s59 offen lds
    s_add_u32 s58, s58, 128
    s_add_u32 s59, s59, 8192
    s_and_b32 s58, s58, 4095
    s_and_b32 s59, s59, 262143
    v_bfe_u32 v42, v1, 2, 2
    v_bfe_u32 v43, v1, 4, 1
    v_and_b32 v44, 3, v1
    v_lshrrev_b32 v45, 5, v1
    v_lshrrev_b32 v40, 1, v44
    v_lshl_add_u32 v40, v43, 1, v40
    v_add_u32 v40, 0, v40
    v_lshlrev_b32 v41, 2, v42
    v_xor_b32 v40, v40, v41
    v_lshlrev_b32 v40, 4, v40
    v_and_b32 v41, 1, v44
    v_lshl_add_u32 v40, v41, 3, v40
    v_lshl_add_u32 v41, v45, 3, v42
    v_lshl_add_u32 v40, v41, 10, v40
    v_add_u32 v8, 98304, v40
    v_lshrrev_b32 v40, 1, v44
    v_lshl_add_u32 v40, v43, 1, v40
    v_add_u32 v40, 4, v40
    v_lshlrev_b32 v41, 2, v42
    v_xor_b32 v40, v40, v41
    v_lshlrev_b32 v40, 4, v40
    v_and_b32 v41, 1, v44
    v_lshl_add_u32 v40, v41, 3, v40
    v_lshl_add_u32 v41, v45, 3, v42
    v_lshl_add_u32 v40, v41, 10, v40
    v_add_u32 v9, 98304, v40
    v_lshrrev_b32 v40, 1, v44
    v_lshl_add_u32 v40, v43, 1, v40
    v_add_u32 v40, 8, v40
    v_lshlrev_b32 v41, 2, v42
    v_xor_b32 v40, v40, v41
    v_lshlrev_b32 v40, 4, v40
    v_and_b32 v41, 1, v44
    v_lshl_add_u32 v40, v41, 3, v40
    v_lshl_add_u32 v41, v45, 3, v42
    v_lshl_add_u32 v40, v41, 10, v40
    v_add_u32 v10, 98304, v40
    v_lshrrev_b32 v40, 1, v44
    v_lshl_add_u32 v40, v43, 1, v40
    v_add_u32 v40, 12, v40
    v_lshlrev_b32 v41, 2, v42
    v_xor_b32 v40, v40, v41
    v_lshlrev_b32 v40, 4, v40
    v_and_b32 v41, 1, v44
    v_lshl_add_u32 v40, v41, 3, v40
    v_lshl_add_u32 v41, v45, 3, v42
    v_lshl_add_u32 v40, v41, 10, v40
    v_add_u32 v11, 98304, v40
    s_lshl_b32 s32, s26, 2
    s_add_u32 s32, s32, s24
    s_mul_i32 s32, s32, 28672
    v_lshlrev_b32 v12, 4, v1
    v_add_u32 v12, s32, v12
    v_accvgpr_read_b32 v112, a0
    v_accvgpr_read_b32 v113, a1
    v_accvgpr_read_b32 v114, a2
    v_accvgpr_read_b32 v115, a3
    v_accvgpr_read_b32 v116, a4
    v_accvgpr_read_b32 v117, a5
    v_accvgpr_read_b32 v118, a6
    v_accvgpr_read_b32 v119, a7
    v_accvgpr_read_b32 v120, a8
    v_accvgpr_read_b32 v121, a9
    v_accvgpr_read_b32 v122, a10
    v_accvgpr_read_b32 v123, a11
    v_accvgpr_read_b32 v124, a12
    v_accvgpr_read_b32 v125, a13
    v_accvgpr_read_b32 v126, a14
    v_accvgpr_read_b32 v127, a15
    v_mul_f32 v112, v112, v37
    v_mul_f32 v113, v113, v37
    v_mul_f32 v114, v114, v37
    v_mul_f32 v115, v115, v37
    v_mul_f32 v116, v116, v37
    v_mul_f32 v117, v117, v37
    v_mul_f32 v118, v118, v37
    v_mul_f32 v119, v119, v37
    v_mul_f32 v120, v120, v37
    v_mul_f32 v121, v121, v37
    v_mul_f32 v122, v122, v37
    v_mul_f32 v123, v123, v37
    v_mul_f32 v124, v124, v37
    v_mul_f32 v125, v125, v37
    v_mul_f32 v126, v126, v37
    v_mul_f32 v127, v127, v37
    v_cvt_pk_bf16_f32 v48, v112, v113
    v_cvt_pk_bf16_f32 v49, v114, v115
    v_cvt_pk_bf16_f32 v50, v116, v117
    v_cvt_pk_bf16_f32 v51, v118, v119
    v_cvt_pk_bf16_f32 v52, v120, v121
    v_cvt_pk_bf16_f32 v53, v122, v123
    v_cvt_pk_bf16_f32 v54, v124, v125
    v_cvt_pk_bf16_f32 v55, v126, v127
    v_accvgpr_read_b32 v128, a16
    v_accvgpr_read_b32 v129, a17
    v_accvgpr_read_b32 v130, a18
    v_accvgpr_read_b32 v131, a19
    v_accvgpr_read_b32 v132, a20
    v_accvgpr_read_b32 v133, a21
    v_accvgpr_read_b32 v134, a22
    v_accvgpr_read_b32 v135, a23
    v_accvgpr_read_b32 v136, a24
    v_accvgpr_read_b32 v137, a25
    v_accvgpr_read_b32 v138, a26
    v_accvgpr_read_b32 v139, a27
    v_accvgpr_read_b32 v140, a28
    v_accvgpr_read_b32 v141, a29
    v_accvgpr_read_b32 v142, a30
    v_accvgpr_read_b32 v143, a31
    v_mul_f32 v128, v128, v37
    v_mul_f32 v129, v129, v37
    v_mul_f32 v130, v130, v37
    v_mul_f32 v131, v131, v37
    v_mul_f32 v132, v132, v37
    v_mul_f32 v133, v133, v37
    v_mul_f32 v134, v134, v37
    v_mul_f32 v135, v135, v37
    v_mul_f32 v136, v136, v37
    v_mul_f32 v137, v137, v37
    v_mul_f32 v138, v138, v37
    v_mul_f32 v139, v139, v37
    v_mul_f32 v140, v140, v37
    v_mul_f32 v141, v141, v37
    v_mul_f32 v142, v142, v37
    v_mul_f32 v143, v143, v37
    v_cvt_pk_bf16_f32 v56, v128, v129
    v_cvt_pk_bf16_f32 v57, v130, v131
    v_cvt_pk_bf16_f32 v58, v132, v133
    v_cvt_pk_bf16_f32 v59, v134, v135
    v_cvt_pk_bf16_f32 v60, v136, v137
    v_cvt_pk_bf16_f32 v61, v138, v139
    v_cvt_pk_bf16_f32 v62, v140, v141
    v_cvt_pk_bf16_f32 v63, v142, v143
    v_accvgpr_read_b32 v112, a32
    v_accvgpr_read_b32 v113, a33
    v_accvgpr_read_b32 v114, a34
    v_accvgpr_read_b32 v115, a35
    v_accvgpr_read_b32 v116, a36
    v_accvgpr_read_b32 v117, a37
    v_accvgpr_read_b32 v118, a38
    v_accvgpr_read_b32 v119, a39
    v_accvgpr_read_b32 v120, a40
    v_accvgpr_read_b32 v121, a41
    v_accvgpr_read_b32 v122, a42
    v_accvgpr_read_b32 v123, a43
    v_accvgpr_read_b32 v124, a44
    v_accvgpr_read_b32 v125, a45
    v_accvgpr_read_b32 v126, a46
    v_accvgpr_read_b32 v127, a47
    v_mul_f32 v112, v112, v37
    v_mul_f32 v113, v113, v37
    v_mul_f32 v114, v114, v37
    v_mul_f32 v115, v115, v37
    v_mul_f32 v116, v116, v37
    v_mul_f32 v117, v117, v37
    v_mul_f32 v118, v118, v37
    v_mul_f32 v119, v119, v37
    v_mul_f32 v120, v120, v37
    v_mul_f32 v121, v121, v37
    v_mul_f32 v122, v122, v37
    v_mul_f32 v123, v123, v37
    v_mul_f32 v124, v124, v37
    v_mul_f32 v125, v125, v37
    v_mul_f32 v126, v126, v37
    v_mul_f32 v127, v127, v37
    v_cvt_pk_bf16_f32 v64, v112, v113
    v_cvt_pk_bf16_f32 v65, v114, v115
    v_cvt_pk_bf16_f32 v66, v116, v117
    v_cvt_pk_bf16_f32 v67, v118, v119
    v_cvt_pk_bf16_f32 v68, v120, v121
    v_cvt_pk_bf16_f32 v69, v122, v123
    v_cvt_pk_bf16_f32 v70, v124, v125
    v_cvt_pk_bf16_f32 v71, v126, v127
    v_accvgpr_read_b32 v128, a48
    v_accvgpr_read_b32 v129, a49
    v_accvgpr_read_b32 v130, a50
    v_accvgpr_read_b32 v131, a51
    v_accvgpr_read_b32 v132, a52
    v_accvgpr_read_b32 v133, a53
    v_accvgpr_read_b32 v134, a54
    v_accvgpr_read_b32 v135, a55
    v_accvgpr_read_b32 v136, a56
    v_accvgpr_read_b32 v137, a57
    v_accvgpr_read_b32 v138, a58
    v_accvgpr_read_b32 v139, a59
    v_accvgpr_read_b32 v140, a60
    v_accvgpr_read_b32 v141, a61
    v_accvgpr_read_b32 v142, a62
    v_accvgpr_read_b32 v143, a63
    v_mul_f32 v128, v128, v37
    v_mul_f32 v129, v129, v37
    v_mul_f32 v130, v130, v37
    v_mul_f32 v131, v131, v37
    v_mul_f32 v132, v132, v37
    v_mul_f32 v133, v133, v37
    v_mul_f32 v134, v134, v37
    v_mul_f32 v135, v135, v37
    v_mul_f32 v136, v136, v37
    v_mul_f32 v137, v137, v37
    v_mul_f32 v138, v138, v37
    v_mul_f32 v139, v139, v37
    v_mul_f32 v140, v140, v37
    v_mul_f32 v141, v141, v37
    v_mul_f32 v142, v142, v37
    v_mul_f32 v143, v143, v37
    v_cvt_pk_bf16_f32 v72, v128, v129
    v_cvt_pk_bf16_f32 v73, v130, v131
    v_cvt_pk_bf16_f32 v74, v132, v133
    v_cvt_pk_bf16_f32 v75, v134, v135
    v_cvt_pk_bf16_f32 v76, v136, v137
    v_cvt_pk_bf16_f32 v77, v138, v139
    v_cvt_pk_bf16_f32 v78, v140, v141
    v_cvt_pk_bf16_f32 v79, v142, v143
    v_accvgpr_read_b32 v112, a64
    v_accvgpr_read_b32 v113, a65
    v_accvgpr_read_b32 v114, a66
    v_accvgpr_read_b32 v115, a67
    v_accvgpr_read_b32 v116, a68
    v_accvgpr_read_b32 v117, a69
    v_accvgpr_read_b32 v118, a70
    v_accvgpr_read_b32 v119, a71
    v_accvgpr_read_b32 v120, a72
    v_accvgpr_read_b32 v121, a73
    v_accvgpr_read_b32 v122, a74
    v_accvgpr_read_b32 v123, a75
    v_accvgpr_read_b32 v124, a76
    v_accvgpr_read_b32 v125, a77
    v_accvgpr_read_b32 v126, a78
    v_accvgpr_read_b32 v127, a79
    v_mul_f32 v112, v112, v37
    v_mul_f32 v113, v113, v37
    v_mul_f32 v114, v114, v37
    v_mul_f32 v115, v115, v37
    v_mul_f32 v116, v116, v37
    v_mul_f32 v117, v117, v37
    v_mul_f32 v118, v118, v37
    v_mul_f32 v119, v119, v37
    v_mul_f32 v120, v120, v37
    v_mul_f32 v121, v121, v37
    v_mul_f32 v122, v122, v37
    v_mul_f32 v123, v123, v37
    v_mul_f32 v124, v124, v37
    v_mul_f32 v125, v125, v37
    v_mul_f32 v126, v126, v37
    v_mul_f32 v127, v127, v37
    v_cvt_pk_bf16_f32 v80, v112, v113
    v_cvt_pk_bf16_f32 v81, v114, v115
    v_cvt_pk_bf16_f32 v82, v116, v117
    v_cvt_pk_bf16_f32 v83, v118, v119
    v_cvt_pk_bf16_f32 v84, v120, v121
    v_cvt_pk_bf16_f32 v85, v122, v123
    v_cvt_pk_bf16_f32 v86, v124, v125
    v_cvt_pk_bf16_f32 v87, v126, v127
    v_accvgpr_read_b32 v128, a80
    v_accvgpr_read_b32 v129, a81
    v_accvgpr_read_b32 v130, a82
    v_accvgpr_read_b32 v131, a83
    v_accvgpr_read_b32 v132, a84
    v_accvgpr_read_b32 v133, a85
    v_accvgpr_read_b32 v134, a86
    v_accvgpr_read_b32 v135, a87
    v_accvgpr_read_b32 v136, a88
    v_accvgpr_read_b32 v137, a89
    v_accvgpr_read_b32 v138, a90
    v_accvgpr_read_b32 v139, a91
    v_accvgpr_read_b32 v140, a92
    v_accvgpr_read_b32 v141, a93
    v_accvgpr_read_b32 v142, a94
    v_accvgpr_read_b32 v143, a95
    v_mul_f32 v128, v128, v37
    v_mul_f32 v129, v129, v37
    v_mul_f32 v130, v130, v37
    v_mul_f32 v131, v131, v37
    v_mul_f32 v132, v132, v37
    v_mul_f32 v133, v133, v37
    v_mul_f32 v134, v134, v37
    v_mul_f32 v135, v135, v37
    v_mul_f32 v136, v136, v37
    v_mul_f32 v137, v137, v37
    v_mul_f32 v138, v138, v37
    v_mul_f32 v139, v139, v37
    v_mul_f32 v140, v140, v37
    v_mul_f32 v141, v141, v37
    v_mul_f32 v142, v142, v37
    v_mul_f32 v143, v143, v37
    v_cvt_pk_bf16_f32 v88, v128, v129
    v_cvt_pk_bf16_f32 v89, v130, v131
    v_cvt_pk_bf16_f32 v90, v132, v133
    v_cvt_pk_bf16_f32 v91, v134, v135
    v_cvt_pk_bf16_f32 v92, v136, v137
    v_cvt_pk_bf16_f32 v93, v138, v139
    v_cvt_pk_bf16_f32 v94, v140, v141
    v_cvt_pk_bf16_f32 v95, v142, v143
    v_accvgpr_read_b32 v112, a96
    v_accvgpr_read_b32 v113, a97
    v_accvgpr_read_b32 v114, a98
    v_accvgpr_read_b32 v115, a99
    v_accvgpr_read_b32 v116, a100
    v_accvgpr_read_b32 v117, a101
    v_accvgpr_read_b32 v118, a102
    v_accvgpr_read_b32 v119, a103
    v_accvgpr_read_b32 v120, a104
    v_accvgpr_read_b32 v121, a105
    v_accvgpr_read_b32 v122, a106
    v_accvgpr_read_b32 v123, a107
    v_accvgpr_read_b32 v124, a108
    v_accvgpr_read_b32 v125, a109
    v_accvgpr_read_b32 v126, a110
    v_accvgpr_read_b32 v127, a111
    v_mul_f32 v112, v112, v37
    v_mul_f32 v113, v113, v37
    v_mul_f32 v114, v114, v37
    v_mul_f32 v115, v115, v37
    v_mul_f32 v116, v116, v37
    v_mul_f32 v117, v117, v37
    v_mul_f32 v118, v118, v37
    v_mul_f32 v119, v119, v37
    v_mul_f32 v120, v120, v37
    v_mul_f32 v121, v121, v37
    v_mul_f32 v122, v122, v37
    v_mul_f32 v123, v123, v37
    v_mul_f32 v124, v124, v37
    v_mul_f32 v125, v125, v37
    v_mul_f32 v126, v126, v37
    v_mul_f32 v127, v127, v37
    v_cvt_pk_bf16_f32 v96, v112, v113
    v_cvt_pk_bf16_f32 v97, v114, v115
    v_cvt_pk_bf16_f32 v98, v116, v117
    v_cvt_pk_bf16_f32 v99, v118, v119
    v_cvt_pk_bf16_f32 v100, v120, v121
    v_cvt_pk_bf16_f32 v101, v122, v123
    v_cvt_pk_bf16_f32 v102, v124, v125
    v_cvt_pk_bf16_f32 v103, v126, v127
    v_accvgpr_read_b32 v128, a112
    v_accvgpr_read_b32 v129, a113
    v_accvgpr_read_b32 v130, a114
    v_accvgpr_read_b32 v131, a115
    v_accvgpr_read_b32 v132, a116
    v_accvgpr_read_b32 v133, a117
    v_accvgpr_read_b32 v134, a118
    v_accvgpr_read_b32 v135, a119
    v_accvgpr_read_b32 v136, a120
    v_accvgpr_read_b32 v137, a121
    v_accvgpr_read_b32 v138, a122
    v_accvgpr_read_b32 v139, a123
    v_accvgpr_read_b32 v140, a124
    v_accvgpr_read_b32 v141, a125
    v_accvgpr_read_b32 v142, a126
    v_accvgpr_read_b32 v143, a127
    v_mul_f32 v128, v128, v37
    v_mul_f32 v129, v129, v37
    v_mul_f32 v130, v130, v37
    v_mul_f32 v131, v131, v37
    v_mul_f32 v132, v132, v37
    v_mul_f32 v133, v133, v37
    v_mul_f32 v134, v134, v37
    v_mul_f32 v135, v135, v37
    v_mul_f32 v136, v136, v37
    v_mul_f32 v137, v137, v37
    v_mul_f32 v138, v138, v37
    v_mul_f32 v139, v139, v37
    v_mul_f32 v140, v140, v37
    v_mul_f32 v141, v141, v37
    v_mul_f32 v142, v142, v37
    v_mul_f32 v143, v143, v37
    v_cvt_pk_bf16_f32 v104, v128, v129
    v_cvt_pk_bf16_f32 v105, v130, v131
    v_cvt_pk_bf16_f32 v106, v132, v133
    v_cvt_pk_bf16_f32 v107, v134, v135
    v_cvt_pk_bf16_f32 v108, v136, v137
    v_cvt_pk_bf16_f32 v109, v138, v139
    v_cvt_pk_bf16_f32 v110, v140, v141
    v_cvt_pk_bf16_f32 v111, v142, v143
    s_waitcnt vmcnt(36)
    s_barrier
    ds_read_b64_tr_b16 v[112:113], v8 offset:32768
    ds_read_b64_tr_b16 v[114:115], v8 offset:36864
    ds_read_b64_tr_b16 v[116:117], v9 offset:32768
    ds_read_b64_tr_b16 v[118:119], v9 offset:36864
    ds_read_b64_tr_b16 v[120:121], v10 offset:32768
    ds_read_b64_tr_b16 v[122:123], v10 offset:36864
    ds_read_b64_tr_b16 v[124:125], v11 offset:32768
    ds_read_b64_tr_b16 v[126:127], v11 offset:36864
    ds_read_b64_tr_b16 v[128:129], v8 offset:33024
    ds_read_b64_tr_b16 v[130:131], v8 offset:37120
    ds_read_b64_tr_b16 v[132:133], v9 offset:33024
    ds_read_b64_tr_b16 v[134:135], v9 offset:37120
    ds_read_b64_tr_b16 v[136:137], v10 offset:33024
    ds_read_b64_tr_b16 v[138:139], v10 offset:37120
    ds_read_b64_tr_b16 v[140:141], v11 offset:33024
    ds_read_b64_tr_b16 v[142:143], v11 offset:37120
    ds_read_b64_tr_b16 v[144:145], v8 offset:33280
    ds_read_b64_tr_b16 v[146:147], v8 offset:37376
    ds_read_b64_tr_b16 v[148:149], v9 offset:33280
    ds_read_b64_tr_b16 v[150:151], v9 offset:37376
    ds_read_b64_tr_b16 v[152:153], v10 offset:33280
    ds_read_b64_tr_b16 v[154:155], v10 offset:37376
    ds_read_b64_tr_b16 v[156:157], v11 offset:33280
    ds_read_b64_tr_b16 v[158:159], v11 offset:37376
    ds_read_b64_tr_b16 v[160:161], v8 offset:33536
    ds_read_b64_tr_b16 v[162:163], v8 offset:37632
    ds_read_b64_tr_b16 v[164:165], v9 offset:33536
    ds_read_b64_tr_b16 v[166:167], v9 offset:37632
    s_waitcnt vmcnt(32) lgkmcnt(0)
    s_barrier
    s_mov_b32 s28, 57344
    v_mfma_f32_32x32x16_bf16 a[0:15], v[112:115], v[48:51], 0
    ds_read_b64_tr_b16 v[168:169], v8 offset:49152
    ds_read_b64_tr_b16 v[170:171], v8 offset:53248
    ds_read_b64_tr_b16 v[172:173], v9 offset:49152
    v_mfma_f32_32x32x16_bf16 a[16:31], v[116:119], v[48:51], 0
    ds_read_b64_tr_b16 v[174:175], v9 offset:53248
    ds_read_b64_tr_b16 v[176:177], v10 offset:49152
    ds_read_b64_tr_b16 v[178:179], v10 offset:53248
    v_mfma_f32_32x32x16_bf16 a[32:47], v[120:123], v[48:51], 0
    ds_read_b64_tr_b16 v[180:181], v11 offset:49152
    ds_read_b64_tr_b16 v[182:183], v11 offset:53248
    ds_read_b64_tr_b16 v[184:185], v8 offset:49408
    s_add_u32 m0, s27, 131072
    s_nop 0
    buffer_load_dwordx4 v4, s[16:19], s28 offen lds
    v_mfma_f32_32x32x16_bf16 a[48:63], v[124:127], v[48:51], 0
    ds_read_b64_tr_b16 v[186:187], v8 offset:53504
    ds_read_b64_tr_b16 v[188:189], v9 offset:49408
    ds_read_b64_tr_b16 v[190:191], v9 offset:53504
    v_mfma_f32_32x32x16_bf16 a[64:79], v[128:131], v[48:51], 0
    ds_read_b64_tr_b16 v[192:193], v10 offset:49408
    ds_read_b64_tr_b16 v[194:195], v10 offset:53504
    ds_read_b64_tr_b16 v[196:197], v11 offset:49408
    s_add_u32 m0, s27, 132096
    s_nop 0
    buffer_load_dwordx4 v5, s[16:19], s28 offen lds
    v_mfma_f32_32x32x16_bf16 a[80:95], v[132:135], v[48:51], 0
    ds_read_b64_tr_b16 v[198:199], v11 offset:53504
    ds_read_b64_tr_b16 v[200:201], v8 offset:49664
    ds_read_b64_tr_b16 v[202:203], v8 offset:53760
    v_mfma_f32_32x32x16_bf16 a[96:111], v[136:139], v[48:51], 0
    ds_read_b64_tr_b16 v[204:205], v9 offset:49664
    ds_read_b64_tr_b16 v[206:207], v9 offset:53760
    ds_read_b64_tr_b16 v[208:209], v10 offset:49664
    s_add_u32 m0, s27, 133120
    s_nop 0
    buffer_load_dwordx4 v6, s[16:19], s28 offen lds
    v_mfma_f32_32x32x16_bf16 a[112:127], v[140:143], v[48:51], 0
    ds_read_b64_tr_b16 v[210:211], v10 offset:53760
    ds_read_b64_tr_b16 v[212:213], v11 offset:49664
    ds_read_b64_tr_b16 v[214:215], v11 offset:53760
    v_mfma_f32_32x32x16_bf16 a[128:143], v[144:147], v[48:51], 0
    ds_read_b64_tr_b16 v[216:217], v8 offset:49920
    ds_read_b64_tr_b16 v[218:219], v8 offset:54016
    ds_read_b64_tr_b16 v[220:221], v9 offset:49920
    s_add_u32 m0, s27, 134144
    s_nop 0
    buffer_load_dwordx4 v7, s[16:19], s28 offen lds
    v_mfma_f32_32x32x16_bf16 a[144:159], v[148:151], v[48:51], 0
    ds_read_b64_tr_b16 v[222:223], v9 offset:54016
    v_mfma_f32_32x32x16_bf16 a[160:175], v[152:155], v[48:51], 0
    v_mfma_f32_32x32x16_bf16 a[176:191], v[156:159], v[48:51], 0
    v_mfma_f32_32x32x16_bf16 a[192:207], v[160:163], v[48:51], 0
    v_mfma_f32_32x32x16_bf16 a[208:223], v[164:167], v[48:51], 0
    s_waitcnt vmcnt(32) lgkmcnt(0)
    s_barrier
    s_mov_b32 s28, 71680
    v_mfma_f32_32x32x16_bf16 a[0:15], v[168:171], v[52:55], a[0:15]
    ds_read_b64_tr_b16 v[112:113], v8 offset:0
    ds_read_b64_tr_b16 v[114:115], v8 offset:4096
    ds_read_b64_tr_b16 v[116:117], v9 offset:0
    v_mfma_f32_32x32x16_bf16 a[16:31], v[172:175], v[52:55], a[16:31]
    ds_read_b64_tr_b16 v[118:119], v9 offset:4096
    ds_read_b64_tr_b16 v[120:121], v10 offset:0
    ds_read_b64_tr_b16 v[122:123], v10 offset:4096
    v_mfma_f32_32x32x16_bf16 a[32:47], v[176:179], v[52:55], a[32:47]
    ds_read_b64_tr_b16 v[124:125], v11 offset:0
    ds_read_b64_tr_b16 v[126:127], v11 offset:4096
    ds_read_b64_tr_b16 v[128:129], v8 offset:256
    s_add_u32 m0, s27, 147456
    s_nop 0
    buffer_load_dwordx4 v4, s[16:19], s28 offen lds
    v_mfma_f32_32x32x16_bf16 a[48:63], v[180:183], v[52:55], a[48:63]
    ds_read_b64_tr_b16 v[130:131], v8 offset:4352
    ds_read_b64_tr_b16 v[132:133], v9 offset:256
    ds_read_b64_tr_b16 v[134:135], v9 offset:4352
    v_mfma_f32_32x32x16_bf16 a[64:79], v[184:187], v[52:55], a[64:79]
    ds_read_b64_tr_b16 v[136:137], v10 offset:256
    ds_read_b64_tr_b16 v[138:139], v10 offset:4352
    ds_read_b64_tr_b16 v[140:141], v11 offset:256
    s_add_u32 m0, s27, 148480
    s_nop 0
    buffer_load_dwordx4 v5, s[16:19], s28 offen lds
    v_mfma_f32_32x32x16_bf16 a[80:95], v[188:191], v[52:55], a[80:95]
    ds_read_b64_tr_b16 v[142:143], v11 offset:4352
    ds_read_b64_tr_b16 v[144:145], v8 offset:512
    ds_read_b64_tr_b16 v[146:147], v8 offset:4608
    v_mfma_f32_32x32x16_bf16 a[96:111], v[192:195], v[52:55], a[96:111]
    ds_read_b64_tr_b16 v[148:149], v9 offset:512
    ds_read_b64_tr_b16 v[150:151], v9 offset:4608
    ds_read_b64_tr_b16 v[152:153], v10 offset:512
    s_add_u32 m0, s27, 149504
    s_nop 0
    buffer_load_dwordx4 v6, s[16:19], s28 offen lds
    v_mfma_f32_32x32x16_bf16 a[112:127], v[196:199], v[52:55], a[112:127]
    ds_read_b64_tr_b16 v[154:155], v10 offset:4608
    ds_read_b64_tr_b16 v[156:157], v11 offset:512
    ds_read_b64_tr_b16 v[158:159], v11 offset:4608
    v_mfma_f32_32x32x16_bf16 a[128:143], v[200:203], v[52:55], a[128:143]
    ds_read_b64_tr_b16 v[160:161], v8 offset:768
    ds_read_b64_tr_b16 v[162:163], v8 offset:4864
    ds_read_b64_tr_b16 v[164:165], v9 offset:768
    s_add_u32 m0, s27, 150528
    s_nop 0
    buffer_load_dwordx4 v7, s[16:19], s28 offen lds
    v_mfma_f32_32x32x16_bf16 a[144:159], v[204:207], v[52:55], a[144:159]
    ds_read_b64_tr_b16 v[166:167], v9 offset:4864
    v_mfma_f32_32x32x16_bf16 a[160:175], v[208:211], v[52:55], a[160:175]
    v_mfma_f32_32x32x16_bf16 a[176:191], v[212:215], v[52:55], a[176:191]
    v_mfma_f32_32x32x16_bf16 a[192:207], v[216:219], v[52:55], a[192:207]
    v_mfma_f32_32x32x16_bf16 a[208:223], v[220:223], v[52:55], a[208:223]
    s_waitcnt vmcnt(32) lgkmcnt(0)
    s_barrier
    s_mov_b32 s28, 86016
    v_mfma_f32_32x32x16_bf16 a[0:15], v[112:115], v[56:59], a[0:15]
    ds_read_b64_tr_b16 v[168:169], v8 offset:16384
    ds_read_b64_tr_b16 v[170:171], v8 offset:20480
    ds_read_b64_tr_b16 v[172:173], v9 offset:16384
    v_mfma_f32_32x32x16_bf16 a[16:31], v[116:119], v[56:59], a[16:31]
    ds_read_b64_tr_b16 v[174:175], v9 offset:20480
    ds_read_b64_tr_b16 v[176:177], v10 offset:16384
    ds_read_b64_tr_b16 v[178:179], v10 offset:20480
    v_mfma_f32_32x32x16_bf16 a[32:47], v[120:123], v[56:59], a[32:47]
    ds_read_b64_tr_b16 v[180:181], v11 offset:16384
    ds_read_b64_tr_b16 v[182:183], v11 offset:20480
    ds_read_b64_tr_b16 v[184:185], v8 offset:16640
    s_add_u32 m0, s27, 98304
    s_nop 0
    buffer_load_dwordx4 v4, s[16:19], s28 offen lds
    v_mfma_f32_32x32x16_bf16 a[48:63], v[124:127], v[56:59], a[48:63]
    ds_read_b64_tr_b16 v[186:187], v8 offset:20736
    ds_read_b64_tr_b16 v[188:189], v9 offset:16640
    ds_read_b64_tr_b16 v[190:191], v9 offset:20736
    v_mfma_f32_32x32x16_bf16 a[64:79], v[128:131], v[56:59], a[64:79]
    ds_read_b64_tr_b16 v[192:193], v10 offset:16640
    ds_read_b64_tr_b16 v[194:195], v10 offset:20736
    ds_read_b64_tr_b16 v[196:197], v11 offset:16640
    s_add_u32 m0, s27, 99328
    s_nop 0
    buffer_load_dwordx4 v5, s[16:19], s28 offen lds
    v_mfma_f32_32x32x16_bf16 a[80:95], v[132:135], v[56:59], a[80:95]
    ds_read_b64_tr_b16 v[198:199], v11 offset:20736
    ds_read_b64_tr_b16 v[200:201], v8 offset:16896
    ds_read_b64_tr_b16 v[202:203], v8 offset:20992
    v_mfma_f32_32x32x16_bf16 a[96:111], v[136:139], v[56:59], a[96:111]
    ds_read_b64_tr_b16 v[204:205], v9 offset:16896
    ds_read_b64_tr_b16 v[206:207], v9 offset:20992
    ds_read_b64_tr_b16 v[208:209], v10 offset:16896
    s_add_u32 m0, s27, 100352
    s_nop 0
    buffer_load_dwordx4 v6, s[16:19], s28 offen lds
    v_mfma_f32_32x32x16_bf16 a[112:127], v[140:143], v[56:59], a[112:127]
    ds_read_b64_tr_b16 v[210:211], v10 offset:20992
    ds_read_b64_tr_b16 v[212:213], v11 offset:16896
    ds_read_b64_tr_b16 v[214:215], v11 offset:20992
    v_mfma_f32_32x32x16_bf16 a[128:143], v[144:147], v[56:59], a[128:143]
    ds_read_b64_tr_b16 v[216:217], v8 offset:17152
    ds_read_b64_tr_b16 v[218:219], v8 offset:21248
    ds_read_b64_tr_b16 v[220:221], v9 offset:17152
    s_add_u32 m0, s27, 101376
    s_nop 0
    buffer_load_dwordx4 v7, s[16:19], s28 offen lds
    v_mfma_f32_32x32x16_bf16 a[144:159], v[148:151], v[56:59], a[144:159]
    ds_read_b64_tr_b16 v[222:223], v9 offset:21248
    v_mfma_f32_32x32x16_bf16 a[160:175], v[152:155], v[56:59], a[160:175]
    v_mfma_f32_32x32x16_bf16 a[176:191], v[156:159], v[56:59], a[176:191]
    v_mfma_f32_32x32x16_bf16 a[192:207], v[160:163], v[56:59], a[192:207]
    v_mfma_f32_32x32x16_bf16 a[208:223], v[164:167], v[56:59], a[208:223]
    s_waitcnt vmcnt(8) lgkmcnt(0)
    s_barrier
    s_mov_b32 s28, 100352
    v_mfma_f32_32x32x16_bf16 a[0:15], v[168:171], v[60:63], a[0:15]
    ds_read_b64_tr_b16 v[112:113], v8 offset:32768
    ds_read_b64_tr_b16 v[114:115], v8 offset:36864
    ds_read_b64_tr_b16 v[116:117], v9 offset:32768
    v_mfma_f32_32x32x16_bf16 a[16:31], v[172:175], v[60:63], a[16:31]
    ds_read_b64_tr_b16 v[118:119], v9 offset:36864
    ds_read_b64_tr_b16 v[120:121], v10 offset:32768
    ds_read_b64_tr_b16 v[122:123], v10 offset:36864
    v_mfma_f32_32x32x16_bf16 a[32:47], v[176:179], v[60:63], a[32:47]
    ds_read_b64_tr_b16 v[124:125], v11 offset:32768
    ds_read_b64_tr_b16 v[126:127], v11 offset:36864
    ds_read_b64_tr_b16 v[128:129], v8 offset:33024
    s_add_u32 m0, s27, 114688
    s_nop 0
    buffer_load_dwordx4 v4, s[16:19], s28 offen lds
    v_mfma_f32_32x32x16_bf16 a[48:63], v[180:183], v[60:63], a[48:63]
    ds_read_b64_tr_b16 v[130:131], v8 offset:37120
    ds_read_b64_tr_b16 v[132:133], v9 offset:33024
    ds_read_b64_tr_b16 v[134:135], v9 offset:37120
    v_mfma_f32_32x32x16_bf16 a[64:79], v[184:187], v[60:63], a[64:79]
    ds_read_b64_tr_b16 v[136:137], v10 offset:33024
    ds_read_b64_tr_b16 v[138:139], v10 offset:37120
    ds_read_b64_tr_b16 v[140:141], v11 offset:33024
    s_add_u32 m0, s27, 115712
    s_nop 0
    buffer_load_dwordx4 v5, s[16:19], s28 offen lds
    v_mfma_f32_32x32x16_bf16 a[80:95], v[188:191], v[60:63], a[80:95]
    ds_read_b64_tr_b16 v[142:143], v11 offset:37120
    ds_read_b64_tr_b16 v[144:145], v8 offset:33280
    ds_read_b64_tr_b16 v[146:147], v8 offset:37376
    v_mfma_f32_32x32x16_bf16 a[96:111], v[192:195], v[60:63], a[96:111]
    ds_read_b64_tr_b16 v[148:149], v9 offset:33280
    ds_read_b64_tr_b16 v[150:151], v9 offset:37376
    ds_read_b64_tr_b16 v[152:153], v10 offset:33280
    s_add_u32 m0, s27, 116736
    s_nop 0
    buffer_load_dwordx4 v6, s[16:19], s28 offen lds
    v_mfma_f32_32x32x16_bf16 a[112:127], v[196:199], v[60:63], a[112:127]
    ds_read_b64_tr_b16 v[154:155], v10 offset:37376
    ds_read_b64_tr_b16 v[156:157], v11 offset:33280
    ds_read_b64_tr_b16 v[158:159], v11 offset:37376
    v_mfma_f32_32x32x16_bf16 a[128:143], v[200:203], v[60:63], a[128:143]
    ds_read_b64_tr_b16 v[160:161], v8 offset:33536
    ds_read_b64_tr_b16 v[162:163], v8 offset:37632
    ds_read_b64_tr_b16 v[164:165], v9 offset:33536
    s_add_u32 m0, s27, 117760
    s_nop 0
    buffer_load_dwordx4 v7, s[16:19], s28 offen lds
    v_mfma_f32_32x32x16_bf16 a[144:159], v[204:207], v[60:63], a[144:159]
    ds_read_b64_tr_b16 v[166:167], v9 offset:37632
    v_mfma_f32_32x32x16_bf16 a[160:175], v[208:211], v[60:63], a[160:175]
    v_mfma_f32_32x32x16_bf16 a[176:191], v[212:215], v[60:63], a[176:191]
    v_mfma_f32_32x32x16_bf16 a[192:207], v[216:219], v[60:63], a[192:207]
    v_mfma_f32_32x32x16_bf16 a[208:223], v[220:223], v[60:63], a[208:223]
    s_waitcnt vmcnt(8) lgkmcnt(0)
    s_barrier
    s_mov_b32 s28, 114688
    v_mfma_f32_32x32x16_bf16 a[0:15], v[112:115], v[64:67], a[0:15]
    ds_read_b64_tr_b16 v[168:169], v8 offset:49152
    ds_read_b64_tr_b16 v[170:171], v8 offset:53248
    ds_read_b64_tr_b16 v[172:173], v9 offset:49152
    v_mfma_f32_32x32x16_bf16 a[16:31], v[116:119], v[64:67], a[16:31]
    ds_read_b64_tr_b16 v[174:175], v9 offset:53248
    ds_read_b64_tr_b16 v[176:177], v10 offset:49152
    ds_read_b64_tr_b16 v[178:179], v10 offset:53248
    v_mfma_f32_32x32x16_bf16 a[32:47], v[120:123], v[64:67], a[32:47]
    ds_read_b64_tr_b16 v[180:181], v11 offset:49152
    ds_read_b64_tr_b16 v[182:183], v11 offset:53248
    ds_read_b64_tr_b16 v[184:185], v8 offset:49408
    s_add_u32 m0, s27, 131072
    s_nop 0
    buffer_load_dwordx4 v4, s[16:19], s28 offen lds
    v_mfma_f32_32x32x16_bf16 a[48:63], v[124:127], v[64:67], a[48:63]
    ds_read_b64_tr_b16 v[186:187], v8 offset:53504
    ds_read_b64_tr_b16 v[188:189], v9 offset:49408
    ds_read_b64_tr_b16 v[190:191], v9 offset:53504
    v_mfma_f32_32x32x16_bf16 a[64:79], v[128:131], v[64:67], a[64:79]
    ds_read_b64_tr_b16 v[192:193], v10 offset:49408
    ds_read_b64_tr_b16 v[194:195], v10 offset:53504
    ds_read_b64_tr_b16 v[196:197], v11 offset:49408
    s_add_u32 m0, s27, 132096
    s_nop 0
    buffer_load_dwordx4 v5, s[16:19], s28 offen lds
    v_mfma_f32_32x32x16_bf16 a[80:95], v[132:135], v[64:67], a[80:95]
    ds_read_b64_tr_b16 v[198:199], v11 offset:53504
    ds_read_b64_tr_b16 v[200:201], v8 offset:49664
    ds_read_b64_tr_b16 v[202:203], v8 offset:53760
    v_mfma_f32_32x32x16_bf16 a[96:111], v[136:139], v[64:67], a[96:111]
    ds_read_b64_tr_b16 v[204:205], v9 offset:49664
    ds_read_b64_tr_b16 v[206:207], v9 offset:53760
    ds_read_b64_tr_b16 v[208:209], v10 offset:49664
    s_add_u32 m0, s27, 133120
    s_nop 0
    buffer_load_dwordx4 v6, s[16:19], s28 offen lds
    v_mfma_f32_32x32x16_bf16 a[112:127], v[140:143], v[64:67], a[112:127]
    ds_read_b64_tr_b16 v[210:211], v10 offset:53760
    ds_read_b64_tr_b16 v[212:213], v11 offset:49664
    ds_read_b64_tr_b16 v[214:215], v11 offset:53760
    v_mfma_f32_32x32x16_bf16 a[128:143], v[144:147], v[64:67], a[128:143]
    ds_read_b64_tr_b16 v[216:217], v8 offset:49920
    ds_read_b64_tr_b16 v[218:219], v8 offset:54016
    ds_read_b64_tr_b16 v[220:221], v9 offset:49920
    s_add_u32 m0, s27, 134144
    s_nop 0
    buffer_load_dwordx4 v7, s[16:19], s28 offen lds
    v_mfma_f32_32x32x16_bf16 a[144:159], v[148:151], v[64:67], a[144:159]
    ds_read_b64_tr_b16 v[222:223], v9 offset:54016
    v_mfma_f32_32x32x16_bf16 a[160:175], v[152:155], v[64:67], a[160:175]
    v_mfma_f32_32x32x16_bf16 a[176:191], v[156:159], v[64:67], a[176:191]
    v_mfma_f32_32x32x16_bf16 a[192:207], v[160:163], v[64:67], a[192:207]
    v_mfma_f32_32x32x16_bf16 a[208:223], v[164:167], v[64:67], a[208:223]
    s_waitcnt vmcnt(8) lgkmcnt(0)
    s_barrier
    s_mov_b32 s28, 129024
    v_mfma_f32_32x32x16_bf16 a[0:15], v[168:171], v[68:71], a[0:15]
    ds_read_b64_tr_b16 v[112:113], v8 offset:0
    ds_read_b64_tr_b16 v[114:115], v8 offset:4096
    ds_read_b64_tr_b16 v[116:117], v9 offset:0
    v_mfma_f32_32x32x16_bf16 a[16:31], v[172:175], v[68:71], a[16:31]
    ds_read_b64_tr_b16 v[118:119], v9 offset:4096
    ds_read_b64_tr_b16 v[120:121], v10 offset:0
    ds_read_b64_tr_b16 v[122:123], v10 offset:4096
    v_mfma_f32_32x32x16_bf16 a[32:47], v[176:179], v[68:71], a[32:47]
    ds_read_b64_tr_b16 v[124:125], v11 offset:0
    ds_read_b64_tr_b16 v[126:127], v11 offset:4096
    ds_read_b64_tr_b16 v[128:129], v8 offset:256
    s_add_u32 m0, s27, 147456
    s_nop 0
    buffer_load_dwordx4 v4, s[16:19], s28 offen lds
    v_mfma_f32_32x32x16_bf16 a[48:63], v[180:183], v[68:71], a[48:63]
    ds_read_b64_tr_b16 v[130:131], v8 offset:4352
    ds_read_b64_tr_b16 v[132:133], v9 offset:256
    ds_read_b64_tr_b16 v[134:135], v9 offset:4352
    v_mfma_f32_32x32x16_bf16 a[64:79], v[184:187], v[68:71], a[64:79]
    ds_read_b64_tr_b16 v[136:137], v10 offset:256
    ds_read_b64_tr_b16 v[138:139], v10 offset:4352
    ds_read_b64_tr_b16 v[140:141], v11 offset:256
    s_add_u32 m0, s27, 148480
    s_nop 0
    buffer_load_dwordx4 v5, s[16:19], s28 offen lds
    v_mfma_f32_32x32x16_bf16 a[80:95], v[188:191], v[68:71], a[80:95]
    ds_read_b64_tr_b16 v[142:143], v11 offset:4352
    ds_read_b64_tr_b16 v[144:145], v8 offset:512
    ds_read_b64_tr_b16 v[146:147], v8 offset:4608
    v_mfma_f32_32x32x16_bf16 a[96:111], v[192:195], v[68:71], a[96:111]
    ds_read_b64_tr_b16 v[148:149], v9 offset:512
    ds_read_b64_tr_b16 v[150:151], v9 offset:4608
    ds_read_b64_tr_b16 v[152:153], v10 offset:512
    s_add_u32 m0, s27, 149504
    s_nop 0
    buffer_load_dwordx4 v6, s[16:19], s28 offen lds
    v_mfma_f32_32x32x16_bf16 a[112:127], v[196:199], v[68:71], a[112:127]
    ds_read_b64_tr_b16 v[154:155], v10 offset:4608
    ds_read_b64_tr_b16 v[156:157], v11 offset:512
    ds_read_b64_tr_b16 v[158:159], v11 offset:4608
    v_mfma_f32_32x32x16_bf16 a[128:143], v[200:203], v[68:71], a[128:143]
    ds_read_b64_tr_b16 v[160:161], v8 offset:768
    ds_read_b64_tr_b16 v[162:163], v8 offset:4864
    ds_read_b64_tr_b16 v[164:165], v9 offset:768
    s_add_u32 m0, s27, 150528
    s_nop 0
    buffer_load_dwordx4 v7, s[16:19], s28 offen lds
    v_mfma_f32_32x32x16_bf16 a[144:159], v[204:207], v[68:71], a[144:159]
    ds_read_b64_tr_b16 v[166:167], v9 offset:4864
    v_mfma_f32_32x32x16_bf16 a[160:175], v[208:211], v[68:71], a[160:175]
    v_mfma_f32_32x32x16_bf16 a[176:191], v[212:215], v[68:71], a[176:191]
    v_mfma_f32_32x32x16_bf16 a[192:207], v[216:219], v[68:71], a[192:207]
    v_mfma_f32_32x32x16_bf16 a[208:223], v[220:223], v[68:71], a[208:223]
    s_waitcnt vmcnt(8) lgkmcnt(0)
    s_barrier
    s_mov_b32 s28, 143360
    v_mfma_f32_32x32x16_bf16 a[0:15], v[112:115], v[72:75], a[0:15]
    ds_read_b64_tr_b16 v[168:169], v8 offset:16384
    ds_read_b64_tr_b16 v[170:171], v8 offset:20480
    ds_read_b64_tr_b16 v[172:173], v9 offset:16384
    v_mfma_f32_32x32x16_bf16 a[16:31], v[116:119], v[72:75], a[16:31]
    ds_read_b64_tr_b16 v[174:175], v9 offset:20480
    ds_read_b64_tr_b16 v[176:177], v10 offset:16384
    ds_read_b64_tr_b16 v[178:179], v10 offset:20480
    v_mfma_f32_32x32x16_bf16 a[32:47], v[120:123], v[72:75], a[32:47]
    ds_read_b64_tr_b16 v[180:181], v11 offset:16384
    ds_read_b64_tr_b16 v[182:183], v11 offset:20480
    ds_read_b64_tr_b16 v[184:185], v8 offset:16640
    s_add_u32 m0, s27, 98304
    s_nop 0
    buffer_load_dwordx4 v4, s[16:19], s28 offen lds
    v_mfma_f32_32x32x16_bf16 a[48:63], v[124:127], v[72:75], a[48:63]
    ds_read_b64_tr_b16 v[186:187], v8 offset:20736
    ds_read_b64_tr_b16 v[188:189], v9 offset:16640
    ds_read_b64_tr_b16 v[190:191], v9 offset:20736
    v_mfma_f32_32x32x16_bf16 a[64:79], v[128:131], v[72:75], a[64:79]
    ds_read_b64_tr_b16 v[192:193], v10 offset:16640
    ds_read_b64_tr_b16 v[194:195], v10 offset:20736
    ds_read_b64_tr_b16 v[196:197], v11 offset:16640
    s_add_u32 m0, s27, 99328
    s_nop 0
    buffer_load_dwordx4 v5, s[16:19], s28 offen lds
    v_mfma_f32_32x32x16_bf16 a[80:95], v[132:135], v[72:75], a[80:95]
    ds_read_b64_tr_b16 v[198:199], v11 offset:20736
    ds_read_b64_tr_b16 v[200:201], v8 offset:16896
    ds_read_b64_tr_b16 v[202:203], v8 offset:20992
    v_mfma_f32_32x32x16_bf16 a[96:111], v[136:139], v[72:75], a[96:111]
    ds_read_b64_tr_b16 v[204:205], v9 offset:16896
    ds_read_b64_tr_b16 v[206:207], v9 offset:20992
    ds_read_b64_tr_b16 v[208:209], v10 offset:16896
    s_add_u32 m0, s27, 100352
    s_nop 0
    buffer_load_dwordx4 v6, s[16:19], s28 offen lds
    v_mfma_f32_32x32x16_bf16 a[112:127], v[140:143], v[72:75], a[112:127]
    ds_read_b64_tr_b16 v[210:211], v10 offset:20992
    ds_read_b64_tr_b16 v[212:213], v11 offset:16896
    ds_read_b64_tr_b16 v[214:215], v11 offset:20992
    v_mfma_f32_32x32x16_bf16 a[128:143], v[144:147], v[72:75], a[128:143]
    ds_read_b64_tr_b16 v[216:217], v8 offset:17152
    ds_read_b64_tr_b16 v[218:219], v8 offset:21248
    ds_read_b64_tr_b16 v[220:221], v9 offset:17152
    s_add_u32 m0, s27, 101376
    s_nop 0
    buffer_load_dwordx4 v7, s[16:19], s28 offen lds
    v_mfma_f32_32x32x16_bf16 a[144:159], v[148:151], v[72:75], a[144:159]
    ds_read_b64_tr_b16 v[222:223], v9 offset:21248
    v_mfma_f32_32x32x16_bf16 a[160:175], v[152:155], v[72:75], a[160:175]
    v_mfma_f32_32x32x16_bf16 a[176:191], v[156:159], v[72:75], a[176:191]
    v_mfma_f32_32x32x16_bf16 a[192:207], v[160:163], v[72:75], a[192:207]
    v_mfma_f32_32x32x16_bf16 a[208:223], v[164:167], v[72:75], a[208:223]
    s_waitcnt vmcnt(8) lgkmcnt(0)
    s_barrier
    s_mov_b32 s28, 157696
    v_mfma_f32_32x32x16_bf16 a[0:15], v[168:171], v[76:79], a[0:15]
    ds_read_b64_tr_b16 v[112:113], v8 offset:32768
    ds_read_b64_tr_b16 v[114:115], v8 offset:36864
    ds_read_b64_tr_b16 v[116:117], v9 offset:32768
    v_mfma_f32_32x32x16_bf16 a[16:31], v[172:175], v[76:79], a[16:31]
    ds_read_b64_tr_b16 v[118:119], v9 offset:36864
    ds_read_b64_tr_b16 v[120:121], v10 offset:32768
    ds_read_b64_tr_b16 v[122:123], v10 offset:36864
    v_mfma_f32_32x32x16_bf16 a[32:47], v[176:179], v[76:79], a[32:47]
    ds_read_b64_tr_b16 v[124:125], v11 offset:32768
    ds_read_b64_tr_b16 v[126:127], v11 offset:36864
    ds_read_b64_tr_b16 v[128:129], v8 offset:33024
    s_add_u32 m0, s27, 114688
    s_nop 0
    buffer_load_dwordx4 v4, s[16:19], s28 offen lds
    v_mfma_f32_32x32x16_bf16 a[48:63], v[180:183], v[76:79], a[48:63]
    ds_read_b64_tr_b16 v[130:131], v8 offset:37120
    ds_read_b64_tr_b16 v[132:133], v9 offset:33024
    ds_read_b64_tr_b16 v[134:135], v9 offset:37120
    v_mfma_f32_32x32x16_bf16 a[64:79], v[184:187], v[76:79], a[64:79]
    ds_read_b64_tr_b16 v[136:137], v10 offset:33024
    ds_read_b64_tr_b16 v[138:139], v10 offset:37120
    ds_read_b64_tr_b16 v[140:141], v11 offset:33024
    s_add_u32 m0, s27, 115712
    s_nop 0
    buffer_load_dwordx4 v5, s[16:19], s28 offen lds
    v_mfma_f32_32x32x16_bf16 a[80:95], v[188:191], v[76:79], a[80:95]
    ds_read_b64_tr_b16 v[142:143], v11 offset:37120
    ds_read_b64_tr_b16 v[144:145], v8 offset:33280
    ds_read_b64_tr_b16 v[146:147], v8 offset:37376
    v_mfma_f32_32x32x16_bf16 a[96:111], v[192:195], v[76:79], a[96:111]
    ds_read_b64_tr_b16 v[148:149], v9 offset:33280
    ds_read_b64_tr_b16 v[150:151], v9 offset:37376
    ds_read_b64_tr_b16 v[152:153], v10 offset:33280
    s_add_u32 m0, s27, 116736
    s_nop 0
    buffer_load_dwordx4 v6, s[16:19], s28 offen lds
    v_mfma_f32_32x32x16_bf16 a[112:127], v[196:199], v[76:79], a[112:127]
    ds_read_b64_tr_b16 v[154:155], v10 offset:37376
    ds_read_b64_tr_b16 v[156:157], v11 offset:33280
    ds_read_b64_tr_b16 v[158:159], v11 offset:37376
    v_mfma_f32_32x32x16_bf16 a[128:143], v[200:203], v[76:79], a[128:143]
    ds_read_b64_tr_b16 v[160:161], v8 offset:33536
    ds_read_b64_tr_b16 v[162:163], v8 offset:37632
    ds_read_b64_tr_b16 v[164:165], v9 offset:33536
    s_add_u32 m0, s27, 117760
    s_nop 0
    buffer_load_dwordx4 v7, s[16:19], s28 offen lds
    v_mfma_f32_32x32x16_bf16 a[144:159], v[204:207], v[76:79], a[144:159]
    ds_read_b64_tr_b16 v[166:167], v9 offset:37632
    v_mfma_f32_32x32x16_bf16 a[160:175], v[208:211], v[76:79], a[160:175]
    v_mfma_f32_32x32x16_bf16 a[176:191], v[212:215], v[76:79], a[176:191]
    v_mfma_f32_32x32x16_bf16 a[192:207], v[216:219], v[76:79], a[192:207]
    v_mfma_f32_32x32x16_bf16 a[208:223], v[220:223], v[76:79], a[208:223]
    s_waitcnt vmcnt(8) lgkmcnt(0)
    s_barrier
    s_mov_b32 s28, 172032
    v_mfma_f32_32x32x16_bf16 a[0:15], v[112:115], v[80:83], a[0:15]
    ds_read_b64_tr_b16 v[168:169], v8 offset:49152
    ds_read_b64_tr_b16 v[170:171], v8 offset:53248
    ds_read_b64_tr_b16 v[172:173], v9 offset:49152
    v_mfma_f32_32x32x16_bf16 a[16:31], v[116:119], v[80:83], a[16:31]
    ds_read_b64_tr_b16 v[174:175], v9 offset:53248
    ds_read_b64_tr_b16 v[176:177], v10 offset:49152
    ds_read_b64_tr_b16 v[178:179], v10 offset:53248
    v_mfma_f32_32x32x16_bf16 a[32:47], v[120:123], v[80:83], a[32:47]
    ds_read_b64_tr_b16 v[180:181], v11 offset:49152
    ds_read_b64_tr_b16 v[182:183], v11 offset:53248
    ds_read_b64_tr_b16 v[184:185], v8 offset:49408
    s_add_u32 m0, s27, 131072
    s_nop 0
    buffer_load_dwordx4 v4, s[16:19], s28 offen lds
    v_mfma_f32_32x32x16_bf16 a[48:63], v[124:127], v[80:83], a[48:63]
    ds_read_b64_tr_b16 v[186:187], v8 offset:53504
    ds_read_b64_tr_b16 v[188:189], v9 offset:49408
    ds_read_b64_tr_b16 v[190:191], v9 offset:53504
    v_mfma_f32_32x32x16_bf16 a[64:79], v[128:131], v[80:83], a[64:79]
    ds_read_b64_tr_b16 v[192:193], v10 offset:49408
    ds_read_b64_tr_b16 v[194:195], v10 offset:53504
    ds_read_b64_tr_b16 v[196:197], v11 offset:49408
    s_add_u32 m0, s27, 132096
    s_nop 0
    buffer_load_dwordx4 v5, s[16:19], s28 offen lds
    v_mfma_f32_32x32x16_bf16 a[80:95], v[132:135], v[80:83], a[80:95]
    ds_read_b64_tr_b16 v[198:199], v11 offset:53504
    ds_read_b64_tr_b16 v[200:201], v8 offset:49664
    ds_read_b64_tr_b16 v[202:203], v8 offset:53760
    v_mfma_f32_32x32x16_bf16 a[96:111], v[136:139], v[80:83], a[96:111]
    ds_read_b64_tr_b16 v[204:205], v9 offset:49664
    ds_read_b64_tr_b16 v[206:207], v9 offset:53760
    ds_read_b64_tr_b16 v[208:209], v10 offset:49664
    s_add_u32 m0, s27, 133120
    s_nop 0
    buffer_load_dwordx4 v6, s[16:19], s28 offen lds
    v_mfma_f32_32x32x16_bf16 a[112:127], v[140:143], v[80:83], a[112:127]
    ds_read_b64_tr_b16 v[210:211], v10 offset:53760
    ds_read_b64_tr_b16 v[212:213], v11 offset:49664
    ds_read_b64_tr_b16 v[214:215], v11 offset:53760
    v_mfma_f32_32x32x16_bf16 a[128:143], v[144:147], v[80:83], a[128:143]
    ds_read_b64_tr_b16 v[216:217], v8 offset:49920
    ds_read_b64_tr_b16 v[218:219], v8 offset:54016
    ds_read_b64_tr_b16 v[220:221], v9 offset:49920
    s_add_u32 m0, s27, 134144
    s_nop 0
    buffer_load_dwordx4 v7, s[16:19], s28 offen lds
    v_mfma_f32_32x32x16_bf16 a[144:159], v[148:151], v[80:83], a[144:159]
    ds_read_b64_tr_b16 v[222:223], v9 offset:54016
    v_mfma_f32_32x32x16_bf16 a[160:175], v[152:155], v[80:83], a[160:175]
    v_mfma_f32_32x32x16_bf16 a[176:191], v[156:159], v[80:83], a[176:191]
    v_mfma_f32_32x32x16_bf16 a[192:207], v[160:163], v[80:83], a[192:207]
    v_mfma_f32_32x32x16_bf16 a[208:223], v[164:167], v[80:83], a[208:223]
    s_waitcnt vmcnt(8) lgkmcnt(0)
    s_barrier
    s_mov_b32 s28, 186368
    v_mfma_f32_32x32x16_bf16 a[0:15], v[168:171], v[84:87], a[0:15]
    ds_read_b64_tr_b16 v[112:113], v8 offset:0
    ds_read_b64_tr_b16 v[114:115], v8 offset:4096
    ds_read_b64_tr_b16 v[116:117], v9 offset:0
    v_mfma_f32_32x32x16_bf16 a[16:31], v[172:175], v[84:87], a[16:31]
    ds_read_b64_tr_b16 v[118:119], v9 offset:4096
    ds_read_b64_tr_b16 v[120:121], v10 offset:0
    ds_read_b64_tr_b16 v[122:123], v10 offset:4096
    v_mfma_f32_32x32x16_bf16 a[32:47], v[176:179], v[84:87], a[32:47]
    ds_read_b64_tr_b16 v[124:125], v11 offset:0
    ds_read_b64_tr_b16 v[126:127], v11 offset:4096
    ds_read_b64_tr_b16 v[128:129], v8 offset:256
    s_add_u32 m0, s27, 147456
    s_nop 0
    buffer_load_dwordx4 v4, s[16:19], s28 offen lds
    v_mfma_f32_32x32x16_bf16 a[48:63], v[180:183], v[84:87], a[48:63]
    ds_read_b64_tr_b16 v[130:131], v8 offset:4352
    ds_read_b64_tr_b16 v[132:133], v9 offset:256
    ds_read_b64_tr_b16 v[134:135], v9 offset:4352
    v_mfma_f32_32x32x16_bf16 a[64:79], v[184:187], v[84:87], a[64:79]
    ds_read_b64_tr_b16 v[136:137], v10 offset:256
    ds_read_b64_tr_b16 v[138:139], v10 offset:4352
    ds_read_b64_tr_b16 v[140:141], v11 offset:256
    s_add_u32 m0, s27, 148480
    s_nop 0
    buffer_load_dwordx4 v5, s[16:19], s28 offen lds
    v_mfma_f32_32x32x16_bf16 a[80:95], v[188:191], v[84:87], a[80:95]
    ds_read_b64_tr_b16 v[142:143], v11 offset:4352
    ds_read_b64_tr_b16 v[144:145], v8 offset:512
    ds_read_b64_tr_b16 v[146:147], v8 offset:4608
    v_mfma_f32_32x32x16_bf16 a[96:111], v[192:195], v[84:87], a[96:111]
    ds_read_b64_tr_b16 v[148:149], v9 offset:512
    ds_read_b64_tr_b16 v[150:151], v9 offset:4608
    ds_read_b64_tr_b16 v[152:153], v10 offset:512
    s_add_u32 m0, s27, 149504
    s_nop 0
    buffer_load_dwordx4 v6, s[16:19], s28 offen lds
    v_mfma_f32_32x32x16_bf16 a[112:127], v[196:199], v[84:87], a[112:127]
    ds_read_b64_tr_b16 v[154:155], v10 offset:4608
    ds_read_b64_tr_b16 v[156:157], v11 offset:512
    ds_read_b64_tr_b16 v[158:159], v11 offset:4608
    v_mfma_f32_32x32x16_bf16 a[128:143], v[200:203], v[84:87], a[128:143]
    ds_read_b64_tr_b16 v[160:161], v8 offset:768
    ds_read_b64_tr_b16 v[162:163], v8 offset:4864
    ds_read_b64_tr_b16 v[164:165], v9 offset:768
    s_add_u32 m0, s27, 150528
    s_nop 0
    buffer_load_dwordx4 v7, s[16:19], s28 offen lds
    v_mfma_f32_32x32x16_bf16 a[144:159], v[204:207], v[84:87], a[144:159]
    ds_read_b64_tr_b16 v[166:167], v9 offset:4864
    v_mfma_f32_32x32x16_bf16 a[160:175], v[208:211], v[84:87], a[160:175]
    v_mfma_f32_32x32x16_bf16 a[176:191], v[212:215], v[84:87], a[176:191]
    v_mfma_f32_32x32x16_bf16 a[192:207], v[216:219], v[84:87], a[192:207]
    v_mfma_f32_32x32x16_bf16 a[208:223], v[220:223], v[84:87], a[208:223]
    s_waitcnt vmcnt(8) lgkmcnt(0)
    s_barrier
    s_mov_b32 s28, 200704
    v_mfma_f32_32x32x16_bf16 a[0:15], v[112:115], v[88:91], a[0:15]
    ds_read_b64_tr_b16 v[168:169], v8 offset:16384
    ds_read_b64_tr_b16 v[170:171], v8 offset:20480
    ds_read_b64_tr_b16 v[172:173], v9 offset:16384
    v_mfma_f32_32x32x16_bf16 a[16:31], v[116:119], v[88:91], a[16:31]
    ds_read_b64_tr_b16 v[174:175], v9 offset:20480
    ds_read_b64_tr_b16 v[176:177], v10 offset:16384
    ds_read_b64_tr_b16 v[178:179], v10 offset:20480
    v_mfma_f32_32x32x16_bf16 a[32:47], v[120:123], v[88:91], a[32:47]
    ds_read_b64_tr_b16 v[180:181], v11 offset:16384
    ds_read_b64_tr_b16 v[182:183], v11 offset:20480
    ds_read_b64_tr_b16 v[184:185], v8 offset:16640
    s_add_u32 m0, s27, 98304
    s_nop 0
    buffer_load_dwordx4 v4, s[16:19], s28 offen lds
    v_mfma_f32_32x32x16_bf16 a[48:63], v[124:127], v[88:91], a[48:63]
    ds_read_b64_tr_b16 v[186:187], v8 offset:20736
    ds_read_b64_tr_b16 v[188:189], v9 offset:16640
    ds_read_b64_tr_b16 v[190:191], v9 offset:20736
    v_mfma_f32_32x32x16_bf16 a[64:79], v[128:131], v[88:91], a[64:79]
    ds_read_b64_tr_b16 v[192:193], v10 offset:16640
    ds_read_b64_tr_b16 v[194:195], v10 offset:20736
    ds_read_b64_tr_b16 v[196:197], v11 offset:16640
    s_add_u32 m0, s27, 99328
    s_nop 0
    buffer_load_dwordx4 v5, s[16:19], s28 offen lds
    v_mfma_f32_32x32x16_bf16 a[80:95], v[132:135], v[88:91], a[80:95]
    ds_read_b64_tr_b16 v[198:199], v11 offset:20736
    ds_read_b64_tr_b16 v[200:201], v8 offset:16896
    ds_read_b64_tr_b16 v[202:203], v8 offset:20992
    v_mfma_f32_32x32x16_bf16 a[96:111], v[136:139], v[88:91], a[96:111]
    ds_read_b64_tr_b16 v[204:205], v9 offset:16896
    ds_read_b64_tr_b16 v[206:207], v9 offset:20992
    ds_read_b64_tr_b16 v[208:209], v10 offset:16896
    s_add_u32 m0, s27, 100352
    s_nop 0
    buffer_load_dwordx4 v6, s[16:19], s28 offen lds
    v_mfma_f32_32x32x16_bf16 a[112:127], v[140:143], v[88:91], a[112:127]
    ds_read_b64_tr_b16 v[210:211], v10 offset:20992
    ds_read_b64_tr_b16 v[212:213], v11 offset:16896
    ds_read_b64_tr_b16 v[214:215], v11 offset:20992
    v_mfma_f32_32x32x16_bf16 a[128:143], v[144:147], v[88:91], a[128:143]
    ds_read_b64_tr_b16 v[216:217], v8 offset:17152
    ds_read_b64_tr_b16 v[218:219], v8 offset:21248
    ds_read_b64_tr_b16 v[220:221], v9 offset:17152
    s_add_u32 m0, s27, 101376
    s_nop 0
    buffer_load_dwordx4 v7, s[16:19], s28 offen lds
    v_mfma_f32_32x32x16_bf16 a[144:159], v[148:151], v[88:91], a[144:159]
    ds_read_b64_tr_b16 v[222:223], v9 offset:21248
    v_mfma_f32_32x32x16_bf16 a[160:175], v[152:155], v[88:91], a[160:175]
    v_mfma_f32_32x32x16_bf16 a[176:191], v[156:159], v[88:91], a[176:191]
    v_mfma_f32_32x32x16_bf16 a[192:207], v[160:163], v[88:91], a[192:207]
    v_mfma_f32_32x32x16_bf16 a[208:223], v[164:167], v[88:91], a[208:223]
    s_waitcnt vmcnt(8) lgkmcnt(0)
    s_barrier
    s_mov_b32 s28, 215040
    v_mfma_f32_32x32x16_bf16 a[0:15], v[168:171], v[92:95], a[0:15]
    ds_read_b64_tr_b16 v[112:113], v8 offset:32768
    ds_read_b64_tr_b16 v[114:115], v8 offset:36864
    ds_read_b64_tr_b16 v[116:117], v9 offset:32768
    v_mfma_f32_32x32x16_bf16 a[16:31], v[172:175], v[92:95], a[16:31]
    ds_read_b64_tr_b16 v[118:119], v9 offset:36864
    ds_read_b64_tr_b16 v[120:121], v10 offset:32768
    ds_read_b64_tr_b16 v[122:123], v10 offset:36864
    v_mfma_f32_32x32x16_bf16 a[32:47], v[176:179], v[92:95], a[32:47]
    ds_read_b64_tr_b16 v[124:125], v11 offset:32768
    ds_read_b64_tr_b16 v[126:127], v11 offset:36864
    ds_read_b64_tr_b16 v[128:129], v8 offset:33024
    s_add_u32 m0, s27, 114688
    s_nop 0
    buffer_load_dwordx4 v4, s[16:19], s28 offen lds
    v_mfma_f32_32x32x16_bf16 a[48:63], v[180:183], v[92:95], a[48:63]
    ds_read_b64_tr_b16 v[130:131], v8 offset:37120
    ds_read_b64_tr_b16 v[132:133], v9 offset:33024
    ds_read_b64_tr_b16 v[134:135], v9 offset:37120
    v_mfma_f32_32x32x16_bf16 a[64:79], v[184:187], v[92:95], a[64:79]
    ds_read_b64_tr_b16 v[136:137], v10 offset:33024
    ds_read_b64_tr_b16 v[138:139], v10 offset:37120
    ds_read_b64_tr_b16 v[140:141], v11 offset:33024
    s_add_u32 m0, s27, 115712
    s_nop 0
    buffer_load_dwordx4 v5, s[16:19], s28 offen lds
    v_mfma_f32_32x32x16_bf16 a[80:95], v[188:191], v[92:95], a[80:95]
    ds_read_b64_tr_b16 v[142:143], v11 offset:37120
    ds_read_b64_tr_b16 v[144:145], v8 offset:33280
    ds_read_b64_tr_b16 v[146:147], v8 offset:37376
    v_mfma_f32_32x32x16_bf16 a[96:111], v[192:195], v[92:95], a[96:111]
    ds_read_b64_tr_b16 v[148:149], v9 offset:33280
    ds_read_b64_tr_b16 v[150:151], v9 offset:37376
    ds_read_b64_tr_b16 v[152:153], v10 offset:33280
    s_add_u32 m0, s27, 116736
    s_nop 0
    buffer_load_dwordx4 v6, s[16:19], s28 offen lds
    v_mfma_f32_32x32x16_bf16 a[112:127], v[196:199], v[92:95], a[112:127]
    ds_read_b64_tr_b16 v[154:155], v10 offset:37376
    ds_read_b64_tr_b16 v[156:157], v11 offset:33280
    ds_read_b64_tr_b16 v[158:159], v11 offset:37376
    v_mfma_f32_32x32x16_bf16 a[128:143], v[200:203], v[92:95], a[128:143]
    ds_read_b64_tr_b16 v[160:161], v8 offset:33536
    ds_read_b64_tr_b16 v[162:163], v8 offset:37632
    ds_read_b64_tr_b16 v[164:165], v9 offset:33536
    s_add_u32 m0, s27, 117760
    s_nop 0
    buffer_load_dwordx4 v7, s[16:19], s28 offen lds
    v_mfma_f32_32x32x16_bf16 a[144:159], v[204:207], v[92:95], a[144:159]
    ds_read_b64_tr_b16 v[166:167], v9 offset:37632
    v_mfma_f32_32x32x16_bf16 a[160:175], v[208:211], v[92:95], a[160:175]
    v_mfma_f32_32x32x16_bf16 a[176:191], v[212:215], v[92:95], a[176:191]
    v_mfma_f32_32x32x16_bf16 a[192:207], v[216:219], v[92:95], a[192:207]
    v_mfma_f32_32x32x16_bf16 a[208:223], v[220:223], v[92:95], a[208:223]
    s_waitcnt vmcnt(8) lgkmcnt(0)
    s_barrier
    v_mfma_f32_32x32x16_bf16 a[0:15], v[112:115], v[96:99], a[0:15]
    ds_read_b64_tr_b16 v[168:169], v8 offset:49152
    ds_read_b64_tr_b16 v[170:171], v8 offset:53248
    ds_read_b64_tr_b16 v[172:173], v9 offset:49152
    v_mfma_f32_32x32x16_bf16 a[16:31], v[116:119], v[96:99], a[16:31]
    ds_read_b64_tr_b16 v[174:175], v9 offset:53248
    ds_read_b64_tr_b16 v[176:177], v10 offset:49152
    ds_read_b64_tr_b16 v[178:179], v10 offset:53248
    v_mfma_f32_32x32x16_bf16 a[32:47], v[120:123], v[96:99], a[32:47]
    ds_read_b64_tr_b16 v[180:181], v11 offset:49152
    ds_read_b64_tr_b16 v[182:183], v11 offset:53248
    ds_read_b64_tr_b16 v[184:185], v8 offset:49408
    v_mfma_f32_32x32x16_bf16 a[48:63], v[124:127], v[96:99], a[48:63]
    ds_read_b64_tr_b16 v[186:187], v8 offset:53504
    ds_read_b64_tr_b16 v[188:189], v9 offset:49408
    ds_read_b64_tr_b16 v[190:191], v9 offset:53504
    v_mfma_f32_32x32x16_bf16 a[64:79], v[128:131], v[96:99], a[64:79]
    ds_read_b64_tr_b16 v[192:193], v10 offset:49408
    ds_read_b64_tr_b16 v[194:195], v10 offset:53504
    ds_read_b64_tr_b16 v[196:197], v11 offset:49408
    v_mfma_f32_32x32x16_bf16 a[80:95], v[132:135], v[96:99], a[80:95]
    ds_read_b64_tr_b16 v[198:199], v11 offset:53504
    ds_read_b64_tr_b16 v[200:201], v8 offset:49664
    ds_read_b64_tr_b16 v[202:203], v8 offset:53760
    v_mfma_f32_32x32x16_bf16 a[96:111], v[136:139], v[96:99], a[96:111]
    ds_read_b64_tr_b16 v[204:205], v9 offset:49664
    ds_read_b64_tr_b16 v[206:207], v9 offset:53760
    ds_read_b64_tr_b16 v[208:209], v10 offset:49664
    v_mfma_f32_32x32x16_bf16 a[112:127], v[140:143], v[96:99], a[112:127]
    ds_read_b64_tr_b16 v[210:211], v10 offset:53760
    ds_read_b64_tr_b16 v[212:213], v11 offset:49664
    ds_read_b64_tr_b16 v[214:215], v11 offset:53760
    v_mfma_f32_32x32x16_bf16 a[128:143], v[144:147], v[96:99], a[128:143]
    ds_read_b64_tr_b16 v[216:217], v8 offset:49920
    ds_read_b64_tr_b16 v[218:219], v8 offset:54016
    ds_read_b64_tr_b16 v[220:221], v9 offset:49920
    v_mfma_f32_32x32x16_bf16 a[144:159], v[148:151], v[96:99], a[144:159]
    ds_read_b64_tr_b16 v[222:223], v9 offset:54016
    v_mfma_f32_32x32x16_bf16 a[160:175], v[152:155], v[96:99], a[160:175]
    v_mfma_f32_32x32x16_bf16 a[176:191], v[156:159], v[96:99], a[176:191]
    v_mfma_f32_32x32x16_bf16 a[192:207], v[160:163], v[96:99], a[192:207]
    v_mfma_f32_32x32x16_bf16 a[208:223], v[164:167], v[96:99], a[208:223]
    s_waitcnt vmcnt(4) lgkmcnt(0)
    s_barrier
    v_mfma_f32_32x32x16_bf16 a[0:15], v[168:171], v[100:103], a[0:15]
    ds_read_b64_tr_b16 v[112:113], v8 offset:0
    ds_read_b64_tr_b16 v[114:115], v8 offset:4096
    ds_read_b64_tr_b16 v[116:117], v9 offset:0
    v_mfma_f32_32x32x16_bf16 a[16:31], v[172:175], v[100:103], a[16:31]
    ds_read_b64_tr_b16 v[118:119], v9 offset:4096
    ds_read_b64_tr_b16 v[120:121], v10 offset:0
    ds_read_b64_tr_b16 v[122:123], v10 offset:4096
    v_mfma_f32_32x32x16_bf16 a[32:47], v[176:179], v[100:103], a[32:47]
    ds_read_b64_tr_b16 v[124:125], v11 offset:0
    ds_read_b64_tr_b16 v[126:127], v11 offset:4096
    ds_read_b64_tr_b16 v[128:129], v8 offset:256
    v_mfma_f32_32x32x16_bf16 a[48:63], v[180:183], v[100:103], a[48:63]
    ds_read_b64_tr_b16 v[130:131], v8 offset:4352
    ds_read_b64_tr_b16 v[132:133], v9 offset:256
    ds_read_b64_tr_b16 v[134:135], v9 offset:4352
    v_mfma_f32_32x32x16_bf16 a[64:79], v[184:187], v[100:103], a[64:79]
    ds_read_b64_tr_b16 v[136:137], v10 offset:256
    ds_read_b64_tr_b16 v[138:139], v10 offset:4352
    ds_read_b64_tr_b16 v[140:141], v11 offset:256
    v_mfma_f32_32x32x16_bf16 a[80:95], v[188:191], v[100:103], a[80:95]
    ds_read_b64_tr_b16 v[142:143], v11 offset:4352
    ds_read_b64_tr_b16 v[144:145], v8 offset:512
    ds_read_b64_tr_b16 v[146:147], v8 offset:4608
    v_mfma_f32_32x32x16_bf16 a[96:111], v[192:195], v[100:103], a[96:111]
    ds_read_b64_tr_b16 v[148:149], v9 offset:512
    ds_read_b64_tr_b16 v[150:151], v9 offset:4608
    ds_read_b64_tr_b16 v[152:153], v10 offset:512
    v_mfma_f32_32x32x16_bf16 a[112:127], v[196:199], v[100:103], a[112:127]
    ds_read_b64_tr_b16 v[154:155], v10 offset:4608
    ds_read_b64_tr_b16 v[156:157], v11 offset:512
    ds_read_b64_tr_b16 v[158:159], v11 offset:4608
    v_mfma_f32_32x32x16_bf16 a[128:143], v[200:203], v[100:103], a[128:143]
    ds_read_b64_tr_b16 v[160:161], v8 offset:768
    ds_read_b64_tr_b16 v[162:163], v8 offset:4864
    ds_read_b64_tr_b16 v[164:165], v9 offset:768
    v_mfma_f32_32x32x16_bf16 a[144:159], v[204:207], v[100:103], a[144:159]
    ds_read_b64_tr_b16 v[166:167], v9 offset:4864
    v_mfma_f32_32x32x16_bf16 a[160:175], v[208:211], v[100:103], a[160:175]
    v_mfma_f32_32x32x16_bf16 a[176:191], v[212:215], v[100:103], a[176:191]
    v_mfma_f32_32x32x16_bf16 a[192:207], v[216:219], v[100:103], a[192:207]
    v_mfma_f32_32x32x16_bf16 a[208:223], v[220:223], v[100:103], a[208:223]
    s_waitcnt vmcnt(0) lgkmcnt(0)
    s_barrier
    v_mfma_f32_32x32x16_bf16 a[0:15], v[112:115], v[104:107], a[0:15]
    ds_read_b64_tr_b16 v[168:169], v8 offset:16384
    ds_read_b64_tr_b16 v[170:171], v8 offset:20480
    ds_read_b64_tr_b16 v[172:173], v9 offset:16384
    v_mfma_f32_32x32x16_bf16 a[16:31], v[116:119], v[104:107], a[16:31]
    ds_read_b64_tr_b16 v[174:175], v9 offset:20480
    ds_read_b64_tr_b16 v[176:177], v10 offset:16384
    ds_read_b64_tr_b16 v[178:179], v10 offset:20480
    v_mfma_f32_32x32x16_bf16 a[32:47], v[120:123], v[104:107], a[32:47]
    ds_read_b64_tr_b16 v[180:181], v11 offset:16384
    ds_read_b64_tr_b16 v[182:183], v11 offset:20480
    ds_read_b64_tr_b16 v[184:185], v8 offset:16640
    v_mfma_f32_32x32x16_bf16 a[48:63], v[124:127], v[104:107], a[48:63]
    ds_read_b64_tr_b16 v[186:187], v8 offset:20736
    ds_read_b64_tr_b16 v[188:189], v9 offset:16640
    ds_read_b64_tr_b16 v[190:191], v9 offset:20736
    v_mfma_f32_32x32x16_bf16 a[64:79], v[128:131], v[104:107], a[64:79]
    ds_read_b64_tr_b16 v[192:193], v10 offset:16640
    ds_read_b64_tr_b16 v[194:195], v10 offset:20736
    ds_read_b64_tr_b16 v[196:197], v11 offset:16640
    v_mfma_f32_32x32x16_bf16 a[80:95], v[132:135], v[104:107], a[80:95]
    ds_read_b64_tr_b16 v[198:199], v11 offset:20736
    ds_read_b64_tr_b16 v[200:201], v8 offset:16896
    ds_read_b64_tr_b16 v[202:203], v8 offset:20992
    v_mfma_f32_32x32x16_bf16 a[96:111], v[136:139], v[104:107], a[96:111]
    ds_read_b64_tr_b16 v[204:205], v9 offset:16896
    ds_read_b64_tr_b16 v[206:207], v9 offset:20992
    ds_read_b64_tr_b16 v[208:209], v10 offset:16896
    v_mfma_f32_32x32x16_bf16 a[112:127], v[140:143], v[104:107], a[112:127]
    ds_read_b64_tr_b16 v[210:211], v10 offset:20992
    ds_read_b64_tr_b16 v[212:213], v11 offset:16896
    ds_read_b64_tr_b16 v[214:215], v11 offset:20992
    v_mfma_f32_32x32x16_bf16 a[128:143], v[144:147], v[104:107], a[128:143]
    ds_read_b64_tr_b16 v[216:217], v8 offset:17152
    ds_read_b64_tr_b16 v[218:219], v8 offset:21248
    ds_read_b64_tr_b16 v[220:221], v9 offset:17152
    v_mfma_f32_32x32x16_bf16 a[144:159], v[148:151], v[104:107], a[144:159]
    ds_read_b64_tr_b16 v[222:223], v9 offset:21248
    v_mfma_f32_32x32x16_bf16 a[160:175], v[152:155], v[104:107], a[160:175]
    v_mfma_f32_32x32x16_bf16 a[176:191], v[156:159], v[104:107], a[176:191]
    v_mfma_f32_32x32x16_bf16 a[192:207], v[160:163], v[104:107], a[192:207]
    v_mfma_f32_32x32x16_bf16 a[208:223], v[164:167], v[104:107], a[208:223]
    s_waitcnt vmcnt(63) lgkmcnt(0)
    s_barrier
    v_mfma_f32_32x32x16_bf16 a[0:15], v[168:171], v[108:111], a[0:15]
    v_mfma_f32_32x32x16_bf16 a[16:31], v[172:175], v[108:111], a[16:31]
    v_mfma_f32_32x32x16_bf16 a[32:47], v[176:179], v[108:111], a[32:47]
    v_mfma_f32_32x32x16_bf16 a[48:63], v[180:183], v[108:111], a[48:63]
    v_mfma_f32_32x32x16_bf16 a[64:79], v[184:187], v[108:111], a[64:79]
    v_mfma_f32_32x32x16_bf16 a[80:95], v[188:191], v[108:111], a[80:95]
    v_mfma_f32_32x32x16_bf16 a[96:111], v[192:195], v[108:111], a[96:111]
    v_mfma_f32_32x32x16_bf16 a[112:127], v[196:199], v[108:111], a[112:127]
    v_mfma_f32_32x32x16_bf16 a[128:143], v[200:203], v[108:111], a[128:143]
    v_mfma_f32_32x32x16_bf16 a[144:159], v[204:207], v[108:111], a[144:159]
    v_mfma_f32_32x32x16_bf16 a[160:175], v[208:211], v[108:111], a[160:175]
    v_mfma_f32_32x32x16_bf16 a[176:191], v[212:215], v[108:111], a[176:191]
    v_mfma_f32_32x32x16_bf16 a[192:207], v[216:219], v[108:111], a[192:207]
    v_mfma_f32_32x32x16_bf16 a[208:223], v[220:223], v[108:111], a[208:223]
    s_barrier
    s_add_u32 m0, s60, 98304
    s_nop 0
    buffer_load_dwordx4 v233, s[12:15], s58 offen lds
    s_add_u32 m0, s60, 99328
    s_nop 0
    buffer_load_dwordx4 v234, s[12:15], s58 offen lds
    s_add_u32 m0, s60, 100352
    s_nop 0
    buffer_load_dwordx4 v235, s[12:15], s58 offen lds
    s_add_u32 m0, s60, 101376
    s_nop 0
    buffer_load_dwordx4 v236, s[12:15], s58 offen lds
    s_add_u32 m0, s61, 98304
    s_nop 0
    buffer_load_dwordx4 v237, s[4:7], s59 offen lds
    s_add_u32 m0, s61, 99328
    s_nop 0
    buffer_load_dwordx4 v238, s[4:7], s59 offen lds
    s_add_u32 s58, s58, 128
    s_add_u32 s59, s59, 8192
    s_and_b32 s58, s58, 4095
    s_and_b32 s59, s59, 262143
    s_add_u32 m0, s60, 122880
    s_nop 0
    buffer_load_dwordx4 v233, s[12:15], s58 offen lds
    s_add_u32 m0, s60, 123904
    s_nop 0
    buffer_load_dwordx4 v234, s[12:15], s58 offen lds
    s_add_u32 m0, s60, 124928
    s_nop 0
    buffer_load_dwordx4 v235, s[12:15], s58 offen lds
    s_add_u32 m0, s60, 125952
    s_nop 0
    buffer_load_dwordx4 v236, s[12:15], s58 offen lds
    s_add_u32 m0, s61, 122880
    s_nop 0
    buffer_load_dwordx4 v237, s[4:7], s59 offen lds
    s_add_u32 m0, s61, 123904
    s_nop 0
    buffer_load_dwordx4 v238, s[4:7], s59 offen lds
    s_add_u32 s58, s58, 128
    s_add_u32 s59, s59, 8192
    s_and_b32 s58, s58, 4095
    s_and_b32 s59, s59, 262143
    v_mov_b32 v144, 0
    v_mov_b32 v145, 0
    v_mov_b32 v146, 0
    v_mov_b32 v147, 0
    v_mov_b32 v148, 0
    v_mov_b32 v149, 0
    v_mov_b32 v150, 0
    v_mov_b32 v151, 0
    v_mov_b32 v152, 0
    v_mov_b32 v153, 0
    v_mov_b32 v154, 0
    v_mov_b32 v155, 0
    v_mov_b32 v156, 0
    v_mov_b32 v157, 0
    v_mov_b32 v158, 0
    v_mov_b32 v159, 0
    v_mov_b32 v160, 0
    v_mov_b32 v161, 0
    v_mov_b32 v162, 0
    v_mov_b32 v163, 0
    v_mov_b32 v164, 0
    v_mov_b32 v165, 0
    v_mov_b32 v166, 0
    v_mov_b32 v167, 0
    v_mov_b32 v168, 0
    v_mov_b32 v169, 0
    v_mov_b32 v170, 0
    v_mov_b32 v171, 0
    v_mov_b32 v172, 0
    v_mov_b32 v173, 0
    v_mov_b32 v174, 0
    v_mov_b32 v175, 0
    s_barrier
    ds_read_b128 v[48:51], v239 offset:0
    ds_read_b64_tr_b16 v[64:65], v243 offset:0
    ds_read_b64_tr_b16 v[66:67], v243 offset:512
    ds_read_b64_tr_b16 v[68:69], v244 offset:0
    ds_read_b64_tr_b16 v[70:71], v244 offset:512
    ds_read_b128 v[52:55], v240 offset:0
    ds_read_b64_tr_b16 v[72:73], v243 offset:2048
    ds_read_b64_tr_b16 v[74:75], v243 offset:2560
    ds_read_b64_tr_b16 v[76:77], v244 offset:2048
    ds_read_b64_tr_b16 v[78:79], v244 offset:2560
    ds_read_b128 v[56:59], v241 offset:0
    ds_read_b64_tr_b16 v[80:81], v243 offset:4096
    ds_read_b64_tr_b16 v[82:83], v243 offset:4608
    ds_read_b64_tr_b16 v[84:85], v244 offset:4096
    ds_read_b64_tr_b16 v[86:87], v244 offset:4608
    ds_read_b128 v[60:63], v242 offset:0
    ds_read_b64_tr_b16 v[88:89], v243 offset:6144
    ds_read_b64_tr_b16 v[90:91], v243 offset:6656
    ds_read_b64_tr_b16 v[92:93], v244 offset:6144
    ds_read_b64_tr_b16 v[94:95], v244 offset:6656
    s_waitcnt vmcnt(24) lgkmcnt(0)
    s_barrier
    v_mfma_f32_32x32x16_bf16 v[144:159], v[64:67], v[48:51], v[144:159]
    v_add_u32 v239, 24576, v239
    v_add_u32 v240, 24576, v240
    v_add_u32 v241, 24576, v241
    v_add_u32 v242, 24576, v242
    s_add_u32 m0, s60, 0
    s_nop 0
    buffer_load_dwordx4 v233, s[12:15], s58 offen lds
    v_accvgpr_read_b32 v184, a0
    v_accvgpr_read_b32 v185, a1
    v_accvgpr_read_b32 v186, a2
    v_accvgpr_read_b32 v187, a3
    v_accvgpr_read_b32 v188, a4
    v_accvgpr_read_b32 v189, a5
    v_accvgpr_read_b32 v190, a6
    v_accvgpr_read_b32 v191, a7
    v_mfma_f32_32x32x16_bf16 v[160:175], v[68:71], v[48:51], v[160:175]
    v_add_u32 v243, 24576, v243
    v_add_u32 v244, 24576, v244
    ds_read_b128 v[96:99], v239 offset:0
    ds_read_b64_tr_b16 v[112:113], v243 offset:0
    s_add_u32 m0, s60, 1024
    s_nop 0
    buffer_load_dwordx4 v234, s[12:15], s58 offen lds
    v_accvgpr_read_b32 v192, a8
    v_accvgpr_read_b32 v193, a9
    v_accvgpr_read_b32 v194, a10
    v_accvgpr_read_b32 v195, a11
    v_accvgpr_read_b32 v196, a12
    v_accvgpr_read_b32 v197, a13
    v_accvgpr_read_b32 v198, a14
    v_accvgpr_read_b32 v199, a15
    v_mfma_f32_32x32x16_bf16 v[144:159], v[72:75], v[52:55], v[144:159]
    ds_read_b64_tr_b16 v[114:115], v243 offset:512
    ds_read_b64_tr_b16 v[116:117], v244 offset:0
    ds_read_b64_tr_b16 v[118:119], v244 offset:512
    ds_read_b128 v[100:103], v240 offset:0
    s_add_u32 m0, s60, 2048
    s_nop 0
    buffer_load_dwordx4 v235, s[12:15], s58 offen lds
    v_cvt_pk_bf16_f32 v176, v184, v185
    v_cvt_pk_bf16_f32 v177, v186, v187
    v_cvt_pk_bf16_f32 v178, v188, v189
    v_cvt_pk_bf16_f32 v179, v190, v191
    v_cvt_pk_bf16_f32 v180, v192, v193
    v_cvt_pk_bf16_f32 v181, v194, v195
    v_cvt_pk_bf16_f32 v182, v196, v197
    v_cvt_pk_bf16_f32 v183, v198, v199
    v_mfma_f32_32x32x16_bf16 v[160:175], v[76:79], v[52:55], v[160:175]
    ds_read_b64_tr_b16 v[120:121], v243 offset:2048
    ds_read_b64_tr_b16 v[122:123], v243 offset:2560
    ds_read_b64_tr_b16 v[124:125], v244 offset:2048
    ds_read_b64_tr_b16 v[126:127], v244 offset:2560
    s_add_u32 m0, s60, 3072
    s_nop 0
    buffer_load_dwordx4 v236, s[12:15], s58 offen lds
    s_nop 1
    v_permlane32_swap_b32 v176, v178
    v_permlane32_swap_b32 v177, v179
    v_permlane32_swap_b32 v180, v182
    v_permlane32_swap_b32 v181, v183
    s_movk_i32 s33, 0
    buffer_store_dwordx4 v[176:179], v12, s[8:11], s33 offen offset:0
    buffer_store_dwordx4 v[180:183], v12, s[8:11], s33 offen offset:1024
    v_mfma_f32_32x32x16_bf16 v[144:159], v[80:83], v[56:59], v[144:159]
    ds_read_b128 v[104:107], v241 offset:0
    ds_read_b64_tr_b16 v[128:129], v243 offset:4096
    ds_read_b64_tr_b16 v[130:131], v243 offset:4608
    ds_read_b64_tr_b16 v[132:133], v244 offset:4096
    s_add_u32 m0, s61, 0
    s_nop 0
    buffer_load_dwordx4 v237, s[4:7], s59 offen lds
    v_accvgpr_read_b32 v208, a16
    v_accvgpr_read_b32 v209, a17
    v_accvgpr_read_b32 v210, a18
    v_accvgpr_read_b32 v211, a19
    v_accvgpr_read_b32 v212, a20
    v_accvgpr_read_b32 v213, a21
    v_accvgpr_read_b32 v214, a22
    v_accvgpr_read_b32 v215, a23
    v_mfma_f32_32x32x16_bf16 v[160:175], v[84:87], v[56:59], v[160:175]
    ds_read_b64_tr_b16 v[134:135], v244 offset:4608
    ds_read_b128 v[108:111], v242 offset:0
    ds_read_b64_tr_b16 v[136:137], v243 offset:6144
    ds_read_b64_tr_b16 v[138:139], v243 offset:6656
    s_add_u32 m0, s61, 1024
    s_nop 0
    buffer_load_dwordx4 v238, s[4:7], s59 offen lds
    v_accvgpr_read_b32 v216, a24
    v_accvgpr_read_b32 v217, a25
    v_accvgpr_read_b32 v218, a26
    v_accvgpr_read_b32 v219, a27
    v_accvgpr_read_b32 v220, a28
    v_accvgpr_read_b32 v221, a29
    v_accvgpr_read_b32 v222, a30
    v_accvgpr_read_b32 v223, a31
    v_mfma_f32_32x32x16_bf16 v[144:159], v[88:91], v[60:63], v[144:159]
    ds_read_b64_tr_b16 v[140:141], v244 offset:6144
    ds_read_b64_tr_b16 v[142:143], v244 offset:6656
    v_cvt_pk_bf16_f32 v200, v208, v209
    v_cvt_pk_bf16_f32 v201, v210, v211
    v_cvt_pk_bf16_f32 v202, v212, v213
    v_cvt_pk_bf16_f32 v203, v214, v215
    v_cvt_pk_bf16_f32 v204, v216, v217
    v_cvt_pk_bf16_f32 v205, v218, v219
    v_cvt_pk_bf16_f32 v206, v220, v221
    v_cvt_pk_bf16_f32 v207, v222, v223
    v_mfma_f32_32x32x16_bf16 v[160:175], v[92:95], v[60:63], v[160:175]
    s_nop 1
    v_permlane32_swap_b32 v200, v202
    v_permlane32_swap_b32 v201, v203
    v_permlane32_swap_b32 v204, v206
    v_permlane32_swap_b32 v205, v207
    s_movk_i32 s33, 2048
    buffer_store_dwordx4 v[200:203], v12, s[8:11], s33 offen offset:0
    buffer_store_dwordx4 v[204:207], v12, s[8:11], s33 offen offset:1024
    s_add_u32 s58, s58, 128
    s_add_u32 s59, s59, 8192
    s_and_b32 s58, s58, 4095
    s_and_b32 s59, s59, 262143
    s_waitcnt vmcnt(24) lgkmcnt(0)
    s_barrier
    v_mfma_f32_32x32x16_bf16 v[144:159], v[112:115], v[96:99], v[144:159]
    v_add_u32 v239, 24576, v239
    v_add_u32 v240, 24576, v240
    v_add_u32 v241, 24576, v241
    v_add_u32 v242, 24576, v242
    s_add_u32 m0, s60, 24576
    s_nop 0
    buffer_load_dwordx4 v233, s[12:15], s58 offen lds
    v_accvgpr_read_b32 v184, a32
    v_accvgpr_read_b32 v185, a33
    v_accvgpr_read_b32 v186, a34
    v_accvgpr_read_b32 v187, a35
    v_accvgpr_read_b32 v188, a36
    v_accvgpr_read_b32 v189, a37
    v_accvgpr_read_b32 v190, a38
    v_accvgpr_read_b32 v191, a39
    v_mfma_f32_32x32x16_bf16 v[160:175], v[116:119], v[96:99], v[160:175]
    v_add_u32 v243, 24576, v243
    v_add_u32 v244, 24576, v244
    ds_read_b128 v[48:51], v239 offset:0
    ds_read_b64_tr_b16 v[64:65], v243 offset:0
    s_add_u32 m0, s60, 25600
    s_nop 0
    buffer_load_dwordx4 v234, s[12:15], s58 offen lds
    v_accvgpr_read_b32 v192, a40
    v_accvgpr_read_b32 v193, a41
    v_accvgpr_read_b32 v194, a42
    v_accvgpr_read_b32 v195, a43
    v_accvgpr_read_b32 v196, a44
    v_accvgpr_read_b32 v197, a45
    v_accvgpr_read_b32 v198, a46
    v_accvgpr_read_b32 v199, a47
    v_mfma_f32_32x32x16_bf16 v[144:159], v[120:123], v[100:103], v[144:159]
    ds_read_b64_tr_b16 v[66:67], v243 offset:512
    ds_read_b64_tr_b16 v[68:69], v244 offset:0
    ds_read_b64_tr_b16 v[70:71], v244 offset:512
    ds_read_b128 v[52:55], v240 offset:0
    s_add_u32 m0, s60, 26624
    s_nop 0
    buffer_load_dwordx4 v235, s[12:15], s58 offen lds
    v_cvt_pk_bf16_f32 v176, v184, v185
    v_cvt_pk_bf16_f32 v177, v186, v187
    v_cvt_pk_bf16_f32 v178, v188, v189
    v_cvt_pk_bf16_f32 v179, v190, v191
    v_cvt_pk_bf16_f32 v180, v192, v193
    v_cvt_pk_bf16_f32 v181, v194, v195
    v_cvt_pk_bf16_f32 v182, v196, v197
    v_cvt_pk_bf16_f32 v183, v198, v199
    v_mfma_f32_32x32x16_bf16 v[160:175], v[124:127], v[100:103], v[160:175]
    ds_read_b64_tr_b16 v[72:73], v243 offset:2048
    ds_read_b64_tr_b16 v[74:75], v243 offset:2560
    ds_read_b64_tr_b16 v[76:77], v244 offset:2048
    ds_read_b64_tr_b16 v[78:79], v244 offset:2560
    s_add_u32 m0, s60, 27648
    s_nop 0
    buffer_load_dwordx4 v236, s[12:15], s58 offen lds
    s_nop 1
    v_permlane32_swap_b32 v176, v178
    v_permlane32_swap_b32 v177, v179
    v_permlane32_swap_b32 v180, v182
    v_permlane32_swap_b32 v181, v183
    s_movk_i32 s33, 4096
    buffer_store_dwordx4 v[176:179], v12, s[8:11], s33 offen offset:0
    buffer_store_dwordx4 v[180:183], v12, s[8:11], s33 offen offset:1024
    v_mfma_f32_32x32x16_bf16 v[144:159], v[128:131], v[104:107], v[144:159]
    ds_read_b128 v[56:59], v241 offset:0
    ds_read_b64_tr_b16 v[80:81], v243 offset:4096
    ds_read_b64_tr_b16 v[82:83], v243 offset:4608
    ds_read_b64_tr_b16 v[84:85], v244 offset:4096
    s_add_u32 m0, s61, 24576
    s_nop 0
    buffer_load_dwordx4 v237, s[4:7], s59 offen lds
    v_accvgpr_read_b32 v208, a48
    v_accvgpr_read_b32 v209, a49
    v_accvgpr_read_b32 v210, a50
    v_accvgpr_read_b32 v211, a51
    v_accvgpr_read_b32 v212, a52
    v_accvgpr_read_b32 v213, a53
    v_accvgpr_read_b32 v214, a54
    v_accvgpr_read_b32 v215, a55
    v_mfma_f32_32x32x16_bf16 v[160:175], v[132:135], v[104:107], v[160:175]
    ds_read_b64_tr_b16 v[86:87], v244 offset:4608
    ds_read_b128 v[60:63], v242 offset:0
    ds_read_b64_tr_b16 v[88:89], v243 offset:6144
    ds_read_b64_tr_b16 v[90:91], v243 offset:6656
    s_add_u32 m0, s61, 25600
    s_nop 0
    buffer_load_dwordx4 v238, s[4:7], s59 offen lds
    v_accvgpr_read_b32 v216, a56
    v_accvgpr_read_b32 v217, a57
    v_accvgpr_read_b32 v218, a58
    v_accvgpr_read_b32 v219, a59
    v_accvgpr_read_b32 v220, a60
    v_accvgpr_read_b32 v221, a61
    v_accvgpr_read_b32 v222, a62
    v_accvgpr_read_b32 v223, a63
    v_mfma_f32_32x32x16_bf16 v[144:159], v[136:139], v[108:111], v[144:159]
    ds_read_b64_tr_b16 v[92:93], v244 offset:6144
    ds_read_b64_tr_b16 v[94:95], v244 offset:6656
    v_cvt_pk_bf16_f32 v200, v208, v209
    v_cvt_pk_bf16_f32 v201, v210, v211
    v_cvt_pk_bf16_f32 v202, v212, v213
    v_cvt_pk_bf16_f32 v203, v214, v215
    v_cvt_pk_bf16_f32 v204, v216, v217
    v_cvt_pk_bf16_f32 v205, v218, v219
    v_cvt_pk_bf16_f32 v206, v220, v221
    v_cvt_pk_bf16_f32 v207, v222, v223
    v_mfma_f32_32x32x16_bf16 v[160:175], v[140:143], v[108:111], v[160:175]
    s_nop 1
    v_permlane32_swap_b32 v200, v202
    v_permlane32_swap_b32 v201, v203
    v_permlane32_swap_b32 v204, v206
    v_permlane32_swap_b32 v205, v207
    s_movk_i32 s33, 6144
    buffer_store_dwordx4 v[200:203], v12, s[8:11], s33 offen offset:0
    buffer_store_dwordx4 v[204:207], v12, s[8:11], s33 offen offset:1024
    s_add_u32 s58, s58, 128
    s_add_u32 s59, s59, 8192
    s_and_b32 s58, s58, 4095
    s_and_b32 s59, s59, 262143
    s_waitcnt vmcnt(24) lgkmcnt(0)
    s_barrier
    v_mfma_f32_32x32x16_bf16 v[144:159], v[64:67], v[48:51], v[144:159]
    v_add_u32 v239, 24576, v239
    v_add_u32 v240, 24576, v240
    v_add_u32 v241, 24576, v241
    v_add_u32 v242, 24576, v242
    s_add_u32 m0, s60, 49152
    s_nop 0
    buffer_load_dwordx4 v233, s[12:15], s58 offen lds
    v_accvgpr_read_b32 v184, a64
    v_accvgpr_read_b32 v185, a65
    v_accvgpr_read_b32 v186, a66
    v_accvgpr_read_b32 v187, a67
    v_accvgpr_read_b32 v188, a68
    v_accvgpr_read_b32 v189, a69
    v_accvgpr_read_b32 v190, a70
    v_accvgpr_read_b32 v191, a71
    v_mfma_f32_32x32x16_bf16 v[160:175], v[68:71], v[48:51], v[160:175]
    v_add_u32 v243, 24576, v243
    v_add_u32 v244, 24576, v244
    ds_read_b128 v[96:99], v239 offset:0
    ds_read_b64_tr_b16 v[112:113], v243 offset:0
    s_add_u32 m0, s60, 50176
    s_nop 0
    buffer_load_dwordx4 v234, s[12:15], s58 offen lds
    v_accvgpr_read_b32 v192, a72
    v_accvgpr_read_b32 v193, a73
    v_accvgpr_read_b32 v194, a74
    v_accvgpr_read_b32 v195, a75
    v_accvgpr_read_b32 v196, a76
    v_accvgpr_read_b32 v197, a77
    v_accvgpr_read_b32 v198, a78
    v_accvgpr_read_b32 v199, a79
    v_mfma_f32_32x32x16_bf16 v[144:159], v[72:75], v[52:55], v[144:159]
    ds_read_b64_tr_b16 v[114:115], v243 offset:512
    ds_read_b64_tr_b16 v[116:117], v244 offset:0
    ds_read_b64_tr_b16 v[118:119], v244 offset:512
    ds_read_b128 v[100:103], v240 offset:0
    s_add_u32 m0, s60, 51200
    s_nop 0
    buffer_load_dwordx4 v235, s[12:15], s58 offen lds
    v_cvt_pk_bf16_f32 v176, v184, v185
    v_cvt_pk_bf16_f32 v177, v186, v187
    v_cvt_pk_bf16_f32 v178, v188, v189
    v_cvt_pk_bf16_f32 v179, v190, v191
    v_cvt_pk_bf16_f32 v180, v192, v193
    v_cvt_pk_bf16_f32 v181, v194, v195
    v_cvt_pk_bf16_f32 v182, v196, v197
    v_cvt_pk_bf16_f32 v183, v198, v199
    v_mfma_f32_32x32x16_bf16 v[160:175], v[76:79], v[52:55], v[160:175]
    ds_read_b64_tr_b16 v[120:121], v243 offset:2048
    ds_read_b64_tr_b16 v[122:123], v243 offset:2560
    ds_read_b64_tr_b16 v[124:125], v244 offset:2048
    ds_read_b64_tr_b16 v[126:127], v244 offset:2560
    s_add_u32 m0, s60, 52224
    s_nop 0
    buffer_load_dwordx4 v236, s[12:15], s58 offen lds
    s_nop 1
    v_permlane32_swap_b32 v176, v178
    v_permlane32_swap_b32 v177, v179
    v_permlane32_swap_b32 v180, v182
    v_permlane32_swap_b32 v181, v183
    s_movk_i32 s33, 8192
    buffer_store_dwordx4 v[176:179], v12, s[8:11], s33 offen offset:0
    buffer_store_dwordx4 v[180:183], v12, s[8:11], s33 offen offset:1024
    v_mfma_f32_32x32x16_bf16 v[144:159], v[80:83], v[56:59], v[144:159]
    ds_read_b128 v[104:107], v241 offset:0
    ds_read_b64_tr_b16 v[128:129], v243 offset:4096
    ds_read_b64_tr_b16 v[130:131], v243 offset:4608
    ds_read_b64_tr_b16 v[132:133], v244 offset:4096
    s_add_u32 m0, s61, 49152
    s_nop 0
    buffer_load_dwordx4 v237, s[4:7], s59 offen lds
    v_accvgpr_read_b32 v208, a80
    v_accvgpr_read_b32 v209, a81
    v_accvgpr_read_b32 v210, a82
    v_accvgpr_read_b32 v211, a83
    v_accvgpr_read_b32 v212, a84
    v_accvgpr_read_b32 v213, a85
    v_accvgpr_read_b32 v214, a86
    v_accvgpr_read_b32 v215, a87
    v_mfma_f32_32x32x16_bf16 v[160:175], v[84:87], v[56:59], v[160:175]
    ds_read_b64_tr_b16 v[134:135], v244 offset:4608
    ds_read_b128 v[108:111], v242 offset:0
    ds_read_b64_tr_b16 v[136:137], v243 offset:6144
    ds_read_b64_tr_b16 v[138:139], v243 offset:6656
    s_add_u32 m0, s61, 50176
    s_nop 0
    buffer_load_dwordx4 v238, s[4:7], s59 offen lds
    v_accvgpr_read_b32 v216, a88
    v_accvgpr_read_b32 v217, a89
    v_accvgpr_read_b32 v218, a90
    v_accvgpr_read_b32 v219, a91
    v_accvgpr_read_b32 v220, a92
    v_accvgpr_read_b32 v221, a93
    v_accvgpr_read_b32 v222, a94
    v_accvgpr_read_b32 v223, a95
    v_mfma_f32_32x32x16_bf16 v[144:159], v[88:91], v[60:63], v[144:159]
    ds_read_b64_tr_b16 v[140:141], v244 offset:6144
    ds_read_b64_tr_b16 v[142:143], v244 offset:6656
    v_cvt_pk_bf16_f32 v200, v208, v209
    v_cvt_pk_bf16_f32 v201, v210, v211
    v_cvt_pk_bf16_f32 v202, v212, v213
    v_cvt_pk_bf16_f32 v203, v214, v215
    v_cvt_pk_bf16_f32 v204, v216, v217
    v_cvt_pk_bf16_f32 v205, v218, v219
    v_cvt_pk_bf16_f32 v206, v220, v221
    v_cvt_pk_bf16_f32 v207, v222, v223
    v_mfma_f32_32x32x16_bf16 v[160:175], v[92:95], v[60:63], v[160:175]
    s_nop 1
    v_permlane32_swap_b32 v200, v202
    v_permlane32_swap_b32 v201, v203
    v_permlane32_swap_b32 v204, v206
    v_permlane32_swap_b32 v205, v207
    s_movk_i32 s33, 10240
    buffer_store_dwordx4 v[200:203], v12, s[8:11], s33 offen offset:0
    buffer_store_dwordx4 v[204:207], v12, s[8:11], s33 offen offset:1024
    s_add_u32 s58, s58, 128
    s_add_u32 s59, s59, 8192
    s_and_b32 s58, s58, 4095
    s_and_b32 s59, s59, 262143
    s_waitcnt vmcnt(24) lgkmcnt(0)
    s_barrier
    v_mfma_f32_32x32x16_bf16 v[144:159], v[112:115], v[96:99], v[144:159]
    v_add_u32 v239, 24576, v239
    v_add_u32 v240, 24576, v240
    v_add_u32 v241, 24576, v241
    v_add_u32 v242, 24576, v242
    s_add_u32 m0, s60, 73728
    s_nop 0
    buffer_load_dwordx4 v233, s[12:15], s58 offen lds
    v_accvgpr_read_b32 v184, a96
    v_accvgpr_read_b32 v185, a97
    v_accvgpr_read_b32 v186, a98
    v_accvgpr_read_b32 v187, a99
    v_accvgpr_read_b32 v188, a100
    v_accvgpr_read_b32 v189, a101
    v_accvgpr_read_b32 v190, a102
    v_accvgpr_read_b32 v191, a103
    v_mfma_f32_32x32x16_bf16 v[160:175], v[116:119], v[96:99], v[160:175]
    v_add_u32 v243, 24576, v243
    v_add_u32 v244, 24576, v244
    ds_read_b128 v[48:51], v239 offset:0
    ds_read_b64_tr_b16 v[64:65], v243 offset:0
    s_add_u32 m0, s60, 74752
    s_nop 0
    buffer_load_dwordx4 v234, s[12:15], s58 offen lds
    v_accvgpr_read_b32 v192, a104
    v_accvgpr_read_b32 v193, a105
    v_accvgpr_read_b32 v194, a106
    v_accvgpr_read_b32 v195, a107
    v_accvgpr_read_b32 v196, a108
    v_accvgpr_read_b32 v197, a109
    v_accvgpr_read_b32 v198, a110
    v_accvgpr_read_b32 v199, a111
    v_mfma_f32_32x32x16_bf16 v[144:159], v[120:123], v[100:103], v[144:159]
    ds_read_b64_tr_b16 v[66:67], v243 offset:512
    ds_read_b64_tr_b16 v[68:69], v244 offset:0
    ds_read_b64_tr_b16 v[70:71], v244 offset:512
    ds_read_b128 v[52:55], v240 offset:0
    s_add_u32 m0, s60, 75776
    s_nop 0
    buffer_load_dwordx4 v235, s[12:15], s58 offen lds
    v_cvt_pk_bf16_f32 v176, v184, v185
    v_cvt_pk_bf16_f32 v177, v186, v187
    v_cvt_pk_bf16_f32 v178, v188, v189
    v_cvt_pk_bf16_f32 v179, v190, v191
    v_cvt_pk_bf16_f32 v180, v192, v193
    v_cvt_pk_bf16_f32 v181, v194, v195
    v_cvt_pk_bf16_f32 v182, v196, v197
    v_cvt_pk_bf16_f32 v183, v198, v199
    v_mfma_f32_32x32x16_bf16 v[160:175], v[124:127], v[100:103], v[160:175]
    ds_read_b64_tr_b16 v[72:73], v243 offset:2048
    ds_read_b64_tr_b16 v[74:75], v243 offset:2560
    ds_read_b64_tr_b16 v[76:77], v244 offset:2048
    ds_read_b64_tr_b16 v[78:79], v244 offset:2560
    s_add_u32 m0, s60, 76800
    s_nop 0
    buffer_load_dwordx4 v236, s[12:15], s58 offen lds
    s_nop 1
    v_permlane32_swap_b32 v176, v178
    v_permlane32_swap_b32 v177, v179
    v_permlane32_swap_b32 v180, v182
    v_permlane32_swap_b32 v181, v183
    s_movk_i32 s33, 12288
    buffer_store_dwordx4 v[176:179], v12, s[8:11], s33 offen offset:0
    buffer_store_dwordx4 v[180:183], v12, s[8:11], s33 offen offset:1024
    v_mfma_f32_32x32x16_bf16 v[144:159], v[128:131], v[104:107], v[144:159]
    ds_read_b128 v[56:59], v241 offset:0
    ds_read_b64_tr_b16 v[80:81], v243 offset:4096
    ds_read_b64_tr_b16 v[82:83], v243 offset:4608
    ds_read_b64_tr_b16 v[84:85], v244 offset:4096
    s_add_u32 m0, s61, 73728
    s_nop 0
    buffer_load_dwordx4 v237, s[4:7], s59 offen lds
    v_accvgpr_read_b32 v208, a112
    v_accvgpr_read_b32 v209, a113
    v_accvgpr_read_b32 v210, a114
    v_accvgpr_read_b32 v211, a115
    v_accvgpr_read_b32 v212, a116
    v_accvgpr_read_b32 v213, a117
    v_accvgpr_read_b32 v214, a118
    v_accvgpr_read_b32 v215, a119
    v_mfma_f32_32x32x16_bf16 v[160:175], v[132:135], v[104:107], v[160:175]
    ds_read_b64_tr_b16 v[86:87], v244 offset:4608
    ds_read_b128 v[60:63], v242 offset:0
    ds_read_b64_tr_b16 v[88:89], v243 offset:6144
    ds_read_b64_tr_b16 v[90:91], v243 offset:6656
    s_add_u32 m0, s61, 74752
    s_nop 0
    buffer_load_dwordx4 v238, s[4:7], s59 offen lds
    v_accvgpr_read_b32 v216, a120
    v_accvgpr_read_b32 v217, a121
    v_accvgpr_read_b32 v218, a122
    v_accvgpr_read_b32 v219, a123
    v_accvgpr_read_b32 v220, a124
    v_accvgpr_read_b32 v221, a125
    v_accvgpr_read_b32 v222, a126
    v_accvgpr_read_b32 v223, a127
    v_mfma_f32_32x32x16_bf16 v[144:159], v[136:139], v[108:111], v[144:159]
    ds_read_b64_tr_b16 v[92:93], v244 offset:6144
    ds_read_b64_tr_b16 v[94:95], v244 offset:6656
    v_cvt_pk_bf16_f32 v200, v208, v209
    v_cvt_pk_bf16_f32 v201, v210, v211
    v_cvt_pk_bf16_f32 v202, v212, v213
    v_cvt_pk_bf16_f32 v203, v214, v215
    v_cvt_pk_bf16_f32 v204, v216, v217
    v_cvt_pk_bf16_f32 v205, v218, v219
    v_cvt_pk_bf16_f32 v206, v220, v221
    v_cvt_pk_bf16_f32 v207, v222, v223
    v_mfma_f32_32x32x16_bf16 v[160:175], v[140:143], v[108:111], v[160:175]
    s_nop 1
    v_permlane32_swap_b32 v200, v202
    v_permlane32_swap_b32 v201, v203
    v_permlane32_swap_b32 v204, v206
    v_permlane32_swap_b32 v205, v207
    s_movk_i32 s33, 14336
    buffer_store_dwordx4 v[200:203], v12, s[8:11], s33 offen offset:0
    buffer_store_dwordx4 v[204:207], v12, s[8:11], s33 offen offset:1024
    s_add_u32 s58, s58, 128
    s_add_u32 s59, s59, 8192
    s_and_b32 s58, s58, 4095
    s_and_b32 s59, s59, 262143
    s_waitcnt vmcnt(24) lgkmcnt(0)
    s_barrier
    v_mfma_f32_32x32x16_bf16 v[144:159], v[64:67], v[48:51], v[144:159]
    v_add_u32 v239, 24576, v239
    v_add_u32 v240, 24576, v240
    v_add_u32 v241, 24576, v241
    v_add_u32 v242, 24576, v242
    s_add_u32 m0, s60, 98304
    s_nop 0
    buffer_load_dwordx4 v233, s[12:15], s58 offen lds
    v_accvgpr_read_b32 v184, a128
    v_accvgpr_read_b32 v185, a129
    v_accvgpr_read_b32 v186, a130
    v_accvgpr_read_b32 v187, a131
    v_accvgpr_read_b32 v188, a132
    v_accvgpr_read_b32 v189, a133
    v_accvgpr_read_b32 v190, a134
    v_accvgpr_read_b32 v191, a135
    v_mfma_f32_32x32x16_bf16 v[160:175], v[68:71], v[48:51], v[160:175]
    v_add_u32 v243, 24576, v243
    v_add_u32 v244, 24576, v244
    ds_read_b128 v[96:99], v239 offset:0
    ds_read_b64_tr_b16 v[112:113], v243 offset:0
    s_add_u32 m0, s60, 99328
    s_nop 0
    buffer_load_dwordx4 v234, s[12:15], s58 offen lds
    v_accvgpr_read_b32 v192, a136
    v_accvgpr_read_b32 v193, a137
    v_accvgpr_read_b32 v194, a138
    v_accvgpr_read_b32 v195, a139
    v_accvgpr_read_b32 v196, a140
    v_accvgpr_read_b32 v197, a141
    v_accvgpr_read_b32 v198, a142
    v_accvgpr_read_b32 v199, a143
    v_mfma_f32_32x32x16_bf16 v[144:159], v[72:75], v[52:55], v[144:159]
    ds_read_b64_tr_b16 v[114:115], v243 offset:512
    ds_read_b64_tr_b16 v[116:117], v244 offset:0
    ds_read_b64_tr_b16 v[118:119], v244 offset:512
    ds_read_b128 v[100:103], v240 offset:0
    s_add_u32 m0, s60, 100352
    s_nop 0
    buffer_load_dwordx4 v235, s[12:15], s58 offen lds
    v_cvt_pk_bf16_f32 v176, v184, v185
    v_cvt_pk_bf16_f32 v177, v186, v187
    v_cvt_pk_bf16_f32 v178, v188, v189
    v_cvt_pk_bf16_f32 v179, v190, v191
    v_cvt_pk_bf16_f32 v180, v192, v193
    v_cvt_pk_bf16_f32 v181, v194, v195
    v_cvt_pk_bf16_f32 v182, v196, v197
    v_cvt_pk_bf16_f32 v183, v198, v199
    v_mfma_f32_32x32x16_bf16 v[160:175], v[76:79], v[52:55], v[160:175]
    ds_read_b64_tr_b16 v[120:121], v243 offset:2048
    ds_read_b64_tr_b16 v[122:123], v243 offset:2560
    ds_read_b64_tr_b16 v[124:125], v244 offset:2048
    ds_read_b64_tr_b16 v[126:127], v244 offset:2560
    s_add_u32 m0, s60, 101376
    s_nop 0
    buffer_load_dwordx4 v236, s[12:15], s58 offen lds
    s_nop 1
    v_permlane32_swap_b32 v176, v178
    v_permlane32_swap_b32 v177, v179
    v_permlane32_swap_b32 v180, v182
    v_permlane32_swap_b32 v181, v183
    s_movk_i32 s33, 16384
    buffer_store_dwordx4 v[176:179], v12, s[8:11], s33 offen offset:0
    buffer_store_dwordx4 v[180:183], v12, s[8:11], s33 offen offset:1024
    v_mfma_f32_32x32x16_bf16 v[144:159], v[80:83], v[56:59], v[144:159]
    ds_read_b128 v[104:107], v241 offset:0
    ds_read_b64_tr_b16 v[128:129], v243 offset:4096
    ds_read_b64_tr_b16 v[130:131], v243 offset:4608
    ds_read_b64_tr_b16 v[132:133], v244 offset:4096
    s_add_u32 m0, s61, 98304
    s_nop 0
    buffer_load_dwordx4 v237, s[4:7], s59 offen lds
    v_accvgpr_read_b32 v208, a144
    v_accvgpr_read_b32 v209, a145
    v_accvgpr_read_b32 v210, a146
    v_accvgpr_read_b32 v211, a147
    v_accvgpr_read_b32 v212, a148
    v_accvgpr_read_b32 v213, a149
    v_accvgpr_read_b32 v214, a150
    v_accvgpr_read_b32 v215, a151
    v_mfma_f32_32x32x16_bf16 v[160:175], v[84:87], v[56:59], v[160:175]
    ds_read_b64_tr_b16 v[134:135], v244 offset:4608
    ds_read_b128 v[108:111], v242 offset:0
    ds_read_b64_tr_b16 v[136:137], v243 offset:6144
    ds_read_b64_tr_b16 v[138:139], v243 offset:6656
    s_add_u32 m0, s61, 99328
    s_nop 0
    buffer_load_dwordx4 v238, s[4:7], s59 offen lds
    v_accvgpr_read_b32 v216, a152
    v_accvgpr_read_b32 v217, a153
    v_accvgpr_read_b32 v218, a154
    v_accvgpr_read_b32 v219, a155
    v_accvgpr_read_b32 v220, a156
    v_accvgpr_read_b32 v221, a157
    v_accvgpr_read_b32 v222, a158
    v_accvgpr_read_b32 v223, a159
    v_mfma_f32_32x32x16_bf16 v[144:159], v[88:91], v[60:63], v[144:159]
    ds_read_b64_tr_b16 v[140:141], v244 offset:6144
    ds_read_b64_tr_b16 v[142:143], v244 offset:6656
    v_cvt_pk_bf16_f32 v200, v208, v209
    v_cvt_pk_bf16_f32 v201, v210, v211
    v_cvt_pk_bf16_f32 v202, v212, v213
    v_cvt_pk_bf16_f32 v203, v214, v215
    v_cvt_pk_bf16_f32 v204, v216, v217
    v_cvt_pk_bf16_f32 v205, v218, v219
    v_cvt_pk_bf16_f32 v206, v220, v221
    v_cvt_pk_bf16_f32 v207, v222, v223
    v_mfma_f32_32x32x16_bf16 v[160:175], v[92:95], v[60:63], v[160:175]
    s_nop 1
    v_permlane32_swap_b32 v200, v202
    v_permlane32_swap_b32 v201, v203
    v_permlane32_swap_b32 v204, v206
    v_permlane32_swap_b32 v205, v207
    s_movk_i32 s33, 18432
    buffer_store_dwordx4 v[200:203], v12, s[8:11], s33 offen offset:0
    buffer_store_dwordx4 v[204:207], v12, s[8:11], s33 offen offset:1024
    s_add_u32 s58, s58, 128
    s_add_u32 s59, s59, 8192
    s_and_b32 s58, s58, 4095
    s_and_b32 s59, s59, 262143
    s_waitcnt vmcnt(24) lgkmcnt(0)
    s_barrier
    v_mfma_f32_32x32x16_bf16 v[144:159], v[112:115], v[96:99], v[144:159]
    v_add_u32 v239, 4294844416, v239
    v_add_u32 v240, 4294844416, v240
    v_add_u32 v241, 4294844416, v241
    v_add_u32 v242, 4294844416, v242
    s_add_u32 m0, s60, 122880
    s_nop 0
    buffer_load_dwordx4 v233, s[12:15], s58 offen lds
    v_accvgpr_read_b32 v184, a160
    v_accvgpr_read_b32 v185, a161
    v_accvgpr_read_b32 v186, a162
    v_accvgpr_read_b32 v187, a163
    v_accvgpr_read_b32 v188, a164
    v_accvgpr_read_b32 v189, a165
    v_accvgpr_read_b32 v190, a166
    v_accvgpr_read_b32 v191, a167
    v_mfma_f32_32x32x16_bf16 v[160:175], v[116:119], v[96:99], v[160:175]
    v_add_u32 v243, 4294844416, v243
    v_add_u32 v244, 4294844416, v244
    ds_read_b128 v[48:51], v239 offset:0
    ds_read_b64_tr_b16 v[64:65], v243 offset:0
    s_add_u32 m0, s60, 123904
    s_nop 0
    buffer_load_dwordx4 v234, s[12:15], s58 offen lds
    v_accvgpr_read_b32 v192, a168
    v_accvgpr_read_b32 v193, a169
    v_accvgpr_read_b32 v194, a170
    v_accvgpr_read_b32 v195, a171
    v_accvgpr_read_b32 v196, a172
    v_accvgpr_read_b32 v197, a173
    v_accvgpr_read_b32 v198, a174
    v_accvgpr_read_b32 v199, a175
    v_mfma_f32_32x32x16_bf16 v[144:159], v[120:123], v[100:103], v[144:159]
    ds_read_b64_tr_b16 v[66:67], v243 offset:512
    ds_read_b64_tr_b16 v[68:69], v244 offset:0
    ds_read_b64_tr_b16 v[70:71], v244 offset:512
    ds_read_b128 v[52:55], v240 offset:0
    s_add_u32 m0, s60, 124928
    s_nop 0
    buffer_load_dwordx4 v235, s[12:15], s58 offen lds
    v_cvt_pk_bf16_f32 v176, v184, v185
    v_cvt_pk_bf16_f32 v177, v186, v187
    v_cvt_pk_bf16_f32 v178, v188, v189
    v_cvt_pk_bf16_f32 v179, v190, v191
    v_cvt_pk_bf16_f32 v180, v192, v193
    v_cvt_pk_bf16_f32 v181, v194, v195
    v_cvt_pk_bf16_f32 v182, v196, v197
    v_cvt_pk_bf16_f32 v183, v198, v199
    v_mfma_f32_32x32x16_bf16 v[160:175], v[124:127], v[100:103], v[160:175]
    ds_read_b64_tr_b16 v[72:73], v243 offset:2048
    ds_read_b64_tr_b16 v[74:75], v243 offset:2560
    ds_read_b64_tr_b16 v[76:77], v244 offset:2048
    ds_read_b64_tr_b16 v[78:79], v244 offset:2560
    s_add_u32 m0, s60, 125952
    s_nop 0
    buffer_load_dwordx4 v236, s[12:15], s58 offen lds
    s_nop 1
    v_permlane32_swap_b32 v176, v178
    v_permlane32_swap_b32 v177, v179
    v_permlane32_swap_b32 v180, v182
    v_permlane32_swap_b32 v181, v183
    s_movk_i32 s33, 20480
    buffer_store_dwordx4 v[176:179], v12, s[8:11], s33 offen offset:0
    buffer_store_dwordx4 v[180:183], v12, s[8:11], s33 offen offset:1024
    v_mfma_f32_32x32x16_bf16 v[144:159], v[128:131], v[104:107], v[144:159]
    ds_read_b128 v[56:59], v241 offset:0
    ds_read_b64_tr_b16 v[80:81], v243 offset:4096
    ds_read_b64_tr_b16 v[82:83], v243 offset:4608
    ds_read_b64_tr_b16 v[84:85], v244 offset:4096
    s_add_u32 m0, s61, 122880
    s_nop 0
    buffer_load_dwordx4 v237, s[4:7], s59 offen lds
    v_accvgpr_read_b32 v208, a176
    v_accvgpr_read_b32 v209, a177
    v_accvgpr_read_b32 v210, a178
    v_accvgpr_read_b32 v211, a179
    v_accvgpr_read_b32 v212, a180
    v_accvgpr_read_b32 v213, a181
    v_accvgpr_read_b32 v214, a182
    v_accvgpr_read_b32 v215, a183
    v_mfma_f32_32x32x16_bf16 v[160:175], v[132:135], v[104:107], v[160:175]
    ds_read_b64_tr_b16 v[86:87], v244 offset:4608
    ds_read_b128 v[60:63], v242 offset:0
    ds_read_b64_tr_b16 v[88:89], v243 offset:6144
    ds_read_b64_tr_b16 v[90:91], v243 offset:6656
    s_add_u32 m0, s61, 123904
    s_nop 0
    buffer_load_dwordx4 v238, s[4:7], s59 offen lds
    v_accvgpr_read_b32 v216, a184
    v_accvgpr_read_b32 v217, a185
    v_accvgpr_read_b32 v218, a186
    v_accvgpr_read_b32 v219, a187
    v_accvgpr_read_b32 v220, a188
    v_accvgpr_read_b32 v221, a189
    v_accvgpr_read_b32 v222, a190
    v_accvgpr_read_b32 v223, a191
    v_mfma_f32_32x32x16_bf16 v[144:159], v[136:139], v[108:111], v[144:159]
    ds_read_b64_tr_b16 v[92:93], v244 offset:6144
    ds_read_b64_tr_b16 v[94:95], v244 offset:6656
    v_cvt_pk_bf16_f32 v200, v208, v209
    v_cvt_pk_bf16_f32 v201, v210, v211
    v_cvt_pk_bf16_f32 v202, v212, v213
    v_cvt_pk_bf16_f32 v203, v214, v215
    v_cvt_pk_bf16_f32 v204, v216, v217
    v_cvt_pk_bf16_f32 v205, v218, v219
    v_cvt_pk_bf16_f32 v206, v220, v221
    v_cvt_pk_bf16_f32 v207, v222, v223
    v_mfma_f32_32x32x16_bf16 v[160:175], v[140:143], v[108:111], v[160:175]
    s_nop 1
    v_permlane32_swap_b32 v200, v202
    v_permlane32_swap_b32 v201, v203
    v_permlane32_swap_b32 v204, v206
    v_permlane32_swap_b32 v205, v207
    s_movk_i32 s33, 22528
    buffer_store_dwordx4 v[200:203], v12, s[8:11], s33 offen offset:0
    buffer_store_dwordx4 v[204:207], v12, s[8:11], s33 offen offset:1024
    s_add_u32 s58, s58, 128
    s_add_u32 s59, s59, 8192
    s_and_b32 s58, s58, 4095
    s_and_b32 s59, s59, 262143
    s_waitcnt vmcnt(24) lgkmcnt(0)
    s_barrier
    v_mfma_f32_32x32x16_bf16 v[144:159], v[64:67], v[48:51], v[144:159]
    v_add_u32 v239, 24576, v239
    v_add_u32 v240, 24576, v240
    v_add_u32 v241, 24576, v241
    v_add_u32 v242, 24576, v242
    s_add_u32 m0, s60, 0
    s_nop 0
    buffer_load_dwordx4 v233, s[12:15], s58 offen lds
    v_accvgpr_read_b32 v184, a192
    v_accvgpr_read_b32 v185, a193
    v_accvgpr_read_b32 v186, a194
    v_accvgpr_read_b32 v187, a195
    v_accvgpr_read_b32 v188, a196
    v_accvgpr_read_b32 v189, a197
    v_accvgpr_read_b32 v190, a198
    v_accvgpr_read_b32 v191, a199
    v_mfma_f32_32x32x16_bf16 v[160:175], v[68:71], v[48:51], v[160:175]
    v_add_u32 v243, 24576, v243
    v_add_u32 v244, 24576, v244
    ds_read_b128 v[96:99], v239 offset:0
    ds_read_b64_tr_b16 v[112:113], v243 offset:0
    s_add_u32 m0, s60, 1024
    s_nop 0
    buffer_load_dwordx4 v234, s[12:15], s58 offen lds
    v_accvgpr_read_b32 v192, a200
    v_accvgpr_read_b32 v193, a201
    v_accvgpr_read_b32 v194, a202
    v_accvgpr_read_b32 v195, a203
    v_accvgpr_read_b32 v196, a204
    v_accvgpr_read_b32 v197, a205
    v_accvgpr_read_b32 v198, a206
    v_accvgpr_read_b32 v199, a207
    v_mfma_f32_32x32x16_bf16 v[144:159], v[72:75], v[52:55], v[144:159]
    ds_read_b64_tr_b16 v[114:115], v243 offset:512
    ds_read_b64_tr_b16 v[116:117], v244 offset:0
    ds_read_b64_tr_b16 v[118:119], v244 offset:512
    ds_read_b128 v[100:103], v240 offset:0
    s_add_u32 m0, s60, 2048
    s_nop 0
    buffer_load_dwordx4 v235, s[12:15], s58 offen lds
    v_cvt_pk_bf16_f32 v176, v184, v185
    v_cvt_pk_bf16_f32 v177, v186, v187
    v_cvt_pk_bf16_f32 v178, v188, v189
    v_cvt_pk_bf16_f32 v179, v190, v191
    v_cvt_pk_bf16_f32 v180, v192, v193
    v_cvt_pk_bf16_f32 v181, v194, v195
    v_cvt_pk_bf16_f32 v182, v196, v197
    v_cvt_pk_bf16_f32 v183, v198, v199
    v_mfma_f32_32x32x16_bf16 v[160:175], v[76:79], v[52:55], v[160:175]
    ds_read_b64_tr_b16 v[120:121], v243 offset:2048
    ds_read_b64_tr_b16 v[122:123], v243 offset:2560
    ds_read_b64_tr_b16 v[124:125], v244 offset:2048
    ds_read_b64_tr_b16 v[126:127], v244 offset:2560
    s_add_u32 m0, s60, 3072
    s_nop 0
    buffer_load_dwordx4 v236, s[12:15], s58 offen lds
    s_nop 1
    v_permlane32_swap_b32 v176, v178
    v_permlane32_swap_b32 v177, v179
    v_permlane32_swap_b32 v180, v182
    v_permlane32_swap_b32 v181, v183
    s_movk_i32 s33, 24576
    buffer_store_dwordx4 v[176:179], v12, s[8:11], s33 offen offset:0
    buffer_store_dwordx4 v[180:183], v12, s[8:11], s33 offen offset:1024
    v_mfma_f32_32x32x16_bf16 v[144:159], v[80:83], v[56:59], v[144:159]
    ds_read_b128 v[104:107], v241 offset:0
    ds_read_b64_tr_b16 v[128:129], v243 offset:4096
    ds_read_b64_tr_b16 v[130:131], v243 offset:4608
    ds_read_b64_tr_b16 v[132:133], v244 offset:4096
    s_add_u32 m0, s61, 0
    s_nop 0
    buffer_load_dwordx4 v237, s[4:7], s59 offen lds
    v_accvgpr_read_b32 v208, a208
    v_accvgpr_read_b32 v209, a209
    v_accvgpr_read_b32 v210, a210
    v_accvgpr_read_b32 v211, a211
    v_accvgpr_read_b32 v212, a212
    v_accvgpr_read_b32 v213, a213
    v_accvgpr_read_b32 v214, a214
    v_accvgpr_read_b32 v215, a215
    v_mfma_f32_32x32x16_bf16 v[160:175], v[84:87], v[56:59], v[160:175]
    ds_read_b64_tr_b16 v[134:135], v244 offset:4608
    ds_read_b128 v[108:111], v242 offset:0
    ds_read_b64_tr_b16 v[136:137], v243 offset:6144
    ds_read_b64_tr_b16 v[138:139], v243 offset:6656
    s_add_u32 m0, s61, 1024
    s_nop 0
    buffer_load_dwordx4 v238, s[4:7], s59 offen lds
    v_accvgpr_read_b32 v216, a216
    v_accvgpr_read_b32 v217, a217
    v_accvgpr_read_b32 v218, a218
    v_accvgpr_read_b32 v219, a219
    v_accvgpr_read_b32 v220, a220
    v_accvgpr_read_b32 v221, a221
    v_accvgpr_read_b32 v222, a222
    v_accvgpr_read_b32 v223, a223
    v_mfma_f32_32x32x16_bf16 v[144:159], v[88:91], v[60:63], v[144:159]
    ds_read_b64_tr_b16 v[140:141], v244 offset:6144
    ds_read_b64_tr_b16 v[142:143], v244 offset:6656
    v_cvt_pk_bf16_f32 v200, v208, v209
    v_cvt_pk_bf16_f32 v201, v210, v211
    v_cvt_pk_bf16_f32 v202, v212, v213
    v_cvt_pk_bf16_f32 v203, v214, v215
    v_cvt_pk_bf16_f32 v204, v216, v217
    v_cvt_pk_bf16_f32 v205, v218, v219
    v_cvt_pk_bf16_f32 v206, v220, v221
    v_cvt_pk_bf16_f32 v207, v222, v223
    v_mfma_f32_32x32x16_bf16 v[160:175], v[92:95], v[60:63], v[160:175]
    s_nop 1
    v_permlane32_swap_b32 v200, v202
    v_permlane32_swap_b32 v201, v203
    v_permlane32_swap_b32 v204, v206
    v_permlane32_swap_b32 v205, v207
    s_movk_i32 s33, 26624
    buffer_store_dwordx4 v[200:203], v12, s[8:11], s33 offen offset:0
    buffer_store_dwordx4 v[204:207], v12, s[8:11], s33 offen offset:1024
    s_add_u32 s58, s58, 128
    s_add_u32 s59, s59, 8192
    s_and_b32 s58, s58, 4095
    s_and_b32 s59, s59, 262143
    s_waitcnt vmcnt(24) lgkmcnt(0)
    s_barrier
    v_mfma_f32_32x32x16_bf16 v[144:159], v[112:115], v[96:99], v[144:159]
    v_add_u32 v239, 24576, v239
    v_add_u32 v240, 24576, v240
    v_add_u32 v241, 24576, v241
    v_add_u32 v242, 24576, v242
    s_add_u32 m0, s60, 24576
    s_nop 0
    buffer_load_dwordx4 v233, s[12:15], s58 offen lds
    v_mfma_f32_32x32x16_bf16 v[160:175], v[116:119], v[96:99], v[160:175]
    v_add_u32 v243, 24576, v243
    v_add_u32 v244, 24576, v244
    ds_read_b128 v[48:51], v239 offset:0
    ds_read_b64_tr_b16 v[64:65], v243 offset:0
    s_add_u32 m0, s60, 25600
    s_nop 0
    buffer_load_dwordx4 v234, s[12:15], s58 offen lds
    v_mfma_f32_32x32x16_bf16 v[144:159], v[120:123], v[100:103], v[144:159]
    ds_read_b64_tr_b16 v[66:67], v243 offset:512
    ds_read_b64_tr_b16 v[68:69], v244 offset:0
    ds_read_b64_tr_b16 v[70:71], v244 offset:512
    ds_read_b128 v[52:55], v240 offset:0
    s_add_u32 m0, s60, 26624
    s_nop 0
    buffer_load_dwordx4 v235, s[12:15], s58 offen lds
    v_mfma_f32_32x32x16_bf16 v[160:175], v[124:127], v[100:103], v[160:175]
    ds_read_b64_tr_b16 v[72:73], v243 offset:2048
    ds_read_b64_tr_b16 v[74:75], v243 offset:2560
    ds_read_b64_tr_b16 v[76:77], v244 offset:2048
    ds_read_b64_tr_b16 v[78:79], v244 offset:2560
    s_add_u32 m0, s60, 27648
    s_nop 0
    buffer_load_dwordx4 v236, s[12:15], s58 offen lds
    v_mfma_f32_32x32x16_bf16 v[144:159], v[128:131], v[104:107], v[144:159]
    ds_read_b128 v[56:59], v241 offset:0
    ds_read_b64_tr_b16 v[80:81], v243 offset:4096
    ds_read_b64_tr_b16 v[82:83], v243 offset:4608
    ds_read_b64_tr_b16 v[84:85], v244 offset:4096
    s_add_u32 m0, s61, 24576
    s_nop 0
    buffer_load_dwordx4 v237, s[4:7], s59 offen lds
    v_mfma_f32_32x32x16_bf16 v[160:175], v[132:135], v[104:107], v[160:175]
    ds_read_b64_tr_b16 v[86:87], v244 offset:4608
    ds_read_b128 v[60:63], v242 offset:0
    ds_read_b64_tr_b16 v[88:89], v243 offset:6144
    ds_read_b64_tr_b16 v[90:91], v243 offset:6656
    s_add_u32 m0, s61, 25600
    s_nop 0
    buffer_load_dwordx4 v238, s[4:7], s59 offen lds
    v_mfma_f32_32x32x16_bf16 v[144:159], v[136:139], v[108:111], v[144:159]
    ds_read_b64_tr_b16 v[92:93], v244 offset:6144
    ds_read_b64_tr_b16 v[94:95], v244 offset:6656
    v_mfma_f32_32x32x16_bf16 v[160:175], v[140:143], v[108:111], v[160:175]
    s_add_u32 s58, s58, 128
    s_add_u32 s59, s59, 8192
    s_and_b32 s58, s58, 4095
    s_and_b32 s59, s59, 262143
    s_mov_b32 s62, 0
L_ag_loop:
    s_waitcnt vmcnt(24) lgkmcnt(0)
    s_barrier
    v_mfma_f32_32x32x16_bf16 v[144:159], v[64:67], v[48:51], v[144:159]
    v_add_u32 v239, 24576, v239
    v_add_u32 v240, 24576, v240
    v_add_u32 v241, 24576, v241
    v_add_u32 v242, 24576, v242
    s_add_u32 m0, s60, 49152
    s_nop 0
    buffer_load_dwordx4 v233, s[12:15], s58 offen lds
    v_mfma_f32_32x32x16_bf16 v[160:175], v[68:71], v[48:51], v[160:175]
    v_add_u32 v243, 24576, v243
    v_add_u32 v244, 24576, v244
    ds_read_b128 v[96:99], v239 offset:0
    ds_read_b64_tr_b16 v[112:113], v243 offset:0
    s_add_u32 m0, s60, 50176
    s_nop 0
    buffer_load_dwordx4 v234, s[12:15], s58 offen lds
    v_mfma_f32_32x32x16_bf16 v[144:159], v[72:75], v[52:55], v[144:159]
    ds_read_b64_tr_b16 v[114:115], v243 offset:512
    ds_read_b64_tr_b16 v[116:117], v244 offset:0
    ds_read_b64_tr_b16 v[118:119], v244 offset:512
    ds_read_b128 v[100:103], v240 offset:0
    s_add_u32 m0, s60, 51200
    s_nop 0
    buffer_load_dwordx4 v235, s[12:15], s58 offen lds
    v_mfma_f32_32x32x16_bf16 v[160:175], v[76:79], v[52:55], v[160:175]
    ds_read_b64_tr_b16 v[120:121], v243 offset:2048
    ds_read_b64_tr_b16 v[122:123], v243 offset:2560
    ds_read_b64_tr_b16 v[124:125], v244 offset:2048
    ds_read_b64_tr_b16 v[126:127], v244 offset:2560
    s_add_u32 m0, s60, 52224
    s_nop 0
    buffer_load_dwordx4 v236, s[12:15], s58 offen lds
    v_mfma_f32_32x32x16_bf16 v[144:159], v[80:83], v[56:59], v[144:159]
    ds_read_b128 v[104:107], v241 offset:0
    ds_read_b64_tr_b16 v[128:129], v243 offset:4096
    ds_read_b64_tr_b16 v[130:131], v243 offset:4608
    ds_read_b64_tr_b16 v[132:133], v244 offset:4096
    s_add_u32 m0, s61, 49152
    s_nop 0
    buffer_load_dwordx4 v237, s[4:7], s59 offen lds
    v_mfma_f32_32x32x16_bf16 v[160:175], v[84:87], v[56:59], v[160:175]
    ds_read_b64_tr_b16 v[134:135], v244 offset:4608
    ds_read_b128 v[108:111], v242 offset:0
    ds_read_b64_tr_b16 v[136:137], v243 offset:6144
    ds_read_b64_tr_b16 v[138:139], v243 offset:6656
    s_add_u32 m0, s61, 50176
    s_nop 0
    buffer_load_dwordx4 v238, s[4:7], s59 offen lds
    v_mfma_f32_32x32x16_bf16 v[144:159], v[88:91], v[60:63], v[144:159]
    ds_read_b64_tr_b16 v[140:141], v244 offset:6144
    ds_read_b64_tr_b16 v[142:143], v244 offset:6656
    v_mfma_f32_32x32x16_bf16 v[160:175], v[92:95], v[60:63], v[160:175]
    s_add_u32 s58, s58, 128
    s_add_u32 s59, s59, 8192
    s_and_b32 s58, s58, 4095
    s_and_b32 s59, s59, 262143
    s_waitcnt vmcnt(24) lgkmcnt(0)
    s_barrier
    v_mfma_f32_32x32x16_bf16 v[144:159], v[112:115], v[96:99], v[144:159]
    v_add_u32 v239, 24576, v239
    v_add_u32 v240, 24576, v240
    v_add_u32 v241, 24576, v241
    v_add_u32 v242, 24576, v242
    s_add_u32 m0, s60, 73728
    s_nop 0
    buffer_load_dwordx4 v233, s[12:15], s58 offen lds
    v_mfma_f32_32x32x16_bf16 v[160:175], v[116:119], v[96:99], v[160:175]
    v_add_u32 v243, 24576, v243
    v_add_u32 v244, 24576, v244
    ds_read_b128 v[48:51], v239 offset:0
    ds_read_b64_tr_b16 v[64:65], v243 offset:0
    s_add_u32 m0, s60, 74752
    s_nop 0
    buffer_load_dwordx4 v234, s[12:15], s58 offen lds
    v_mfma_f32_32x32x16_bf16 v[144:159], v[120:123], v[100:103], v[144:159]
    ds_read_b64_tr_b16 v[66:67], v243 offset:512
    ds_read_b64_tr_b16 v[68:69], v244 offset:0
    ds_read_b64_tr_b16 v[70:71], v244 offset:512
    ds_read_b128 v[52:55], v240 offset:0
    s_add_u32 m0, s60, 75776
    s_nop 0
    buffer_load_dwordx4 v235, s[12:15], s58 offen lds
    v_mfma_f32_32x32x16_bf16 v[160:175], v[124:127], v[100:103], v[160:175]
    ds_read_b64_tr_b16 v[72:73], v243 offset:2048
    ds_read_b64_tr_b16 v[74:75], v243 offset:2560
    ds_read_b64_tr_b16 v[76:77], v244 offset:2048
    ds_read_b64_tr_b16 v[78:79], v244 offset:2560
    s_add_u32 m0, s60, 76800
    s_nop 0
    buffer_load_dwordx4 v236, s[12:15], s58 offen lds
    v_mfma_f32_32x32x16_bf16 v[144:159], v[128:131], v[104:107], v[144:159]
    ds_read_b128 v[56:59], v241 offset:0
    ds_read_b64_tr_b16 v[80:81], v243 offset:4096
    ds_read_b64_tr_b16 v[82:83], v243 offset:4608
    ds_read_b64_tr_b16 v[84:85], v244 offset:4096
    s_add_u32 m0, s61, 73728
    s_nop 0
    buffer_load_dwordx4 v237, s[4:7], s59 offen lds
    v_mfma_f32_32x32x16_bf16 v[160:175], v[132:135], v[104:107], v[160:175]
    ds_read_b64_tr_b16 v[86:87], v244 offset:4608
    ds_read_b128 v[60:63], v242 offset:0
    ds_read_b64_tr_b16 v[88:89], v243 offset:6144
    ds_read_b64_tr_b16 v[90:91], v243 offset:6656
    s_add_u32 m0, s61, 74752
    s_nop 0
    buffer_load_dwordx4 v238, s[4:7], s59 offen lds
    v_mfma_f32_32x32x16_bf16 v[144:159], v[136:139], v[108:111], v[144:159]
    ds_read_b64_tr_b16 v[92:93], v244 offset:6144
    ds_read_b64_tr_b16 v[94:95], v244 offset:6656
    v_mfma_f32_32x32x16_bf16 v[160:175], v[140:143], v[108:111], v[160:175]
    s_add_u32 s58, s58, 128
    s_add_u32 s59, s59, 8192
    s_and_b32 s58, s58, 4095
    s_and_b32 s59, s59, 262143
    s_waitcnt vmcnt(24) lgkmcnt(0)
    s_barrier
    v_mfma_f32_32x32x16_bf16 v[144:159], v[64:67], v[48:51], v[144:159]
    v_add_u32 v239, 24576, v239
    v_add_u32 v240, 24576, v240
    v_add_u32 v241, 24576, v241
    v_add_u32 v242, 24576, v242
    s_add_u32 m0, s60, 98304
    s_nop 0
    buffer_load_dwordx4 v233, s[12:15], s58 offen lds
    v_mfma_f32_32x32x16_bf16 v[160:175], v[68:71], v[48:51], v[160:175]
    v_add_u32 v243, 24576, v243
    v_add_u32 v244, 24576, v244
    ds_read_b128 v[96:99], v239 offset:0
    ds_read_b64_tr_b16 v[112:113], v243 offset:0
    s_add_u32 m0, s60, 99328
    s_nop 0
    buffer_load_dwordx4 v234, s[12:15], s58 offen lds
    v_mfma_f32_32x32x16_bf16 v[144:159], v[72:75], v[52:55], v[144:159]
    ds_read_b64_tr_b16 v[114:115], v243 offset:512
    ds_read_b64_tr_b16 v[116:117], v244 offset:0
    ds_read_b64_tr_b16 v[118:119], v244 offset:512
    ds_read_b128 v[100:103], v240 offset:0
    s_add_u32 m0, s60, 100352
    s_nop 0
    buffer_load_dwordx4 v235, s[12:15], s58 offen lds
    v_mfma_f32_32x32x16_bf16 v[160:175], v[76:79], v[52:55], v[160:175]
    ds_read_b64_tr_b16 v[120:121], v243 offset:2048
    ds_read_b64_tr_b16 v[122:123], v243 offset:2560
    ds_read_b64_tr_b16 v[124:125], v244 offset:2048
    ds_read_b64_tr_b16 v[126:127], v244 offset:2560
    s_add_u32 m0, s60, 101376
    s_nop 0
    buffer_load_dwordx4 v236, s[12:15], s58 offen lds
    v_mfma_f32_32x32x16_bf16 v[144:159], v[80:83], v[56:59], v[144:159]
    ds_read_b128 v[104:107], v241 offset:0
    ds_read_b64_tr_b16 v[128:129], v243 offset:4096
    ds_read_b64_tr_b16 v[130:131], v243 offset:4608
    ds_read_b64_tr_b16 v[132:133], v244 offset:4096
    s_add_u32 m0, s61, 98304
    s_nop 0
    buffer_load_dwordx4 v237, s[4:7], s59 offen lds
    v_mfma_f32_32x32x16_bf16 v[160:175], v[84:87], v[56:59], v[160:175]
    ds_read_b64_tr_b16 v[134:135], v244 offset:4608
    ds_read_b128 v[108:111], v242 offset:0
    ds_read_b64_tr_b16 v[136:137], v243 offset:6144
    ds_read_b64_tr_b16 v[138:139], v243 offset:6656
    s_add_u32 m0, s61, 99328
    s_nop 0
    buffer_load_dwordx4 v238, s[4:7], s59 offen lds
    v_mfma_f32_32x32x16_bf16 v[144:159], v[88:91], v[60:63], v[144:159]
    ds_read_b64_tr_b16 v[140:141], v244 offset:6144
    ds_read_b64_tr_b16 v[142:143], v244 offset:6656
    v_mfma_f32_32x32x16_bf16 v[160:175], v[92:95], v[60:63], v[160:175]
    s_add_u32 s58, s58, 128
    s_add_u32 s59, s59, 8192
    s_and_b32 s58, s58, 4095
    s_and_b32 s59, s59, 262143
    s_waitcnt vmcnt(24) lgkmcnt(0)
    s_barrier
    v_mfma_f32_32x32x16_bf16 v[144:159], v[112:115], v[96:99], v[144:159]
    v_add_u32 v239, 4294844416, v239
    v_add_u32 v240, 4294844416, v240
    v_add_u32 v241, 4294844416, v241
    v_add_u32 v242, 4294844416, v242
    s_add_u32 m0, s60, 122880
    s_nop 0
    buffer_load_dwordx4 v233, s[12:15], s58 offen lds
    v_mfma_f32_32x32x16_bf16 v[160:175], v[116:119], v[96:99], v[160:175]
    v_add_u32 v243, 4294844416, v243
    v_add_u32 v244, 4294844416, v244
    ds_read_b128 v[48:51], v239 offset:0
    ds_read_b64_tr_b16 v[64:65], v243 offset:0
    s_add_u32 m0, s60, 123904
    s_nop 0
    buffer_load_dwordx4 v234, s[12:15], s58 offen lds
    v_mfma_f32_32x32x16_bf16 v[144:159], v[120:123], v[100:103], v[144:159]
    ds_read_b64_tr_b16 v[66:67], v243 offset:512
    ds_read_b64_tr_b16 v[68:69], v244 offset:0
    ds_read_b64_tr_b16 v[70:71], v244 offset:512
    ds_read_b128 v[52:55], v240 offset:0
    s_add_u32 m0, s60, 124928
    s_nop 0
    buffer_load_dwordx4 v235, s[12:15], s58 offen lds
    v_mfma_f32_32x32x16_bf16 v[160:175], v[124:127], v[100:103], v[160:175]
    ds_read_b64_tr_b16 v[72:73], v243 offset:2048
    ds_read_b64_tr_b16 v[74:75], v243 offset:2560
    ds_read_b64_tr_b16 v[76:77], v244 offset:2048
    ds_read_b64_tr_b16 v[78:79], v244 offset:2560
    s_add_u32 m0, s60, 125952
    s_nop 0
    buffer_load_dwordx4 v236, s[12:15], s58 offen lds
    v_mfma_f32_32x32x16_bf16 v[144:159], v[128:131], v[104:107], v[144:159]
    ds_read_b128 v[56:59], v241 offset:0
    ds_read_b64_tr_b16 v[80:81], v243 offset:4096
    ds_read_b64_tr_b16 v[82:83], v243 offset:4608
    ds_read_b64_tr_b16 v[84:85], v244 offset:4096
    s_add_u32 m0, s61, 122880
    s_nop 0
    buffer_load_dwordx4 v237, s[4:7], s59 offen lds
    v_mfma_f32_32x32x16_bf16 v[160:175], v[132:135], v[104:107], v[160:175]
    ds_read_b64_tr_b16 v[86:87], v244 offset:4608
    ds_read_b128 v[60:63], v242 offset:0
    ds_read_b64_tr_b16 v[88:89], v243 offset:6144
    ds_read_b64_tr_b16 v[90:91], v243 offset:6656
    s_add_u32 m0, s61, 123904
    s_nop 0
    buffer_load_dwordx4 v238, s[4:7], s59 offen lds
    v_mfma_f32_32x32x16_bf16 v[144:159], v[136:139], v[108:111], v[144:159]
    ds_read_b64_tr_b16 v[92:93], v244 offset:6144
    ds_read_b64_tr_b16 v[94:95], v244 offset:6656
    v_mfma_f32_32x32x16_bf16 v[160:175], v[140:143], v[108:111], v[160:175]
    s_add_u32 s58, s58, 128
    s_add_u32 s59, s59, 8192
    s_and_b32 s58, s58, 4095
    s_and_b32 s59, s59, 262143
    s_waitcnt vmcnt(24) lgkmcnt(0)
    s_barrier
    v_mfma_f32_32x32x16_bf16 v[144:159], v[64:67], v[48:51], v[144:159]
    v_add_u32 v239, 24576, v239
    v_add_u32 v240, 24576, v240
    v_add_u32 v241, 24576, v241
    v_add_u32 v242, 24576, v242
    s_add_u32 m0, s60, 0
    s_nop 0
    buffer_load_dwordx4 v233, s[12:15], s58 offen lds
    v_mfma_f32_32x32x16_bf16 v[160:175], v[68:71], v[48:51], v[160:175]
    v_add_u32 v243, 24576, v243
    v_add_u32 v244, 24576, v244
    ds_read_b128 v[96:99], v239 offset:0
    ds_read_b64_tr_b16 v[112:113], v243 offset:0
    s_add_u32 m0, s60, 1024
    s_nop 0
    buffer_load_dwordx4 v234, s[12:15], s58 offen lds
    v_mfma_f32_32x32x16_bf16 v[144:159], v[72:75], v[52:55], v[144:159]
    ds_read_b64_tr_b16 v[114:115], v243 offset:512
    ds_read_b64_tr_b16 v[116:117], v244 offset:0
    ds_read_b64_tr_b16 v[118:119], v244 offset:512
    ds_read_b128 v[100:103], v240 offset:0
    s_add_u32 m0, s60, 2048
    s_nop 0
    buffer_load_dwordx4 v235, s[12:15], s58 offen lds
    v_mfma_f32_32x32x16_bf16 v[160:175], v[76:79], v[52:55], v[160:175]
    ds_read_b64_tr_b16 v[120:121], v243 offset:2048
    ds_read_b64_tr_b16 v[122:123], v243 offset:2560
    ds_read_b64_tr_b16 v[124:125], v244 offset:2048
    ds_read_b64_tr_b16 v[126:127], v244 offset:2560
    s_add_u32 m0, s60, 3072
    s_nop 0
    buffer_load_dwordx4 v236, s[12:15], s58 offen lds
    v_mfma_f32_32x32x16_bf16 v[144:159], v[80:83], v[56:59], v[144:159]
    ds_read_b128 v[104:107], v241 offset:0
    ds_read_b64_tr_b16 v[128:129], v243 offset:4096
    ds_read_b64_tr_b16 v[130:131], v243 offset:4608
    ds_read_b64_tr_b16 v[132:133], v244 offset:4096
    s_add_u32 m0, s61, 0
    s_nop 0
    buffer_load_dwordx4 v237, s[4:7], s59 offen lds
    v_mfma_f32_32x32x16_bf16 v[160:175], v[84:87], v[56:59], v[160:175]
    ds_read_b64_tr_b16 v[134:135], v244 offset:4608
    ds_read_b128 v[108:111], v242 offset:0
    ds_read_b64_tr_b16 v[136:137], v243 offset:6144
    ds_read_b64_tr_b16 v[138:139], v243 offset:6656
    s_add_u32 m0, s61, 1024
    s_nop 0
    buffer_load_dwordx4 v238, s[4:7], s59 offen lds
    v_mfma_f32_32x32x16_bf16 v[144:159], v[88:91], v[60:63], v[144:159]
    ds_read_b64_tr_b16 v[140:141], v244 offset:6144
    ds_read_b64_tr_b16 v[142:143], v244 offset:6656
    v_mfma_f32_32x32x16_bf16 v[160:175], v[92:95], v[60:63], v[160:175]
    s_add_u32 s58, s58, 128
    s_add_u32 s59, s59, 8192
    s_and_b32 s58, s58, 4095
    s_and_b32 s59, s59, 262143
    s_waitcnt vmcnt(24) lgkmcnt(0)
    s_barrier
    v_mfma_f32_32x32x16_bf16 v[144:159], v[112:115], v[96:99], v[144:159]
    v_add_u32 v239, 24576, v239
    v_add_u32 v240, 24576, v240
    v_add_u32 v241, 24576, v241
    v_add_u32 v242, 24576, v242
    s_add_u32 m0, s60, 24576
    s_nop 0
    buffer_load_dwordx4 v233, s[12:15], s58 offen lds
    v_mfma_f32_32x32x16_bf16 v[160:175], v[116:119], v[96:99], v[160:175]
    v_add_u32 v243, 24576, v243
    v_add_u32 v244, 24576, v244
    ds_read_b128 v[48:51], v239 offset:0
    ds_read_b64_tr_b16 v[64:65], v243 offset:0
    s_add_u32 m0, s60, 25600
    s_nop 0
    buffer_load_dwordx4 v234, s[12:15], s58 offen lds
    v_mfma_f32_32x32x16_bf16 v[144:159], v[120:123], v[100:103], v[144:159]
    ds_read_b64_tr_b16 v[66:67], v243 offset:512
    ds_read_b64_tr_b16 v[68:69], v244 offset:0
    ds_read_b64_tr_b16 v[70:71], v244 offset:512
    ds_read_b128 v[52:55], v240 offset:0
    s_add_u32 m0, s60, 26624
    s_nop 0
    buffer_load_dwordx4 v235, s[12:15], s58 offen lds
    v_mfma_f32_32x32x16_bf16 v[160:175], v[124:127], v[100:103], v[160:175]
    ds_read_b64_tr_b16 v[72:73], v243 offset:2048
    ds_read_b64_tr_b16 v[74:75], v243 offset:2560
    ds_read_b64_tr_b16 v[76:77], v244 offset:2048
    ds_read_b64_tr_b16 v[78:79], v244 offset:2560
    s_add_u32 m0, s60, 27648
    s_nop 0
    buffer_load_dwordx4 v236, s[12:15], s58 offen lds
    v_mfma_f32_32x32x16_bf16 v[144:159], v[128:131], v[104:107], v[144:159]
    ds_read_b128 v[56:59], v241 offset:0
    ds_read_b64_tr_b16 v[80:81], v243 offset:4096
    ds_read_b64_tr_b16 v[82:83], v243 offset:4608
    ds_read_b64_tr_b16 v[84:85], v244 offset:4096
    s_add_u32 m0, s61, 24576
    s_nop 0
    buffer_load_dwordx4 v237, s[4:7], s59 offen lds
    v_mfma_f32_32x32x16_bf16 v[160:175], v[132:135], v[104:107], v[160:175]
    ds_read_b64_tr_b16 v[86:87], v244 offset:4608
    ds_read_b128 v[60:63], v242 offset:0
    ds_read_b64_tr_b16 v[88:89], v243 offset:6144
    ds_read_b64_tr_b16 v[90:91], v243 offset:6656
    s_add_u32 m0, s61, 25600
    s_nop 0
    buffer_load_dwordx4 v238, s[4:7], s59 offen lds
    v_mfma_f32_32x32x16_bf16 v[144:159], v[136:139], v[108:111], v[144:159]
    ds_read_b64_tr_b16 v[92:93], v244 offset:6144
    ds_read_b64_tr_b16 v[94:95], v244 offset:6656
    v_mfma_f32_32x32x16_bf16 v[160:175], v[140:143], v[108:111], v[160:175]
    s_add_u32 s58, s58, 128
    s_add_u32 s59, s59, 8192
    s_and_b32 s58, s58, 4095
    s_and_b32 s59, s59, 262143
    s_add_u32 s62, s62, 1
    s_cmp_lt_u32 s62, 4
    s_cbranch_scc1 L_ag_loop
    s_waitcnt vmcnt(0) lgkmcnt(0)
    s_nop 15
    v_and_b32 v225, 31, v224
    s_mul_i32 s32, s63, 32
    s_add_u32 s32, s32, s29
    v_add_u32 v225, s32, v225
    s_mov_b32 s32, 1792
    v_mul_lo_u32 v226, v225, s32
    s_mul_i32 s32, s64, 64
    s_add_u32 s32, s32, s30
    s_lshl_b32 s32, s32, 1
    v_add_u32 v226, s32, v226
    v_lshl_add_u32 v226, v232, 4, v226
    v_lshlrev_b32 v229, 1, v225
    buffer_load_ushort v228, v229, s[52:55], 0 offen
    v_lshlrev_b32 v227, 30, v232
    v_add_u32 v227, v227, v226
    buffer_load_dwordx4 v[48:51], v226, s[20:23], 0 offen offset:0
    buffer_load_dwordx4 v[52:55], v226, s[20:23], 0 offen offset:32
    buffer_load_dwordx4 v[56:59], v226, s[20:23], 0 offen offset:64
    buffer_load_dwordx4 v[60:63], v227, s[20:23], 0 offen offset:96
    s_waitcnt vmcnt(0)
    v_lshlrev_b32 v228, 16, v228
    v_cvt_pk_bf16_f32 v64, v144, v145
    v_cvt_pk_bf16_f32 v65, v146, v147
    v_cvt_pk_bf16_f32 v66, v148, v149
    v_cvt_pk_bf16_f32 v67, v150, v151
    s_nop 1
    v_permlane32_swap_b32 v64, v66
    v_permlane32_swap_b32 v65, v67
    v_lshlrev_b32 v144, 16, v64
    v_and_b32 v145, s38, v64
    v_lshlrev_b32 v146, 16, v65
    v_and_b32 v147, s38, v65
    v_lshlrev_b32 v148, 16, v66
    v_and_b32 v149, s38, v66
    v_lshlrev_b32 v150, 16, v67
    v_and_b32 v151, s38, v67
    v_add_f32 v144, v144, v228
    v_add_f32 v145, v145, v228
    v_add_f32 v146, v146, v228
    v_add_f32 v147, v147, v228
    v_add_f32 v148, v148, v228
    v_add_f32 v149, v149, v228
    v_add_f32 v150, v150, v228
    v_add_f32 v151, v151, v228
    v_cvt_pk_bf16_f32 v64, v144, v145
    v_cvt_pk_bf16_f32 v65, v146, v147
    v_cvt_pk_bf16_f32 v66, v148, v149
    v_cvt_pk_bf16_f32 v67, v150, v151
    v_lshlrev_b32 v144, 16, v64
    v_and_b32 v145, s38, v64
    v_lshlrev_b32 v146, 16, v65
    v_and_b32 v147, s38, v65
    v_lshlrev_b32 v148, 16, v66
    v_and_b32 v149, s38, v66
    v_lshlrev_b32 v150, 16, v67
    v_and_b32 v151, s38, v67
    v_lshlrev_b32 v68, 16, v48
    v_and_b32 v69, s38, v48
    v_lshlrev_b32 v70, 16, v49
    v_and_b32 v71, s38, v49
    v_lshlrev_b32 v72, 16, v50
    v_and_b32 v73, s38, v50
    v_lshlrev_b32 v74, 16, v51
    v_and_b32 v75, s38, v51
    v_mul_f32 v144, v144, v68
    v_mul_f32 v145, v145, v69
    v_mul_f32 v146, v146, v70
    v_mul_f32 v147, v147, v71
    v_mul_f32 v148, v148, v72
    v_mul_f32 v149, v149, v73
    v_mul_f32 v150, v150, v74
    v_mul_f32 v151, v151, v75
    v_cvt_pk_bf16_f32 v48, v144, v145
    v_cvt_pk_bf16_f32 v49, v146, v147
    v_cvt_pk_bf16_f32 v50, v148, v149
    v_cvt_pk_bf16_f32 v51, v150, v151
    buffer_store_dwordx4 v[48:51], v226, s[48:51], 0 offen offset:0
    v_cvt_pk_bf16_f32 v64, v152, v153
    v_cvt_pk_bf16_f32 v65, v154, v155
    v_cvt_pk_bf16_f32 v66, v156, v157
    v_cvt_pk_bf16_f32 v67, v158, v159
    s_nop 1
    v_permlane32_swap_b32 v64, v66
    v_permlane32_swap_b32 v65, v67
    v_lshlrev_b32 v152, 16, v64
    v_and_b32 v153, s38, v64
    v_lshlrev_b32 v154, 16, v65
    v_and_b32 v155, s38, v65
    v_lshlrev_b32 v156, 16, v66
    v_and_b32 v157, s38, v66
    v_lshlrev_b32 v158, 16, v67
    v_and_b32 v159, s38, v67
    v_add_f32 v152, v152, v228
    v_add_f32 v153, v153, v228
    v_add_f32 v154, v154, v228
    v_add_f32 v155, v155, v228
    v_add_f32 v156, v156, v228
    v_add_f32 v157, v157, v228
    v_add_f32 v158, v158, v228
    v_add_f32 v159, v159, v228
    v_cvt_pk_bf16_f32 v64, v152, v153
    v_cvt_pk_bf16_f32 v65, v154, v155
    v_cvt_pk_bf16_f32 v66, v156, v157
    v_cvt_pk_bf16_f32 v67, v158, v159
    v_lshlrev_b32 v152, 16, v64
    v_and_b32 v153, s38, v64
    v_lshlrev_b32 v154, 16, v65
    v_and_b32 v155, s38, v65
    v_lshlrev_b32 v156, 16, v66
    v_and_b32 v157, s38, v66
    v_lshlrev_b32 v158, 16, v67
    v_and_b32 v159, s38, v67
    v_lshlrev_b32 v68, 16, v52
    v_and_b32 v69, s38, v52
    v_lshlrev_b32 v70, 16, v53
    v_and_b32 v71, s38, v53
    v_lshlrev_b32 v72, 16, v54
    v_and_b32 v73, s38, v54
    v_lshlrev_b32 v74, 16, v55
    v_and_b32 v75, s38, v55
    v_mul_f32 v152, v152, v68
    v_mul_f32 v153, v153, v69
    v_mul_f32 v154, v154, v70
    v_mul_f32 v155, v155, v71
    v_mul_f32 v156, v156, v72
    v_mul_f32 v157, v157, v73
    v_mul_f32 v158, v158, v74
    v_mul_f32 v159, v159, v75
    v_cvt_pk_bf16_f32 v52, v152, v153
    v_cvt_pk_bf16_f32 v53, v154, v155
    v_cvt_pk_bf16_f32 v54, v156, v157
    v_cvt_pk_bf16_f32 v55, v158, v159
    buffer_store_dwordx4 v[52:55], v226, s[48:51], 0 offen offset:32
    v_cvt_pk_bf16_f32 v64, v160, v161
    v_cvt_pk_bf16_f32 v65, v162, v163
    v_cvt_pk_bf16_f32 v66, v164, v165
    v_cvt_pk_bf16_f32 v67, v166, v167
    s_nop 1
    v_permlane32_swap_b32 v64, v66
    v_permlane32_swap_b32 v65, v67
    v_lshlrev_b32 v160, 16, v64
    v_and_b32 v161, s38, v64
    v_lshlrev_b32 v162, 16, v65
    v_and_b32 v163, s38, v65
    v_lshlrev_b32 v164, 16, v66
    v_and_b32 v165, s38, v66
    v_lshlrev_b32 v166, 16, v67
    v_and_b32 v167, s38, v67
    v_add_f32 v160, v160, v228
    v_add_f32 v161, v161, v228
    v_add_f32 v162, v162, v228
    v_add_f32 v163, v163, v228
    v_add_f32 v164, v164, v228
    v_add_f32 v165, v165, v228
    v_add_f32 v166, v166, v228
    v_add_f32 v167, v167, v228
    v_cvt_pk_bf16_f32 v64, v160, v161
    v_cvt_pk_bf16_f32 v65, v162, v163
    v_cvt_pk_bf16_f32 v66, v164, v165
    v_cvt_pk_bf16_f32 v67, v166, v167
    v_lshlrev_b32 v160, 16, v64
    v_and_b32 v161, s38, v64
    v_lshlrev_b32 v162, 16, v65
    v_and_b32 v163, s38, v65
    v_lshlrev_b32 v164, 16, v66
    v_and_b32 v165, s38, v66
    v_lshlrev_b32 v166, 16, v67
    v_and_b32 v167, s38, v67
    v_lshlrev_b32 v68, 16, v56
    v_and_b32 v69, s38, v56
    v_lshlrev_b32 v70, 16, v57
    v_and_b32 v71, s38, v57
    v_lshlrev_b32 v72, 16, v58
    v_and_b32 v73, s38, v58
    v_lshlrev_b32 v74, 16, v59
    v_and_b32 v75, s38, v59
    v_mul_f32 v160, v160, v68
    v_mul_f32 v161, v161, v69
    v_mul_f32 v162, v162, v70
    v_mul_f32 v163, v163, v71
    v_mul_f32 v164, v164, v72
    v_mul_f32 v165, v165, v73
    v_mul_f32 v166, v166, v74
    v_mul_f32 v167, v167, v75
    v_cvt_pk_bf16_f32 v56, v160, v161
    v_cvt_pk_bf16_f32 v57, v162, v163
    v_cvt_pk_bf16_f32 v58, v164, v165
    v_cvt_pk_bf16_f32 v59, v166, v167
    buffer_store_dwordx4 v[56:59], v226, s[48:51], 0 offen offset:64
    v_cvt_pk_bf16_f32 v64, v168, v169
    v_cvt_pk_bf16_f32 v65, v170, v171
    v_cvt_pk_bf16_f32 v66, v172, v173
    v_cvt_pk_bf16_f32 v67, v174, v175
    s_nop 1
    v_permlane32_swap_b32 v64, v66
    v_permlane32_swap_b32 v65, v67
    v_lshlrev_b32 v168, 16, v64
    v_and_b32 v169, s38, v64
    v_lshlrev_b32 v170, 16, v65
    v_and_b32 v171, s38, v65
    v_lshlrev_b32 v172, 16, v66
    v_and_b32 v173, s38, v66
    v_lshlrev_b32 v174, 16, v67
    v_and_b32 v175, s38, v67
    v_add_f32 v168, v168, v228
    v_add_f32 v169, v169, v228
    v_add_f32 v170, v170, v228
    v_add_f32 v171, v171, v228
    v_add_f32 v172, v172, v228
    v_add_f32 v173, v173, v228
    v_add_f32 v174, v174, v228
    v_add_f32 v175, v175, v228
    v_cvt_pk_bf16_f32 v64, v168, v169
    v_cvt_pk_bf16_f32 v65, v170, v171
    v_cvt_pk_bf16_f32 v66, v172, v173
    v_cvt_pk_bf16_f32 v67, v174, v175
    v_lshlrev_b32 v168, 16, v64
    v_and_b32 v169, s38, v64
    v_lshlrev_b32 v170, 16, v65
    v_and_b32 v171, s38, v65
    v_lshlrev_b32 v172, 16, v66
    v_and_b32 v173, s38, v66
    v_lshlrev_b32 v174, 16, v67
    v_and_b32 v175, s38, v67
    v_lshlrev_b32 v68, 16, v60
    v_and_b32 v69, s38, v60
    v_lshlrev_b32 v70, 16, v61
    v_and_b32 v71, s38, v61
    v_lshlrev_b32 v72, 16, v62
    v_and_b32 v73, s38, v62
    v_lshlrev_b32 v74, 16, v63
    v_and_b32 v75, s38, v63
    v_mul_f32 v168, v168, v68
    v_mul_f32 v169, v169, v69
    v_mul_f32 v170, v170, v70
    v_mul_f32 v171, v171, v71
    v_mul_f32 v172, v172, v72
    v_mul_f32 v173, v173, v73
    v_mul_f32 v174, v174, v74
    v_mul_f32 v175, v175, v75
    v_cvt_pk_bf16_f32 v60, v168, v169
    v_cvt_pk_bf16_f32 v61, v170, v171
    v_cvt_pk_bf16_f32 v62, v172, v173
    v_cvt_pk_bf16_f32 v63, v174, v175
    buffer_store_dwordx4 v[60:63], v227, s[48:51], 0 offen offset:96
    s_load_dwordx2 s[44:45], s[0:1], 72
    v_lshlrev_b32 v40, 4, v0
    s_waitcnt lgkmcnt(0)
    s_add_u32 s12, s44, 0
    s_addc_u32 s13, s45, 0
    s_mov_b32 s14, 802816
    s_mov_b32 s15, 0x20000
    s_mul_i32 s32, s2, 3136
    buffer_load_dwordx4 v[152:155], v40, s[12:15], s32 offen
L_attn_end:
    s_endpgm
L_attn_hookB:
    v_mov_b32 v255, 64
    global_load_dword v254, v255, s[62:63] sc0 sc1
    s_load_dwordx2 s[40:41], s[0:1], 32
    s_load_dwordx2 s[42:43], s[0:1], 56
    s_load_dwordx2 s[44:45], s[0:1], 64
    s_lshl_b32 s32, s24, 2
    v_xor_b32 v236, 0, v1
    v_lshlrev_b32 v236, 4, v236
    s_add_u32 s33, s32, 0
    s_mul_i32 s33, s33, 896
    v_add_u32 v236, s33, v236
    v_xor_b32 v237, 4, v1
    v_lshlrev_b32 v237, 4, v237
    s_add_u32 s33, s32, 1
    s_mul_i32 s33, s33, 896
    v_add_u32 v237, s33, v237
    v_xor_b32 v238, 8, v1
    v_lshlrev_b32 v238, 4, v238
    s_add_u32 s33, s32, 2
    s_mul_i32 s33, s33, 896
    v_add_u32 v238, s33, v238
    v_xor_b32 v239, 12, v1
    v_lshlrev_b32 v239, 4, v239
    s_add_u32 s33, s32, 3
    s_mul_i32 s33, s33, 896
    v_add_u32 v239, s33, v239
    s_waitcnt lgkmcnt(0)
    s_mul_i32 s32, s25, 229376
    s_add_u32 s16, s40, s32
    s_addc_u32 s17, s41, 0
    s_sub_u32 s18, 3670016, s32
    s_mov_b32 s19, 0x20000
    s_mov_b32 s32, 0
    s_add_u32 m0, s27, 131072
    s_nop 0
    buffer_load_dwordx4 v236, s[16:19], s32 offen lds
    s_add_u32 m0, s27, 132096
    s_nop 0
    buffer_load_dwordx4 v237, s[16:19], s32 offen lds
    s_add_u32 m0, s27, 133120
    s_nop 0
    buffer_load_dwordx4 v238, s[16:19], s32 offen lds
    s_add_u32 m0, s27, 134144
    s_nop 0
    buffer_load_dwordx4 v239, s[16:19], s32 offen lds
    s_mov_b32 s32, 14336
    s_add_u32 m0, s27, 147456
    s_nop 0
    buffer_load_dwordx4 v236, s[16:19], s32 offen lds
    s_add_u32 m0, s27, 148480
    s_nop 0
    buffer_load_dwordx4 v237, s[16:19], s32 offen lds
    s_add_u32 m0, s27, 149504
    s_nop 0
    buffer_load_dwordx4 v238, s[16:19], s32 offen lds
    s_add_u32 m0, s27, 150528
    s_nop 0
    buffer_load_dwordx4 v239, s[16:19], s32 offen lds
    s_add_u32 s48, s42, 0
    s_addc_u32 s49, s43, 0
    s_mov_b32 s50, 8388608
    s_mov_b32 s51, 0x20000
    s_bfe_u32 s32, s2, 0x20001
    s_lshl_b32 s32, s32, 21
    s_lshr_b32 s33, s2, 3
    s_lshl_b32 s33, s33, 16
    s_add_u32 s32, s32, s33
    v_lshlrev_b32 v240, 4, v0
    buffer_load_dwordx4 v[244:247], v240, s[48:51], s32 offen
    s_add_u32 s32, s32, 4096
    buffer_load_dwordx4 v[244:247], v240, s[48:51], s32 offen
    s_add_u32 s32, s32, 4096
    buffer_load_dwordx4 v[244:247], v240, s[48:51], s32 offen
    s_add_u32 s32, s32, 4096
    buffer_load_dwordx4 v[244:247], v240, s[48:51], s32 offen
    s_add_u32 s32, s32, 4096
    buffer_load_dwordx4 v[244:247], v240, s[48:51], s32 offen
    s_add_u32 s32, s32, 4096
    buffer_load_dwordx4 v[244:247], v240, s[48:51], s32 offen
    s_add_u32 s32, s32, 4096
    buffer_load_dwordx4 v[244:247], v240, s[48:51], s32 offen
    s_add_u32 s32, s32, 4096
    buffer_load_dwordx4 v[244:247], v240, s[48:51], s32 offen
    s_add_u32 s32, s32, 4096
    buffer_load_dwordx4 v[244:247], v240, s[48:51], s32 offen
    s_add_u32 s32, s32, 4096
    buffer_load_dwordx4 v[244:247], v240, s[48:51], s32 offen
    s_add_u32 s32, s32, 4096
    buffer_load_dwordx4 v[244:247], v240, s[48:51], s32 offen
    s_add_u32 s32, s32, 4096
    buffer_load_dwordx4 v[244:247], v240, s[48:51], s32 offen
    s_add_u32 s32, s32, 4096
    buffer_load_dwordx4 v[244:247], v240, s[48:51], s32 offen
    s_add_u32 s32, s32, 4096
    buffer_load_dwordx4 v[244:247], v240, s[48:51], s32 offen
    s_add_u32 s32, s32, 4096
    buffer_load_dwordx4 v[244:247], v240, s[48:51], s32 offen
    s_add_u32 s32, s32, 4096
    buffer_load_dwordx4 v[244:247], v240, s[48:51], s32 offen
    s_add_u32 s32, s32, 4096
    s_branch L_attn_loop
L_attn_hook:
    s_cmp_eq_u32 s30, 2
    s_cbranch_scc1 L_attn_hook1
    s_cmp_eq_u32 s30, 3
    s_cbranch_scc1 L_attn_hook2
    s_cmp_eq_u32 s30, 4
    s_cbranch_scc1 L_attn_hook3
    s_cmp_eq_u32 s30, 5
    s_cbranch_scc1 L_attn_hook4
    s_cmp_lt_u32 s25, 8
    s_cbranch_scc1 L_attn_loop
    s_cmp_lg_u32 s24, 0
    s_cbranch_scc1 L_attn_loop
    v_mov_b32 v254, 1
    s_lshl_b32 s32, s26, 2
    v_mov_b32 v255, s32
    s_mov_b64 s[64:65], exec
    s_mov_b64 exec, 1
    global_atomic_add v255, v254, s[62:63] sc1
    s_mov_b64 exec, s[64:65]
    s_branch L_attn_loop
L_attn_hook1:
    s_lshl_b32 s32, s26, 2
    v_mov_b32 v255, s32
    global_load_dword v254, v255, s[62:63] sc0 sc1
    s_branch L_attn_loop
L_attn_hook2:
    v_readfirstlane_b32 s33, v254
    s_cmp_ge_u32 s33, 8
    s_cbranch_scc1 L_attn_h2ok
L_attn_h2poll:
    s_sleep 8
    global_load_dword v254, v255, s[62:63] sc0 sc1
    s_waitcnt vmcnt(0)
    v_readfirstlane_b32 s33, v254
    s_cmp_lt_u32 s33, 8
    s_cbranch_scc1 L_attn_h2poll
L_attn_h2ok:
    s_add_u32 s16, s46, 6291456
    s_addc_u32 s17, s47, 0
    s_mov_b32 s18, 3670016
    s_mov_b32 s19, 0x20000
    v_lshrrev_b32 v248, 5, v0
    s_lshl_b32 s32, s2, 3
    v_add_u32 v248, s32, v248
    s_movk_i32 s32, 1792
    v_mul_lo_u32 v248, v248, s32
    v_and_b32 v249, 31, v0
    v_lshl_add_u32 v248, v249, 4, v248
    v_cmp_gt_u32 vcc, 28, v249
    v_mov_b32 v250, 0x40000000
    s_nop 1
    v_cndmask_b32 v248, v250, v248, vcc
    buffer_load_dwordx4 v[232:235], v248, s[16:19], 0 offen offset:0 sc0 sc1
    buffer_load_dwordx4 v[236:239], v248, s[16:19], 0 offen offset:448 sc0 sc1
    buffer_load_dwordx4 v[240:243], v248, s[16:19], 0 offen offset:896 sc0 sc1
    buffer_load_dwordx4 v[244:247], v248, s[16:19], 0 offen offset:1344 sc0 sc1
    s_branch L_attn_loop
L_attn_hook3:
    s_add_u32 s16, s46, 10485760
    s_addc_u32 s17, s47, 0
    s_mov_b32 s18, 4194304
    s_mov_b32 s19, 0x20000
    v_mov_b32 v249, 0
    v_mov_b32 v250, 0
    v_dot2_f32_bf16 v249, v232, v32, v249
    v_dot2_f32_bf16 v250, v232, v232, v250
    v_dot2_f32_bf16 v249, v233, v32, v249
    v_dot2_f32_bf16 v250, v233, v233, v250
    v_dot2_f32_bf16 v249, v234, v32, v249
    v_dot2_f32_bf16 v250, v234, v234, v250
    v_dot2_f32_bf16 v249, v235, v32, v249
    v_dot2_f32_bf16 v250, v235, v235, v250
    v_dot2_f32_bf16 v249, v236, v32, v249
    v_dot2_f32_bf16 v250, v236, v236, v250
    v_dot2_f32_bf16 v249, v237, v32, v249
    v_dot2_f32_bf16 v250, v237, v237, v250
    v_dot2_f32_bf16 v249, v238, v32, v249
    v_dot2_f32_bf16 v250, v238, v238, v250
    v_dot2_f32_bf16 v249, v239, v32, v249
    v_dot2_f32_bf16 v250, v239, v239, v250
    v_dot2_f32_bf16 v249, v240, v32, v249
    v_dot2_f32_bf16 v250, v240, v240, v250
    v_dot2_f32_bf16 v249, v241, v32, v249
    v_dot2_f32_bf16 v250, v241, v241, v250
    v_dot2_f32_bf16 v249, v242, v32, v249
    v_dot2_f32_bf16 v250, v242, v242, v250
    v_dot2_f32_bf16 v249, v243, v32, v249
    v_dot2_f32_bf16 v250, v243, v243, v250
    v_dot2_f32_bf16 v249, v244, v32, v249
    v_dot2_f32_bf16 v250, v244, v244, v250
    v_dot2_f32_bf16 v249, v245, v32, v249
    v_dot2_f32_bf16 v250, v245, v245, v250
    v_dot2_f32_bf16 v249, v246, v32, v249
    v_dot2_f32_bf16 v250, v246, v246, v250
    v_dot2_f32_bf16 v249, v247, v32, v249
    v_dot2_f32_bf16 v250, v247, v247, v250
    s_nop 3
    ds_swizzle_b32 v251, v249 offset:1055
    ds_swizzle_b32 v252, v250 offset:1055
    s_waitcnt lgkmcnt(0)
    v_add_f32 v249, v249, v251
    v_add_f32 v250, v250, v252
    ds_swizzle_b32 v251, v249 offset:2079
    ds_swizzle_b32 v252, v250 offset:2079
    s_waitcnt lgkmcnt(0)
    v_add_f32 v249, v249, v251
    v_add_f32 v250, v250, v252
    ds_swizzle_b32 v251, v249 offset:4127
    ds_swizzle_b32 v252, v250 offset:4127
    s_waitcnt lgkmcnt(0)
    v_add_f32 v249, v249, v251
    v_add_f32 v250, v250, v252
    ds_swizzle_b32 v251, v249 offset:8223
    ds_swizzle_b32 v252, v250 offset:8223
    s_waitcnt lgkmcnt(0)
    v_add_f32 v249, v249, v251
    v_add_f32 v250, v250, v252
    ds_swizzle_b32 v251, v249 offset:16415
    ds_swizzle_b32 v252, v250 offset:16415
    s_waitcnt lgkmcnt(0)
    v_add_f32 v249, v249, v251
    v_add_f32 v250, v250, v252
    v_mul_f32 v249, 0x3a924925, v249
    v_mul_f32 v250, 0x3a924925, v250
    v_fma_f32 v250, -v249, v249, v250
    v_max_f32 v250, 0, v250
    v_cvt_pk_bf16_f32 v251, v249, v250
    v_lshlrev_b32 v249, 16, v251
    v_and_b32 v250, 0xffff0000, v251
    v_add_f32 v250, 0x3727c5ac, v250
    v_cvt_pk_bf16_f32 v251, v250, v250
    v_lshlrev_b32 v250, 16, v251
    v_sqrt_f32 v250, v250
    s_nop 0
    v_cvt_pk_bf16_f32 v251, v250, v250
    v_lshlrev_b32 v250, 16, v251
    v_rcp_f32 v250, v250
    s_nop 0
    v_lshlrev_b32 v251, 16, v232
    v_lshlrev_b32 v253, 16, v233
    v_and_b32 v252, s38, v232
    v_and_b32 v254, s38, v233
    v_sub_f32 v251, v251, v249
    v_sub_f32 v253, v253, v249
    v_sub_f32 v252, v252, v249
    v_sub_f32 v254, v254, v249
    v_cvt_pk_bf16_f32 v251, v251, v252
    v_cvt_pk_bf16_f32 v253, v253, v254
    v_and_b32 v252, s38, v251
    v_and_b32 v254, s38, v253
    v_lshlrev_b32 v251, 16, v251
    v_lshlrev_b32 v253, 16, v253
    v_mul_f32 v251, v251, v250
    v_mul_f32 v253, v253, v250
    v_mul_f32 v252, v252, v250
    v_mul_f32 v254, v254, v250
    v_cvt_pk_bf16_f32 v232, v251, v252
    v_cvt_pk_bf16_f32 v233, v253, v254
    v_lshlrev_b32 v251, 16, v234
    v_lshlrev_b32 v253, 16, v235
    v_and_b32 v252, s38, v234
    v_and_b32 v254, s38, v235
    v_sub_f32 v251, v251, v249
    v_sub_f32 v253, v253, v249
    v_sub_f32 v252, v252, v249
    v_sub_f32 v254, v254, v249
    v_cvt_pk_bf16_f32 v251, v251, v252
    v_cvt_pk_bf16_f32 v253, v253, v254
    v_and_b32 v252, s38, v251
    v_and_b32 v254, s38, v253
    v_lshlrev_b32 v251, 16, v251
    v_lshlrev_b32 v253, 16, v253
    v_mul_f32 v251, v251, v250
    v_mul_f32 v253, v253, v250
    v_mul_f32 v252, v252, v250
    v_mul_f32 v254, v254, v250
    v_cvt_pk_bf16_f32 v234, v251, v252
    v_cvt_pk_bf16_f32 v235, v253, v254
    v_lshlrev_b32 v251, 16, v236
    v_lshlrev_b32 v253, 16, v237
    v_and_b32 v252, s38, v236
    v_and_b32 v254, s38, v237
    v_sub_f32 v251, v251, v249
    v_sub_f32 v253, v253, v249
    v_sub_f32 v252, v252, v249
    v_sub_f32 v254, v254, v249
    v_cvt_pk_bf16_f32 v251, v251, v252
    v_cvt_pk_bf16_f32 v253, v253, v254
    v_and_b32 v252, s38, v251
    v_and_b32 v254, s38, v253
    v_lshlrev_b32 v251, 16, v251
    v_lshlrev_b32 v253, 16, v253
    v_mul_f32 v251, v251, v250
    v_mul_f32 v253, v253, v250
    v_mul_f32 v252, v252, v250
    v_mul_f32 v254, v254, v250
    v_cvt_pk_bf16_f32 v236, v251, v252
    v_cvt_pk_bf16_f32 v237, v253, v254
    v_lshlrev_b32 v251, 16, v238
    v_lshlrev_b32 v253, 16, v239
    v_and_b32 v252, s38, v238
    v_and_b32 v254, s38, v239
    v_sub_f32 v251, v251, v249
    v_sub_f32 v253, v253, v249
    v_sub_f32 v252, v252, v249
    v_sub_f32 v254, v254, v249
    v_cvt_pk_bf16_f32 v251, v251, v252
    v_cvt_pk_bf16_f32 v253, v253, v254
    v_and_b32 v252, s38, v251
    v_and_b32 v254, s38, v253
    v_lshlrev_b32 v251, 16, v251
    v_lshlrev_b32 v253, 16, v253
    v_mul_f32 v251, v251, v250
    v_mul_f32 v253, v253, v250
    v_mul_f32 v252, v252, v250
    v_mul_f32 v254, v254, v250
    v_cvt_pk_bf16_f32 v238, v251, v252
    v_cvt_pk_bf16_f32 v239, v253, v254
    v_lshlrev_b32 v251, 16, v240
    v_lshlrev_b32 v253, 16, v241
    v_and_b32 v252, s38, v240
    v_and_b32 v254, s38, v241
    v_sub_f32 v251, v251, v249
    v_sub_f32 v253, v253, v249
    v_sub_f32 v252, v252, v249
    v_sub_f32 v254, v254, v249
    v_cvt_pk_bf16_f32 v251, v251, v252
    v_cvt_pk_bf16_f32 v253, v253, v254
    v_and_b32 v252, s38, v251
    v_and_b32 v254, s38, v253
    v_lshlrev_b32 v251, 16, v251
    v_lshlrev_b32 v253, 16, v253
    v_mul_f32 v251, v251, v250
    v_mul_f32 v253, v253, v250
    v_mul_f32 v252, v252, v250
    v_mul_f32 v254, v254, v250
    v_cvt_pk_bf16_f32 v240, v251, v252
    v_cvt_pk_bf16_f32 v241, v253, v254
    v_lshlrev_b32 v251, 16, v242
    v_lshlrev_b32 v253, 16, v243
    v_and_b32 v252, s38, v242
    v_and_b32 v254, s38, v243
    v_sub_f32 v251, v251, v249
    v_sub_f32 v253, v253, v249
    v_sub_f32 v252, v252, v249
    v_sub_f32 v254, v254, v249
    v_cvt_pk_bf16_f32 v251, v251, v252
    v_cvt_pk_bf16_f32 v253, v253, v254
    v_and_b32 v252, s38, v251
    v_and_b32 v254, s38, v253
    v_lshlrev_b32 v251, 16, v251
    v_lshlrev_b32 v253, 16, v253
    v_mul_f32 v251, v251, v250
    v_mul_f32 v253, v253, v250
    v_mul_f32 v252, v252, v250
    v_mul_f32 v254, v254, v250
    v_cvt_pk_bf16_f32 v242, v251, v252
    v_cvt_pk_bf16_f32 v243, v253, v254
    v_lshlrev_b32 v251, 16, v244
    v_lshlrev_b32 v253, 16, v245
    v_and_b32 v252, s38, v244
    v_and_b32 v254, s38, v245
    v_sub_f32 v251, v251, v249
    v_sub_f32 v253, v253, v249
    v_sub_f32 v252, v252, v249
    v_sub_f32 v254, v254, v249
    v_cvt_pk_bf16_f32 v251, v251, v252
    v_cvt_pk_bf16_f32 v253, v253, v254
    v_and_b32 v252, s38, v251
    v_and_b32 v254, s38, v253
    v_lshlrev_b32 v251, 16, v251
    v_lshlrev_b32 v253, 16, v253
    v_mul_f32 v251, v251, v250
    v_mul_f32 v253, v253, v250
    v_mul_f32 v252, v252, v250
    v_mul_f32 v254, v254, v250
    v_cvt_pk_bf16_f32 v244, v251, v252
    v_cvt_pk_bf16_f32 v245, v253, v254
    v_lshlrev_b32 v251, 16, v246
    v_lshlrev_b32 v253, 16, v247
    v_and_b32 v252, s38, v246
    v_and_b32 v254, s38, v247
    v_sub_f32 v251, v251, v249
    v_sub_f32 v253, v253, v249
    v_sub_f32 v252, v252, v249
    v_sub_f32 v254, v254, v249
    v_cvt_pk_bf16_f32 v251, v251, v252
    v_cvt_pk_bf16_f32 v253, v253, v254
    v_and_b32 v252, s38, v251
    v_and_b32 v254, s38, v253
    v_lshlrev_b32 v251, 16, v251
    v_lshlrev_b32 v253, 16, v253
    v_mul_f32 v251, v251, v250
    v_mul_f32 v253, v253, v250
    v_mul_f32 v252, v252, v250
    v_mul_f32 v254, v254, v250
    v_cvt_pk_bf16_f32 v246, v251, v252
    v_cvt_pk_bf16_f32 v247, v253, v254
    v_lshrrev_b32 v248, 5, v0
    s_lshl_b32 s32, s2, 3
    v_add_u32 v248, s32, v248
    v_lshlrev_b32 v248, 7, v248
    v_and_b32 v251, 31, v0
    v_mul_u32_u24 v252, 37, v251
    v_lshrrev_b32 v252, 8, v252
    v_mul_u32_u24 v253, 7, v252
    v_sub_u32 v253, v251, v253
    v_lshl_add_u32 v248, v253, 4, v248
    v_lshl_add_u32 v248, v252, 18, v248
    v_cmp_gt_u32 vcc, 28, v251
    v_mov_b32 v254, 0x40000000
    s_nop 1
    v_cndmask_b32 v248, v254, v248, vcc
    s_mov_b32 s32, 0
    buffer_store_dwordx4 v[232:235], v248, s[16:19], s32 offen sc0 sc1
    s_mov_b32 s32, 1048576
    buffer_store_dwordx4 v[236:239], v248, s[16:19], s32 offen sc0 sc1
    s_mov_b32 s32, 2097152
    buffer_store_dwordx4 v[240:243], v248, s[16:19], s32 offen sc0 sc1
    s_mov_b32 s32, 3145728
    buffer_store_dwordx4 v[244:247], v248, s[16:19], s32 offen sc0 sc1
    s_branch L_attn_loop
L_attn_hook4:
    s_cmp_lg_u32 s24, 0
    s_cbranch_scc1 L_attn_loop
    v_mov_b32 v254, 1
    v_mov_b32 v255, 64
    s_mov_b64 s[64:65], exec
    s_mov_b64 exec, 1
    global_atomic_add v255, v254, s[62:63] sc1
    s_mov_b64 exec, s[64:65]
    s_branch L_attn_loop
L_attn_rare0:
    s_nop 15
    v_mov_b32 v40, v35
    s_nop 1
    v_permlane32_swap_b32 v40, v35
    s_nop 1
    v_max3_f32 v40, v40, v35, 0
    v_sub_f32 v37, 0, v40
    v_exp_f32 v37, v37
    v_sub_f32 v64, v64, v40
    v_sub_f32 v80, v80, v40
    v_sub_f32 v65, v65, v40
    v_sub_f32 v81, v81, v40
    v_sub_f32 v66, v66, v40
    v_sub_f32 v82, v82, v40
    v_sub_f32 v67, v67, v40
    v_sub_f32 v83, v83, v40
    v_sub_f32 v68, v68, v40
    v_sub_f32 v84, v84, v40
    v_sub_f32 v69, v69, v40
    v_sub_f32 v85, v85, v40
    v_sub_f32 v70, v70, v40
    v_sub_f32 v86, v86, v40
    v_sub_f32 v71, v71, v40
    v_sub_f32 v87, v87, v40
    v_sub_f32 v72, v72, v40
    v_sub_f32 v88, v88, v40
    v_sub_f32 v73, v73, v40
    v_sub_f32 v89, v89, v40
    v_sub_f32 v74, v74, v40
    v_sub_f32 v90, v90, v40
    v_sub_f32 v75, v75, v40
    v_sub_f32 v91, v91, v40
    v_sub_f32 v76, v76, v40
    v_sub_f32 v92, v92, v40
    v_sub_f32 v77, v77, v40
    v_sub_f32 v93, v93, v40
    v_sub_f32 v78, v78, v40
    v_sub_f32 v94, v94, v40
    v_sub_f32 v79, v79, v40
    v_sub_f32 v95, v95, v40
    v_mul_f32 v34, v34, v37
    v_accvgpr_read_b32 v40, a0
    v_accvgpr_read_b32 v41, a1
    v_accvgpr_read_b32 v42, a2
    v_accvgpr_read_b32 v43, a3
    v_mul_f32 v40, v40, v37
    v_mul_f32 v41, v41, v37
    v_mul_f32 v42, v42, v37
    v_mul_f32 v43, v43, v37
    v_accvgpr_write_b32 a0, v40
    v_accvgpr_write_b32 a1, v41
    v_accvgpr_write_b32 a2, v42
    v_accvgpr_write_b32 a3, v43
    v_accvgpr_read_b32 v40, a4
    v_accvgpr_read_b32 v41, a5
    v_accvgpr_read_b32 v42, a6
    v_accvgpr_read_b32 v43, a7
    v_mul_f32 v40, v40, v37
    v_mul_f32 v41, v41, v37
    v_mul_f32 v42, v42, v37
    v_mul_f32 v43, v43, v37
    v_accvgpr_write_b32 a4, v40
    v_accvgpr_write_b32 a5, v41
    v_accvgpr_write_b32 a6, v42
    v_accvgpr_write_b32 a7, v43
    v_accvgpr_read_b32 v40, a8
    v_accvgpr_read_b32 v41, a9
    v_accvgpr_read_b32 v42, a10
    v_accvgpr_read_b32 v43, a11
    v_mul_f32 v40, v40, v37
    v_mul_f32 v41, v41, v37
    v_mul_f32 v42, v42, v37
    v_mul_f32 v43, v43, v37
    v_accvgpr_write_b32 a8, v40
    v_accvgpr_write_b32 a9, v41
    v_accvgpr_write_b32 a10, v42
    v_accvgpr_write_b32 a11, v43
    v_accvgpr_read_b32 v40, a12
    v_accvgpr_read_b32 v41, a13
    v_accvgpr_read_b32 v42, a14
    v_accvgpr_read_b32 v43, a15
    v_mul_f32 v40, v40, v37
    v_mul_f32 v41, v41, v37
    v_mul_f32 v42, v42, v37
    v_mul_f32 v43, v43, v37
    v_accvgpr_write_b32 a12, v40
    v_accvgpr_write_b32 a13, v41
    v_accvgpr_write_b32 a14, v42
    v_accvgpr_write_b32 a15, v43
    v_accvgpr_read_b32 v40, a16
    v_accvgpr_read_b32 v41, a17
    v_accvgpr_read_b32 v42, a18
    v_accvgpr_read_b32 v43, a19
    v_mul_f32 v40, v40, v37
    v_mul_f32 v41, v41, v37
    v_mul_f32 v42, v42, v37
    v_mul_f32 v43, v43, v37
    v_accvgpr_write_b32 a16, v40
    v_accvgpr_write_b32 a17, v41
    v_accvgpr_write_b32 a18, v42
    v_accvgpr_write_b32 a19, v43
    v_accvgpr_read_b32 v40, a20
    v_accvgpr_read_b32 v41, a21
    v_accvgpr_read_b32 v42, a22
    v_accvgpr_read_b32 v43, a23
    v_mul_f32 v40, v40, v37
    v_mul_f32 v41, v41, v37
    v_mul_f32 v42, v42, v37
    v_mul_f32 v43, v43, v37
    v_accvgpr_write_b32 a20, v40
    v_accvgpr_write_b32 a21, v41
    v_accvgpr_write_b32 a22, v42
    v_accvgpr_write_b32 a23, v43
    v_accvgpr_read_b32 v40, a24
    v_accvgpr_read_b32 v41, a25
    v_accvgpr_read_b32 v42, a26
    v_accvgpr_read_b32 v43, a27
    v_mul_f32 v40, v40, v37
    v_mul_f32 v41, v41, v37
    v_mul_f32 v42, v42, v37
    v_mul_f32 v43, v43, v37
    v_accvgpr_write_b32 a24, v40
    v_accvgpr_write_b32 a25, v41
    v_accvgpr_write_b32 a26, v42
    v_accvgpr_write_b32 a27, v43
    v_accvgpr_read_b32 v40, a28
    v_accvgpr_read_b32 v41, a29
    v_accvgpr_read_b32 v42, a30
    v_accvgpr_read_b32 v43, a31
    v_mul_f32 v40, v40, v37
    v_mul_f32 v41, v41, v37
    v_mul_f32 v42, v42, v37
    v_mul_f32 v43, v43, v37
    v_accvgpr_write_b32 a28, v40
    v_accvgpr_write_b32 a29, v41
    v_accvgpr_write_b32 a30, v42
    v_accvgpr_write_b32 a31, v43
    v_accvgpr_read_b32 v40, a32
    v_accvgpr_read_b32 v41, a33
    v_accvgpr_read_b32 v42, a34
    v_accvgpr_read_b32 v43, a35
    v_mul_f32 v40, v40, v37
    v_mul_f32 v41, v41, v37
    v_mul_f32 v42, v42, v37
    v_mul_f32 v43, v43, v37
    v_accvgpr_write_b32 a32, v40
    v_accvgpr_write_b32 a33, v41
    v_accvgpr_write_b32 a34, v42
    v_accvgpr_write_b32 a35, v43
    v_accvgpr_read_b32 v40, a36
    v_accvgpr_read_b32 v41, a37
    v_accvgpr_read_b32 v42, a38
    v_accvgpr_read_b32 v43, a39
    v_mul_f32 v40, v40, v37
    v_mul_f32 v41, v41, v37
    v_mul_f32 v42, v42, v37
    v_mul_f32 v43, v43, v37
    v_accvgpr_write_b32 a36, v40
    v_accvgpr_write_b32 a37, v41
    v_accvgpr_write_b32 a38, v42
    v_accvgpr_write_b32 a39, v43
    v_accvgpr_read_b32 v40, a40
    v_accvgpr_read_b32 v41, a41
    v_accvgpr_read_b32 v42, a42
    v_accvgpr_read_b32 v43, a43
    v_mul_f32 v40, v40, v37
    v_mul_f32 v41, v41, v37
    v_mul_f32 v42, v42, v37
    v_mul_f32 v43, v43, v37
    v_accvgpr_write_b32 a40, v40
    v_accvgpr_write_b32 a41, v41
    v_accvgpr_write_b32 a42, v42
    v_accvgpr_write_b32 a43, v43
    v_accvgpr_read_b32 v40, a44
    v_accvgpr_read_b32 v41, a45
    v_accvgpr_read_b32 v42, a46
    v_accvgpr_read_b32 v43, a47
    v_mul_f32 v40, v40, v37
    v_mul_f32 v41, v41, v37
    v_mul_f32 v42, v42, v37
    v_mul_f32 v43, v43, v37
    v_accvgpr_write_b32 a44, v40
    v_accvgpr_write_b32 a45, v41
    v_accvgpr_write_b32 a46, v42
    v_accvgpr_write_b32 a47, v43
    v_accvgpr_read_b32 v40, a48
    v_accvgpr_read_b32 v41, a49
    v_accvgpr_read_b32 v42, a50
    v_accvgpr_read_b32 v43, a51
    v_mul_f32 v40, v40, v37
    v_mul_f32 v41, v41, v37
    v_mul_f32 v42, v42, v37
    v_mul_f32 v43, v43, v37
    v_accvgpr_write_b32 a48, v40
    v_accvgpr_write_b32 a49, v41
    v_accvgpr_write_b32 a50, v42
    v_accvgpr_write_b32 a51, v43
    v_accvgpr_read_b32 v40, a52
    v_accvgpr_read_b32 v41, a53
    v_accvgpr_read_b32 v42, a54
    v_accvgpr_read_b32 v43, a55
    v_mul_f32 v40, v40, v37
    v_mul_f32 v41, v41, v37
    v_mul_f32 v42, v42, v37
    v_mul_f32 v43, v43, v37
    v_accvgpr_write_b32 a52, v40
    v_accvgpr_write_b32 a53, v41
    v_accvgpr_write_b32 a54, v42
    v_accvgpr_write_b32 a55, v43
    v_accvgpr_read_b32 v40, a56
    v_accvgpr_read_b32 v41, a57
    v_accvgpr_read_b32 v42, a58
    v_accvgpr_read_b32 v43, a59
    v_mul_f32 v40, v40, v37
    v_mul_f32 v41, v41, v37
    v_mul_f32 v42, v42, v37
    v_mul_f32 v43, v43, v37
    v_accvgpr_write_b32 a56, v40
    v_accvgpr_write_b32 a57, v41
    v_accvgpr_write_b32 a58, v42
    v_accvgpr_write_b32 a59, v43
    v_accvgpr_read_b32 v40, a60
    v_accvgpr_read_b32 v41, a61
    v_accvgpr_read_b32 v42, a62
    v_accvgpr_read_b32 v43, a63
    v_mul_f32 v40, v40, v37
    v_mul_f32 v41, v41, v37
    v_mul_f32 v42, v42, v37
    v_mul_f32 v43, v43, v37
    v_accvgpr_write_b32 a60, v40
    v_accvgpr_write_b32 a61, v41
    v_accvgpr_write_b32 a62, v42
    v_accvgpr_write_b32 a63, v43
    v_accvgpr_read_b32 v40, a64
    v_accvgpr_read_b32 v41, a65
    v_accvgpr_read_b32 v42, a66
    v_accvgpr_read_b32 v43, a67
    v_mul_f32 v40, v40, v37
    v_mul_f32 v41, v41, v37
    v_mul_f32 v42, v42, v37
    v_mul_f32 v43, v43, v37
    v_accvgpr_write_b32 a64, v40
    v_accvgpr_write_b32 a65, v41
    v_accvgpr_write_b32 a66, v42
    v_accvgpr_write_b32 a67, v43
    v_accvgpr_read_b32 v40, a68
    v_accvgpr_read_b32 v41, a69
    v_accvgpr_read_b32 v42, a70
    v_accvgpr_read_b32 v43, a71
    v_mul_f32 v40, v40, v37
    v_mul_f32 v41, v41, v37
    v_mul_f32 v42, v42, v37
    v_mul_f32 v43, v43, v37
    v_accvgpr_write_b32 a68, v40
    v_accvgpr_write_b32 a69, v41
    v_accvgpr_write_b32 a70, v42
    v_accvgpr_write_b32 a71, v43
    v_accvgpr_read_b32 v40, a72
    v_accvgpr_read_b32 v41, a73
    v_accvgpr_read_b32 v42, a74
    v_accvgpr_read_b32 v43, a75
    v_mul_f32 v40, v40, v37
    v_mul_f32 v41, v41, v37
    v_mul_f32 v42, v42, v37
    v_mul_f32 v43, v43, v37
    v_accvgpr_write_b32 a72, v40
    v_accvgpr_write_b32 a73, v41
    v_accvgpr_write_b32 a74, v42
    v_accvgpr_write_b32 a75, v43
    v_accvgpr_read_b32 v40, a76
    v_accvgpr_read_b32 v41, a77
    v_accvgpr_read_b32 v42, a78
    v_accvgpr_read_b32 v43, a79
    v_mul_f32 v40, v40, v37
    v_mul_f32 v41, v41, v37
    v_mul_f32 v42, v42, v37
    v_mul_f32 v43, v43, v37
    v_accvgpr_write_b32 a76, v40
    v_accvgpr_write_b32 a77, v41
    v_accvgpr_write_b32 a78, v42
    v_accvgpr_write_b32 a79, v43
    v_accvgpr_read_b32 v40, a80
    v_accvgpr_read_b32 v41, a81
    v_accvgpr_read_b32 v42, a82
    v_accvgpr_read_b32 v43, a83
    v_mul_f32 v40, v40, v37
    v_mul_f32 v41, v41, v37
    v_mul_f32 v42, v42, v37
    v_mul_f32 v43, v43, v37
    v_accvgpr_write_b32 a80, v40
    v_accvgpr_write_b32 a81, v41
    v_accvgpr_write_b32 a82, v42
    v_accvgpr_write_b32 a83, v43
    v_accvgpr_read_b32 v40, a84
    v_accvgpr_read_b32 v41, a85
    v_accvgpr_read_b32 v42, a86
    v_accvgpr_read_b32 v43, a87
    v_mul_f32 v40, v40, v37
    v_mul_f32 v41, v41, v37
    v_mul_f32 v42, v42, v37
    v_mul_f32 v43, v43, v37
    v_accvgpr_write_b32 a84, v40
    v_accvgpr_write_b32 a85, v41
    v_accvgpr_write_b32 a86, v42
    v_accvgpr_write_b32 a87, v43
    v_accvgpr_read_b32 v40, a88
    v_accvgpr_read_b32 v41, a89
    v_accvgpr_read_b32 v42, a90
    v_accvgpr_read_b32 v43, a91
    v_mul_f32 v40, v40, v37
    v_mul_f32 v41, v41, v37
    v_mul_f32 v42, v42, v37
    v_mul_f32 v43, v43, v37
    v_accvgpr_write_b32 a88, v40
    v_accvgpr_write_b32 a89, v41
    v_accvgpr_write_b32 a90, v42
    v_accvgpr_write_b32 a91, v43
    v_accvgpr_read_b32 v40, a92
    v_accvgpr_read_b32 v41, a93
    v_accvgpr_read_b32 v42, a94
    v_accvgpr_read_b32 v43, a95
    v_mul_f32 v40, v40, v37
    v_mul_f32 v41, v41, v37
    v_mul_f32 v42, v42, v37
    v_mul_f32 v43, v43, v37
    v_accvgpr_write_b32 a92, v40
    v_accvgpr_write_b32 a93, v41
    v_accvgpr_write_b32 a94, v42
    v_accvgpr_write_b32 a95, v43
    v_accvgpr_read_b32 v40, a96
    v_accvgpr_read_b32 v41, a97
    v_accvgpr_read_b32 v42, a98
    v_accvgpr_read_b32 v43, a99
    v_mul_f32 v40, v40, v37
    v_mul_f32 v41, v41, v37
    v_mul_f32 v42, v42, v37
    v_mul_f32 v43, v43, v37
    v_accvgpr_write_b32 a96, v40
    v_accvgpr_write_b32 a97, v41
    v_accvgpr_write_b32 a98, v42
    v_accvgpr_write_b32 a99, v43
    v_accvgpr_read_b32 v40, a100
    v_accvgpr_read_b32 v41, a101
    v_accvgpr_read_b32 v42, a102
    v_accvgpr_read_b32 v43, a103
    v_mul_f32 v40, v40, v37
    v_mul_f32 v41, v41, v37
    v_mul_f32 v42, v42, v37
    v_mul_f32 v43, v43, v37
    v_accvgpr_write_b32 a100, v40
    v_accvgpr_write_b32 a101, v41
    v_accvgpr_write_b32 a102, v42
    v_accvgpr_write_b32 a103, v43
    v_accvgpr_read_b32 v40, a104
    v_accvgpr_read_b32 v41, a105
    v_accvgpr_read_b32 v42, a106
    v_accvgpr_read_b32 v43, a107
    v_mul_f32 v40, v40, v37
    v_mul_f32 v41, v41, v37
    v_mul_f32 v42, v42, v37
    v_mul_f32 v43, v43, v37
    v_accvgpr_write_b32 a104, v40
    v_accvgpr_write_b32 a105, v41
    v_accvgpr_write_b32 a106, v42
    v_accvgpr_write_b32 a107, v43
    v_accvgpr_read_b32 v40, a108
    v_accvgpr_read_b32 v41, a109
    v_accvgpr_read_b32 v42, a110
    v_accvgpr_read_b32 v43, a111
    v_mul_f32 v40, v40, v37
    v_mul_f32 v41, v41, v37
    v_mul_f32 v42, v42, v37
    v_mul_f32 v43, v43, v37
    v_accvgpr_write_b32 a108, v40
    v_accvgpr_write_b32 a109, v41
    v_accvgpr_write_b32 a110, v42
    v_accvgpr_write_b32 a111, v43
    v_accvgpr_read_b32 v40, a112
    v_accvgpr_read_b32 v41, a113
    v_accvgpr_read_b32 v42, a114
    v_accvgpr_read_b32 v43, a115
    v_mul_f32 v40, v40, v37
    v_mul_f32 v41, v41, v37
    v_mul_f32 v42, v42, v37
    v_mul_f32 v43, v43, v37
    v_accvgpr_write_b32 a112, v40
    v_accvgpr_write_b32 a113, v41
    v_accvgpr_write_b32 a114, v42
    v_accvgpr_write_b32 a115, v43
    v_accvgpr_read_b32 v40, a116
    v_accvgpr_read_b32 v41, a117
    v_accvgpr_read_b32 v42, a118
    v_accvgpr_read_b32 v43, a119
    v_mul_f32 v40, v40, v37
    v_mul_f32 v41, v41, v37
    v_mul_f32 v42, v42, v37
    v_mul_f32 v43, v43, v37
    v_accvgpr_write_b32 a116, v40
    v_accvgpr_write_b32 a117, v41
    v_accvgpr_write_b32 a118, v42
    v_accvgpr_write_b32 a119, v43
    v_accvgpr_read_b32 v40, a120
    v_accvgpr_read_b32 v41, a121
    v_accvgpr_read_b32 v42, a122
    v_accvgpr_read_b32 v43, a123
    v_mul_f32 v40, v40, v37
    v_mul_f32 v41, v41, v37
    v_mul_f32 v42, v42, v37
    v_mul_f32 v43, v43, v37
    v_accvgpr_write_b32 a120, v40
    v_accvgpr_write_b32 a121, v41
    v_accvgpr_write_b32 a122, v42
    v_accvgpr_write_b32 a123, v43
    v_accvgpr_read_b32 v40, a124
    v_accvgpr_read_b32 v41, a125
    v_accvgpr_read_b32 v42, a126
    v_accvgpr_read_b32 v43, a127
    v_mul_f32 v40, v40, v37
    v_mul_f32 v41, v41, v37
    v_mul_f32 v42, v42, v37
    v_mul_f32 v43, v43, v37
    v_accvgpr_write_b32 a124, v40
    v_accvgpr_write_b32 a125, v41
    v_accvgpr_write_b32 a126, v42
    v_accvgpr_write_b32 a127, v43
    s_nop 1
    s_branch L_attn_back0
L_attn_rare1:
    s_nop 15
    v_mov_b32 v40, v35
    s_nop 1
    v_permlane32_swap_b32 v40, v35
    s_nop 1
    v_max3_f32 v40, v40, v35, 0
    v_sub_f32 v37, 0, v40
    v_exp_f32 v37, v37
    v_sub_f32 v48, v48, v40
    v_sub_f32 v80, v80, v40
    v_sub_f32 v49, v49, v40
    v_sub_f32 v81, v81, v40
    v_sub_f32 v50, v50, v40
    v_sub_f32 v82, v82, v40
    v_sub_f32 v51, v51, v40
    v_sub_f32 v83, v83, v40
    v_sub_f32 v52, v52, v40
    v_sub_f32 v84, v84, v40
    v_sub_f32 v53, v53, v40
    v_sub_f32 v85, v85, v40
    v_sub_f32 v54, v54, v40
    v_sub_f32 v86, v86, v40
    v_sub_f32 v55, v55, v40
    v_sub_f32 v87, v87, v40
    v_sub_f32 v56, v56, v40
    v_sub_f32 v88, v88, v40
    v_sub_f32 v57, v57, v40
    v_sub_f32 v89, v89, v40
    v_sub_f32 v58, v58, v40
    v_sub_f32 v90, v90, v40
    v_sub_f32 v59, v59, v40
    v_sub_f32 v91, v91, v40
    v_sub_f32 v60, v60, v40
    v_sub_f32 v92, v92, v40
    v_sub_f32 v61, v61, v40
    v_sub_f32 v93, v93, v40
    v_sub_f32 v62, v62, v40
    v_sub_f32 v94, v94, v40
    v_sub_f32 v63, v63, v40
    v_sub_f32 v95, v95, v40
    v_mul_f32 v34, v34, v37
    v_accvgpr_read_b32 v40, a0
    v_accvgpr_read_b32 v41, a1
    v_accvgpr_read_b32 v42, a2
    v_accvgpr_read_b32 v43, a3
    v_mul_f32 v40, v40, v37
    v_mul_f32 v41, v41, v37
    v_mul_f32 v42, v42, v37
    v_mul_f32 v43, v43, v37
    v_accvgpr_write_b32 a0, v40
    v_accvgpr_write_b32 a1, v41
    v_accvgpr_write_b32 a2, v42
    v_accvgpr_write_b32 a3, v43
    v_accvgpr_read_b32 v40, a4
    v_accvgpr_read_b32 v41, a5
    v_accvgpr_read_b32 v42, a6
    v_accvgpr_read_b32 v43, a7
    v_mul_f32 v40, v40, v37
    v_mul_f32 v41, v41, v37
    v_mul_f32 v42, v42, v37
    v_mul_f32 v43, v43, v37
    v_accvgpr_write_b32 a4, v40
    v_accvgpr_write_b32 a5, v41
    v_accvgpr_write_b32 a6, v42
    v_accvgpr_write_b32 a7, v43
    v_accvgpr_read_b32 v40, a8
    v_accvgpr_read_b32 v41, a9
    v_accvgpr_read_b32 v42, a10
    v_accvgpr_read_b32 v43, a11
    v_mul_f32 v40, v40, v37
    v_mul_f32 v41, v41, v37
    v_mul_f32 v42, v42, v37
    v_mul_f32 v43, v43, v37
    v_accvgpr_write_b32 a8, v40
    v_accvgpr_write_b32 a9, v41
    v_accvgpr_write_b32 a10, v42
    v_accvgpr_write_b32 a11, v43
    v_accvgpr_read_b32 v40, a12
    v_accvgpr_read_b32 v41, a13
    v_accvgpr_read_b32 v42, a14
    v_accvgpr_read_b32 v43, a15
    v_mul_f32 v40, v40, v37
    v_mul_f32 v41, v41, v37
    v_mul_f32 v42, v42, v37
    v_mul_f32 v43, v43, v37
    v_accvgpr_write_b32 a12, v40
    v_accvgpr_write_b32 a13, v41
    v_accvgpr_write_b32 a14, v42
    v_accvgpr_write_b32 a15, v43
    v_accvgpr_read_b32 v40, a16
    v_accvgpr_read_b32 v41, a17
    v_accvgpr_read_b32 v42, a18
    v_accvgpr_read_b32 v43, a19
    v_mul_f32 v40, v40, v37
    v_mul_f32 v41, v41, v37
    v_mul_f32 v42, v42, v37
    v_mul_f32 v43, v43, v37
    v_accvgpr_write_b32 a16, v40
    v_accvgpr_write_b32 a17, v41
    v_accvgpr_write_b32 a18, v42
    v_accvgpr_write_b32 a19, v43
    v_accvgpr_read_b32 v40, a20
    v_accvgpr_read_b32 v41, a21
    v_accvgpr_read_b32 v42, a22
    v_accvgpr_read_b32 v43, a23
    v_mul_f32 v40, v40, v37
    v_mul_f32 v41, v41, v37
    v_mul_f32 v42, v42, v37
    v_mul_f32 v43, v43, v37
    v_accvgpr_write_b32 a20, v40
    v_accvgpr_write_b32 a21, v41
    v_accvgpr_write_b32 a22, v42
    v_accvgpr_write_b32 a23, v43
    v_accvgpr_read_b32 v40, a24
    v_accvgpr_read_b32 v41, a25
    v_accvgpr_read_b32 v42, a26
    v_accvgpr_read_b32 v43, a27
    v_mul_f32 v40, v40, v37
    v_mul_f32 v41, v41, v37
    v_mul_f32 v42, v42, v37
    v_mul_f32 v43, v43, v37
    v_accvgpr_write_b32 a24, v40
    v_accvgpr_write_b32 a25, v41
    v_accvgpr_write_b32 a26, v42
    v_accvgpr_write_b32 a27, v43
    v_accvgpr_read_b32 v40, a28
    v_accvgpr_read_b32 v41, a29
    v_accvgpr_read_b32 v42, a30
    v_accvgpr_read_b32 v43, a31
    v_mul_f32 v40, v40, v37
    v_mul_f32 v41, v41, v37
    v_mul_f32 v42, v42, v37
    v_mul_f32 v43, v43, v37
    v_accvgpr_write_b32 a28, v40
    v_accvgpr_write_b32 a29, v41
    v_accvgpr_write_b32 a30, v42
    v_accvgpr_write_b32 a31, v43
    v_accvgpr_read_b32 v40, a32
    v_accvgpr_read_b32 v41, a33
    v_accvgpr_read_b32 v42, a34
    v_accvgpr_read_b32 v43, a35
    v_mul_f32 v40, v40, v37
    v_mul_f32 v41, v41, v37
    v_mul_f32 v42, v42, v37
    v_mul_f32 v43, v43, v37
    v_accvgpr_write_b32 a32, v40
    v_accvgpr_write_b32 a33, v41
    v_accvgpr_write_b32 a34, v42
    v_accvgpr_write_b32 a35, v43
    v_accvgpr_read_b32 v40, a36
    v_accvgpr_read_b32 v41, a37
    v_accvgpr_read_b32 v42, a38
    v_accvgpr_read_b32 v43, a39
    v_mul_f32 v40, v40, v37
    v_mul_f32 v41, v41, v37
    v_mul_f32 v42, v42, v37
    v_mul_f32 v43, v43, v37
    v_accvgpr_write_b32 a36, v40
    v_accvgpr_write_b32 a37, v41
    v_accvgpr_write_b32 a38, v42
    v_accvgpr_write_b32 a39, v43
    v_accvgpr_read_b32 v40, a40
    v_accvgpr_read_b32 v41, a41
    v_accvgpr_read_b32 v42, a42
    v_accvgpr_read_b32 v43, a43
    v_mul_f32 v40, v40, v37
    v_mul_f32 v41, v41, v37
    v_mul_f32 v42, v42, v37
    v_mul_f32 v43, v43, v37
    v_accvgpr_write_b32 a40, v40
    v_accvgpr_write_b32 a41, v41
    v_accvgpr_write_b32 a42, v42
    v_accvgpr_write_b32 a43, v43
    v_accvgpr_read_b32 v40, a44
    v_accvgpr_read_b32 v41, a45
    v_accvgpr_read_b32 v42, a46
    v_accvgpr_read_b32 v43, a47
    v_mul_f32 v40, v40, v37
    v_mul_f32 v41, v41, v37
    v_mul_f32 v42, v42, v37
    v_mul_f32 v43, v43, v37
    v_accvgpr_write_b32 a44, v40
    v_accvgpr_write_b32 a45, v41
    v_accvgpr_write_b32 a46, v42
    v_accvgpr_write_b32 a47, v43
    v_accvgpr_read_b32 v40, a48
    v_accvgpr_read_b32 v41, a49
    v_accvgpr_read_b32 v42, a50
    v_accvgpr_read_b32 v43, a51
    v_mul_f32 v40, v40, v37
    v_mul_f32 v41, v41, v37
    v_mul_f32 v42, v42, v37
    v_mul_f32 v43, v43, v37
    v_accvgpr_write_b32 a48, v40
    v_accvgpr_write_b32 a49, v41
    v_accvgpr_write_b32 a50, v42
    v_accvgpr_write_b32 a51, v43
    v_accvgpr_read_b32 v40, a52
    v_accvgpr_read_b32 v41, a53
    v_accvgpr_read_b32 v42, a54
    v_accvgpr_read_b32 v43, a55
    v_mul_f32 v40, v40, v37
    v_mul_f32 v41, v41, v37
    v_mul_f32 v42, v42, v37
    v_mul_f32 v43, v43, v37
    v_accvgpr_write_b32 a52, v40
    v_accvgpr_write_b32 a53, v41
    v_accvgpr_write_b32 a54, v42
    v_accvgpr_write_b32 a55, v43
    v_accvgpr_read_b32 v40, a56
    v_accvgpr_read_b32 v41, a57
    v_accvgpr_read_b32 v42, a58
    v_accvgpr_read_b32 v43, a59
    v_mul_f32 v40, v40, v37
    v_mul_f32 v41, v41, v37
    v_mul_f32 v42, v42, v37
    v_mul_f32 v43, v43, v37
    v_accvgpr_write_b32 a56, v40
    v_accvgpr_write_b32 a57, v41
    v_accvgpr_write_b32 a58, v42
    v_accvgpr_write_b32 a59, v43
    v_accvgpr_read_b32 v40, a60
    v_accvgpr_read_b32 v41, a61
    v_accvgpr_read_b32 v42, a62
    v_accvgpr_read_b32 v43, a63
    v_mul_f32 v40, v40, v37
    v_mul_f32 v41, v41, v37
    v_mul_f32 v42, v42, v37
    v_mul_f32 v43, v43, v37
    v_accvgpr_write_b32 a60, v40
    v_accvgpr_write_b32 a61, v41
    v_accvgpr_write_b32 a62, v42
    v_accvgpr_write_b32 a63, v43
    v_accvgpr_read_b32 v40, a64
    v_accvgpr_read_b32 v41, a65
    v_accvgpr_read_b32 v42, a66
    v_accvgpr_read_b32 v43, a67
    v_mul_f32 v40, v40, v37
    v_mul_f32 v41, v41, v37
    v_mul_f32 v42, v42, v37
    v_mul_f32 v43, v43, v37
    v_accvgpr_write_b32 a64, v40
    v_accvgpr_write_b32 a65, v41
    v_accvgpr_write_b32 a66, v42
    v_accvgpr_write_b32 a67, v43
    v_accvgpr_read_b32 v40, a68
    v_accvgpr_read_b32 v41, a69
    v_accvgpr_read_b32 v42, a70
    v_accvgpr_read_b32 v43, a71
    v_mul_f32 v40, v40, v37
    v_mul_f32 v41, v41, v37
    v_mul_f32 v42, v42, v37
    v_mul_f32 v43, v43, v37
    v_accvgpr_write_b32 a68, v40
    v_accvgpr_write_b32 a69, v41
    v_accvgpr_write_b32 a70, v42
    v_accvgpr_write_b32 a71, v43
    v_accvgpr_read_b32 v40, a72
    v_accvgpr_read_b32 v41, a73
    v_accvgpr_read_b32 v42, a74
    v_accvgpr_read_b32 v43, a75
    v_mul_f32 v40, v40, v37
    v_mul_f32 v41, v41, v37
    v_mul_f32 v42, v42, v37
    v_mul_f32 v43, v43, v37
    v_accvgpr_write_b32 a72, v40
    v_accvgpr_write_b32 a73, v41
    v_accvgpr_write_b32 a74, v42
    v_accvgpr_write_b32 a75, v43
    v_accvgpr_read_b32 v40, a76
    v_accvgpr_read_b32 v41, a77
    v_accvgpr_read_b32 v42, a78
    v_accvgpr_read_b32 v43, a79
    v_mul_f32 v40, v40, v37
    v_mul_f32 v41, v41, v37
    v_mul_f32 v42, v42, v37
    v_mul_f32 v43, v43, v37
    v_accvgpr_write_b32 a76, v40
    v_accvgpr_write_b32 a77, v41
    v_accvgpr_write_b32 a78, v42
    v_accvgpr_write_b32 a79, v43
    v_accvgpr_read_b32 v40, a80
    v_accvgpr_read_b32 v41, a81
    v_accvgpr_read_b32 v42, a82
    v_accvgpr_read_b32 v43, a83
    v_mul_f32 v40, v40, v37
    v_mul_f32 v41, v41, v37
    v_mul_f32 v42, v42, v37
    v_mul_f32 v43, v43, v37
    v_accvgpr_write_b32 a80, v40
    v_accvgpr_write_b32 a81, v41
    v_accvgpr_write_b32 a82, v42
    v_accvgpr_write_b32 a83, v43
    v_accvgpr_read_b32 v40, a84
    v_accvgpr_read_b32 v41, a85
    v_accvgpr_read_b32 v42, a86
    v_accvgpr_read_b32 v43, a87
    v_mul_f32 v40, v40, v37
    v_mul_f32 v41, v41, v37
    v_mul_f32 v42, v42, v37
    v_mul_f32 v43, v43, v37
    v_accvgpr_write_b32 a84, v40
    v_accvgpr_write_b32 a85, v41
    v_accvgpr_write_b32 a86, v42
    v_accvgpr_write_b32 a87, v43
    v_accvgpr_read_b32 v40, a88
    v_accvgpr_read_b32 v41, a89
    v_accvgpr_read_b32 v42, a90
    v_accvgpr_read_b32 v43, a91
    v_mul_f32 v40, v40, v37
    v_mul_f32 v41, v41, v37
    v_mul_f32 v42, v42, v37
    v_mul_f32 v43, v43, v37
    v_accvgpr_write_b32 a88, v40
    v_accvgpr_write_b32 a89, v41
    v_accvgpr_write_b32 a90, v42
    v_accvgpr_write_b32 a91, v43
    v_accvgpr_read_b32 v40, a92
    v_accvgpr_read_b32 v41, a93
    v_accvgpr_read_b32 v42, a94
    v_accvgpr_read_b32 v43, a95
    v_mul_f32 v40, v40, v37
    v_mul_f32 v41, v41, v37
    v_mul_f32 v42, v42, v37
    v_mul_f32 v43, v43, v37
    v_accvgpr_write_b32 a92, v40
    v_accvgpr_write_b32 a93, v41
    v_accvgpr_write_b32 a94, v42
    v_accvgpr_write_b32 a95, v43
    v_accvgpr_read_b32 v40, a96
    v_accvgpr_read_b32 v41, a97
    v_accvgpr_read_b32 v42, a98
    v_accvgpr_read_b32 v43, a99
    v_mul_f32 v40, v40, v37
    v_mul_f32 v41, v41, v37
    v_mul_f32 v42, v42, v37
    v_mul_f32 v43, v43, v37
    v_accvgpr_write_b32 a96, v40
    v_accvgpr_write_b32 a97, v41
    v_accvgpr_write_b32 a98, v42
    v_accvgpr_write_b32 a99, v43
    v_accvgpr_read_b32 v40, a100
    v_accvgpr_read_b32 v41, a101
    v_accvgpr_read_b32 v42, a102
    v_accvgpr_read_b32 v43, a103
    v_mul_f32 v40, v40, v37
    v_mul_f32 v41, v41, v37
    v_mul_f32 v42, v42, v37
    v_mul_f32 v43, v43, v37
    v_accvgpr_write_b32 a100, v40
    v_accvgpr_write_b32 a101, v41
    v_accvgpr_write_b32 a102, v42
    v_accvgpr_write_b32 a103, v43
    v_accvgpr_read_b32 v40, a104
    v_accvgpr_read_b32 v41, a105
    v_accvgpr_read_b32 v42, a106
    v_accvgpr_read_b32 v43, a107
    v_mul_f32 v40, v40, v37
    v_mul_f32 v41, v41, v37
    v_mul_f32 v42, v42, v37
    v_mul_f32 v43, v43, v37
    v_accvgpr_write_b32 a104, v40
    v_accvgpr_write_b32 a105, v41
    v_accvgpr_write_b32 a106, v42
    v_accvgpr_write_b32 a107, v43
    v_accvgpr_read_b32 v40, a108
    v_accvgpr_read_b32 v41, a109
    v_accvgpr_read_b32 v42, a110
    v_accvgpr_read_b32 v43, a111
    v_mul_f32 v40, v40, v37
    v_mul_f32 v41, v41, v37
    v_mul_f32 v42, v42, v37
    v_mul_f32 v43, v43, v37
    v_accvgpr_write_b32 a108, v40
    v_accvgpr_write_b32 a109, v41
    v_accvgpr_write_b32 a110, v42
    v_accvgpr_write_b32 a111, v43
    v_accvgpr_read_b32 v40, a112
    v_accvgpr_read_b32 v41, a113
    v_accvgpr_read_b32 v42, a114
    v_accvgpr_read_b32 v43, a115
    v_mul_f32 v40, v40, v37
    v_mul_f32 v41, v41, v37
    v_mul_f32 v42, v42, v37
    v_mul_f32 v43, v43, v37
    v_accvgpr_write_b32 a112, v40
    v_accvgpr_write_b32 a113, v41
    v_accvgpr_write_b32 a114, v42
    v_accvgpr_write_b32 a115, v43
    v_accvgpr_read_b32 v40, a116
    v_accvgpr_read_b32 v41, a117
    v_accvgpr_read_b32 v42, a118
    v_accvgpr_read_b32 v43, a119
    v_mul_f32 v40, v40, v37
    v_mul_f32 v41, v41, v37
    v_mul_f32 v42, v42, v37
    v_mul_f32 v43, v43, v37
    v_accvgpr_write_b32 a116, v40
    v_accvgpr_write_b32 a117, v41
    v_accvgpr_write_b32 a118, v42
    v_accvgpr_write_b32 a119, v43
    v_accvgpr_read_b32 v40, a120
    v_accvgpr_read_b32 v41, a121
    v_accvgpr_read_b32 v42, a122
    v_accvgpr_read_b32 v43, a123
    v_mul_f32 v40, v40, v37
    v_mul_f32 v41, v41, v37
    v_mul_f32 v42, v42, v37
    v_mul_f32 v43, v43, v37
    v_accvgpr_write_b32 a120, v40
    v_accvgpr_write_b32 a121, v41
    v_accvgpr_write_b32 a122, v42
    v_accvgpr_write_b32 a123, v43
    v_accvgpr_read_b32 v40, a124
    v_accvgpr_read_b32 v41, a125
    v_accvgpr_read_b32 v42, a126
    v_accvgpr_read_b32 v43, a127
    v_mul_f32 v40, v40, v37
    v_mul_f32 v41, v41, v37
    v_mul_f32 v42, v42, v37
    v_mul_f32 v43, v43, v37
    v_accvgpr_write_b32 a124, v40
    v_accvgpr_write_b32 a125, v41
    v_accvgpr_write_b32 a126, v42
    v_accvgpr_write_b32 a127, v43
    s_nop 1
    s_branch L_attn_back1
L_attn_rare2:
    s_nop 15
    v_mov_b32 v40, v35
    s_nop 1
    v_permlane32_swap_b32 v40, v35
    s_nop 1
    v_max3_f32 v40, v40, v35, 0
    v_sub_f32 v37, 0, v40
    v_exp_f32 v37, v37
    v_sub_f32 v64, v64, v40
    v_sub_f32 v80, v80, v40
    v_sub_f32 v65, v65, v40
    v_sub_f32 v81, v81, v40
    v_sub_f32 v66, v66, v40
    v_sub_f32 v82, v82, v40
    v_sub_f32 v67, v67, v40
    v_sub_f32 v83, v83, v40
    v_sub_f32 v68, v68, v40
    v_sub_f32 v84, v84, v40
    v_sub_f32 v69, v69, v40
    v_sub_f32 v85, v85, v40
    v_sub_f32 v70, v70, v40
    v_sub_f32 v86, v86, v40
    v_sub_f32 v71, v71, v40
    v_sub_f32 v87, v87, v40
    v_sub_f32 v72, v72, v40
    v_sub_f32 v88, v88, v40
    v_sub_f32 v73, v73, v40
    v_sub_f32 v89, v89, v40
    v_sub_f32 v74, v74, v40
    v_sub_f32 v90, v90, v40
    v_sub_f32 v75, v75, v40
    v_sub_f32 v91, v91, v40
    v_sub_f32 v76, v76, v40
    v_sub_f32 v92, v92, v40
    v_sub_f32 v77, v77, v40
    v_sub_f32 v93, v93, v40
    v_sub_f32 v78, v78, v40
    v_sub_f32 v94, v94, v40
    v_sub_f32 v79, v79, v40
    v_sub_f32 v95, v95, v40
    v_mul_f32 v34, v34, v37
    v_accvgpr_read_b32 v40, a0
    v_accvgpr_read_b32 v41, a1
    v_accvgpr_read_b32 v42, a2
    v_accvgpr_read_b32 v43, a3
    v_mul_f32 v40, v40, v37
    v_mul_f32 v41, v41, v37
    v_mul_f32 v42, v42, v37
    v_mul_f32 v43, v43, v37
    v_accvgpr_write_b32 a0, v40
    v_accvgpr_write_b32 a1, v41
    v_accvgpr_write_b32 a2, v42
    v_accvgpr_write_b32 a3, v43
    v_accvgpr_read_b32 v40, a4
    v_accvgpr_read_b32 v41, a5
    v_accvgpr_read_b32 v42, a6
    v_accvgpr_read_b32 v43, a7
    v_mul_f32 v40, v40, v37
    v_mul_f32 v41, v41, v37
    v_mul_f32 v42, v42, v37
    v_mul_f32 v43, v43, v37
    v_accvgpr_write_b32 a4, v40
    v_accvgpr_write_b32 a5, v41
    v_accvgpr_write_b32 a6, v42
    v_accvgpr_write_b32 a7, v43
    v_accvgpr_read_b32 v40, a8
    v_accvgpr_read_b32 v41, a9
    v_accvgpr_read_b32 v42, a10
    v_accvgpr_read_b32 v43, a11
    v_mul_f32 v40, v40, v37
    v_mul_f32 v41, v41, v37
    v_mul_f32 v42, v42, v37
    v_mul_f32 v43, v43, v37
    v_accvgpr_write_b32 a8, v40
    v_accvgpr_write_b32 a9, v41
    v_accvgpr_write_b32 a10, v42
    v_accvgpr_write_b32 a11, v43
    v_accvgpr_read_b32 v40, a12
    v_accvgpr_read_b32 v41, a13
    v_accvgpr_read_b32 v42, a14
    v_accvgpr_read_b32 v43, a15
    v_mul_f32 v40, v40, v37
    v_mul_f32 v41, v41, v37
    v_mul_f32 v42, v42, v37
    v_mul_f32 v43, v43, v37
    v_accvgpr_write_b32 a12, v40
    v_accvgpr_write_b32 a13, v41
    v_accvgpr_write_b32 a14, v42
    v_accvgpr_write_b32 a15, v43
    v_accvgpr_read_b32 v40, a16
    v_accvgpr_read_b32 v41, a17
    v_accvgpr_read_b32 v42, a18
    v_accvgpr_read_b32 v43, a19
    v_mul_f32 v40, v40, v37
    v_mul_f32 v41, v41, v37
    v_mul_f32 v42, v42, v37
    v_mul_f32 v43, v43, v37
    v_accvgpr_write_b32 a16, v40
    v_accvgpr_write_b32 a17, v41
    v_accvgpr_write_b32 a18, v42
    v_accvgpr_write_b32 a19, v43
    v_accvgpr_read_b32 v40, a20
    v_accvgpr_read_b32 v41, a21
    v_accvgpr_read_b32 v42, a22
    v_accvgpr_read_b32 v43, a23
    v_mul_f32 v40, v40, v37
    v_mul_f32 v41, v41, v37
    v_mul_f32 v42, v42, v37
    v_mul_f32 v43, v43, v37
    v_accvgpr_write_b32 a20, v40
    v_accvgpr_write_b32 a21, v41
    v_accvgpr_write_b32 a22, v42
    v_accvgpr_write_b32 a23, v43
    v_accvgpr_read_b32 v40, a24
    v_accvgpr_read_b32 v41, a25
    v_accvgpr_read_b32 v42, a26
    v_accvgpr_read_b32 v43, a27
    v_mul_f32 v40, v40, v37
    v_mul_f32 v41, v41, v37
    v_mul_f32 v42, v42, v37
    v_mul_f32 v43, v43, v37
    v_accvgpr_write_b32 a24, v40
    v_accvgpr_write_b32 a25, v41
    v_accvgpr_write_b32 a26, v42
    v_accvgpr_write_b32 a27, v43
    v_accvgpr_read_b32 v40, a28
    v_accvgpr_read_b32 v41, a29
    v_accvgpr_read_b32 v42, a30
    v_accvgpr_read_b32 v43, a31
    v_mul_f32 v40, v40, v37
    v_mul_f32 v41, v41, v37
    v_mul_f32 v42, v42, v37
    v_mul_f32 v43, v43, v37
    v_accvgpr_write_b32 a28, v40
    v_accvgpr_write_b32 a29, v41
    v_accvgpr_write_b32 a30, v42
    v_accvgpr_write_b32 a31, v43
    v_accvgpr_read_b32 v40, a32
    v_accvgpr_read_b32 v41, a33
    v_accvgpr_read_b32 v42, a34
    v_accvgpr_read_b32 v43, a35
    v_mul_f32 v40, v40, v37
    v_mul_f32 v41, v41, v37
    v_mul_f32 v42, v42, v37
    v_mul_f32 v43, v43, v37
    v_accvgpr_write_b32 a32, v40
    v_accvgpr_write_b32 a33, v41
    v_accvgpr_write_b32 a34, v42
    v_accvgpr_write_b32 a35, v43
    v_accvgpr_read_b32 v40, a36
    v_accvgpr_read_b32 v41, a37
    v_accvgpr_read_b32 v42, a38
    v_accvgpr_read_b32 v43, a39
    v_mul_f32 v40, v40, v37
    v_mul_f32 v41, v41, v37
    v_mul_f32 v42, v42, v37
    v_mul_f32 v43, v43, v37
    v_accvgpr_write_b32 a36, v40
    v_accvgpr_write_b32 a37, v41
    v_accvgpr_write_b32 a38, v42
    v_accvgpr_write_b32 a39, v43
    v_accvgpr_read_b32 v40, a40
    v_accvgpr_read_b32 v41, a41
    v_accvgpr_read_b32 v42, a42
    v_accvgpr_read_b32 v43, a43
    v_mul_f32 v40, v40, v37
    v_mul_f32 v41, v41, v37
    v_mul_f32 v42, v42, v37
    v_mul_f32 v43, v43, v37
    v_accvgpr_write_b32 a40, v40
    v_accvgpr_write_b32 a41, v41
    v_accvgpr_write_b32 a42, v42
    v_accvgpr_write_b32 a43, v43
    v_accvgpr_read_b32 v40, a44
    v_accvgpr_read_b32 v41, a45
    v_accvgpr_read_b32 v42, a46
    v_accvgpr_read_b32 v43, a47
    v_mul_f32 v40, v40, v37
    v_mul_f32 v41, v41, v37
    v_mul_f32 v42, v42, v37
    v_mul_f32 v43, v43, v37
    v_accvgpr_write_b32 a44, v40
    v_accvgpr_write_b32 a45, v41
    v_accvgpr_write_b32 a46, v42
    v_accvgpr_write_b32 a47, v43
    v_accvgpr_read_b32 v40, a48
    v_accvgpr_read_b32 v41, a49
    v_accvgpr_read_b32 v42, a50
    v_accvgpr_read_b32 v43, a51
    v_mul_f32 v40, v40, v37
    v_mul_f32 v41, v41, v37
    v_mul_f32 v42, v42, v37
    v_mul_f32 v43, v43, v37
    v_accvgpr_write_b32 a48, v40
    v_accvgpr_write_b32 a49, v41
    v_accvgpr_write_b32 a50, v42
    v_accvgpr_write_b32 a51, v43
    v_accvgpr_read_b32 v40, a52
    v_accvgpr_read_b32 v41, a53
    v_accvgpr_read_b32 v42, a54
    v_accvgpr_read_b32 v43, a55
    v_mul_f32 v40, v40, v37
    v_mul_f32 v41, v41, v37
    v_mul_f32 v42, v42, v37
    v_mul_f32 v43, v43, v37
    v_accvgpr_write_b32 a52, v40
    v_accvgpr_write_b32 a53, v41
    v_accvgpr_write_b32 a54, v42
    v_accvgpr_write_b32 a55, v43
    v_accvgpr_read_b32 v40, a56
    v_accvgpr_read_b32 v41, a57
    v_accvgpr_read_b32 v42, a58
    v_accvgpr_read_b32 v43, a59
    v_mul_f32 v40, v40, v37
    v_mul_f32 v41, v41, v37
    v_mul_f32 v42, v42, v37
    v_mul_f32 v43, v43, v37
    v_accvgpr_write_b32 a56, v40
    v_accvgpr_write_b32 a57, v41
    v_accvgpr_write_b32 a58, v42
    v_accvgpr_write_b32 a59, v43
    v_accvgpr_read_b32 v40, a60
    v_accvgpr_read_b32 v41, a61
    v_accvgpr_read_b32 v42, a62
    v_accvgpr_read_b32 v43, a63
    v_mul_f32 v40, v40, v37
    v_mul_f32 v41, v41, v37
    v_mul_f32 v42, v42, v37
    v_mul_f32 v43, v43, v37
    v_accvgpr_write_b32 a60, v40
    v_accvgpr_write_b32 a61, v41
    v_accvgpr_write_b32 a62, v42
    v_accvgpr_write_b32 a63, v43
    v_accvgpr_read_b32 v40, a64
    v_accvgpr_read_b32 v41, a65
    v_accvgpr_read_b32 v42, a66
    v_accvgpr_read_b32 v43, a67
    v_mul_f32 v40, v40, v37
    v_mul_f32 v41, v41, v37
    v_mul_f32 v42, v42, v37
    v_mul_f32 v43, v43, v37
    v_accvgpr_write_b32 a64, v40
    v_accvgpr_write_b32 a65, v41
    v_accvgpr_write_b32 a66, v42
    v_accvgpr_write_b32 a67, v43
    v_accvgpr_read_b32 v40, a68
    v_accvgpr_read_b32 v41, a69
    v_accvgpr_read_b32 v42, a70
    v_accvgpr_read_b32 v43, a71
    v_mul_f32 v40, v40, v37
    v_mul_f32 v41, v41, v37
    v_mul_f32 v42, v42, v37
    v_mul_f32 v43, v43, v37
    v_accvgpr_write_b32 a68, v40
    v_accvgpr_write_b32 a69, v41
    v_accvgpr_write_b32 a70, v42
    v_accvgpr_write_b32 a71, v43
    v_accvgpr_read_b32 v40, a72
    v_accvgpr_read_b32 v41, a73
    v_accvgpr_read_b32 v42, a74
    v_accvgpr_read_b32 v43, a75
    v_mul_f32 v40, v40, v37
    v_mul_f32 v41, v41, v37
    v_mul_f32 v42, v42, v37
    v_mul_f32 v43, v43, v37
    v_accvgpr_write_b32 a72, v40
    v_accvgpr_write_b32 a73, v41
    v_accvgpr_write_b32 a74, v42
    v_accvgpr_write_b32 a75, v43
    v_accvgpr_read_b32 v40, a76
    v_accvgpr_read_b32 v41, a77
    v_accvgpr_read_b32 v42, a78
    v_accvgpr_read_b32 v43, a79
    v_mul_f32 v40, v40, v37
    v_mul_f32 v41, v41, v37
    v_mul_f32 v42, v42, v37
    v_mul_f32 v43, v43, v37
    v_accvgpr_write_b32 a76, v40
    v_accvgpr_write_b32 a77, v41
    v_accvgpr_write_b32 a78, v42
    v_accvgpr_write_b32 a79, v43
    v_accvgpr_read_b32 v40, a80
    v_accvgpr_read_b32 v41, a81
    v_accvgpr_read_b32 v42, a82
    v_accvgpr_read_b32 v43, a83
    v_mul_f32 v40, v40, v37
    v_mul_f32 v41, v41, v37
    v_mul_f32 v42, v42, v37
    v_mul_f32 v43, v43, v37
    v_accvgpr_write_b32 a80, v40
    v_accvgpr_write_b32 a81, v41
    v_accvgpr_write_b32 a82, v42
    v_accvgpr_write_b32 a83, v43
    v_accvgpr_read_b32 v40, a84
    v_accvgpr_read_b32 v41, a85
    v_accvgpr_read_b32 v42, a86
    v_accvgpr_read_b32 v43, a87
    v_mul_f32 v40, v40, v37
    v_mul_f32 v41, v41, v37
    v_mul_f32 v42, v42, v37
    v_mul_f32 v43, v43, v37
    v_accvgpr_write_b32 a84, v40
    v_accvgpr_write_b32 a85, v41
    v_accvgpr_write_b32 a86, v42
    v_accvgpr_write_b32 a87, v43
    v_accvgpr_read_b32 v40, a88
    v_accvgpr_read_b32 v41, a89
    v_accvgpr_read_b32 v42, a90
    v_accvgpr_read_b32 v43, a91
    v_mul_f32 v40, v40, v37
    v_mul_f32 v41, v41, v37
    v_mul_f32 v42, v42, v37
    v_mul_f32 v43, v43, v37
    v_accvgpr_write_b32 a88, v40
    v_accvgpr_write_b32 a89, v41
    v_accvgpr_write_b32 a90, v42
    v_accvgpr_write_b32 a91, v43
    v_accvgpr_read_b32 v40, a92
    v_accvgpr_read_b32 v41, a93
    v_accvgpr_read_b32 v42, a94
    v_accvgpr_read_b32 v43, a95
    v_mul_f32 v40, v40, v37
    v_mul_f32 v41, v41, v37
    v_mul_f32 v42, v42, v37
    v_mul_f32 v43, v43, v37
    v_accvgpr_write_b32 a92, v40
    v_accvgpr_write_b32 a93, v41
    v_accvgpr_write_b32 a94, v42
    v_accvgpr_write_b32 a95, v43
    v_accvgpr_read_b32 v40, a96
    v_accvgpr_read_b32 v41, a97
    v_accvgpr_read_b32 v42, a98
    v_accvgpr_read_b32 v43, a99
    v_mul_f32 v40, v40, v37
    v_mul_f32 v41, v41, v37
    v_mul_f32 v42, v42, v37
    v_mul_f32 v43, v43, v37
    v_accvgpr_write_b32 a96, v40
    v_accvgpr_write_b32 a97, v41
    v_accvgpr_write_b32 a98, v42
    v_accvgpr_write_b32 a99, v43
    v_accvgpr_read_b32 v40, a100
    v_accvgpr_read_b32 v41, a101
    v_accvgpr_read_b32 v42, a102
    v_accvgpr_read_b32 v43, a103
    v_mul_f32 v40, v40, v37
    v_mul_f32 v41, v41, v37
    v_mul_f32 v42, v42, v37
    v_mul_f32 v43, v43, v37
    v_accvgpr_write_b32 a100, v40
    v_accvgpr_write_b32 a101, v41
    v_accvgpr_write_b32 a102, v42
    v_accvgpr_write_b32 a103, v43
    v_accvgpr_read_b32 v40, a104
    v_accvgpr_read_b32 v41, a105
    v_accvgpr_read_b32 v42, a106
    v_accvgpr_read_b32 v43, a107
    v_mul_f32 v40, v40, v37
    v_mul_f32 v41, v41, v37
    v_mul_f32 v42, v42, v37
    v_mul_f32 v43, v43, v37
    v_accvgpr_write_b32 a104, v40
    v_accvgpr_write_b32 a105, v41
    v_accvgpr_write_b32 a106, v42
    v_accvgpr_write_b32 a107, v43
    v_accvgpr_read_b32 v40, a108
    v_accvgpr_read_b32 v41, a109
    v_accvgpr_read_b32 v42, a110
    v_accvgpr_read_b32 v43, a111
    v_mul_f32 v40, v40, v37
    v_mul_f32 v41, v41, v37
    v_mul_f32 v42, v42, v37
    v_mul_f32 v43, v43, v37
    v_accvgpr_write_b32 a108, v40
    v_accvgpr_write_b32 a109, v41
    v_accvgpr_write_b32 a110, v42
    v_accvgpr_write_b32 a111, v43
    v_accvgpr_read_b32 v40, a112
    v_accvgpr_read_b32 v41, a113
    v_accvgpr_read_b32 v42, a114
    v_accvgpr_read_b32 v43, a115
    v_mul_f32 v40, v40, v37
    v_mul_f32 v41, v41, v37
    v_mul_f32 v42, v42, v37
    v_mul_f32 v43, v43, v37
    v_accvgpr_write_b32 a112, v40
    v_accvgpr_write_b32 a113, v41
    v_accvgpr_write_b32 a114, v42
    v_accvgpr_write_b32 a115, v43
    v_accvgpr_read_b32 v40, a116
    v_accvgpr_read_b32 v41, a117
    v_accvgpr_read_b32 v42, a118
    v_accvgpr_read_b32 v43, a119
    v_mul_f32 v40, v40, v37
    v_mul_f32 v41, v41, v37
    v_mul_f32 v42, v42, v37
    v_mul_f32 v43, v43, v37
    v_accvgpr_write_b32 a116, v40
    v_accvgpr_write_b32 a117, v41
    v_accvgpr_write_b32 a118, v42
    v_accvgpr_write_b32 a119, v43
    v_accvgpr_read_b32 v40, a120
    v_accvgpr_read_b32 v41, a121
    v_accvgpr_read_b32 v42, a122
    v_accvgpr_read_b32 v43, a123
    v_mul_f32 v40, v40, v37
    v_mul_f32 v41, v41, v37
    v_mul_f32 v42, v42, v37
    v_mul_f32 v43, v43, v37
    v_accvgpr_write_b32 a120, v40
    v_accvgpr_write_b32 a121, v41
    v_accvgpr_write_b32 a122, v42
    v_accvgpr_write_b32 a123, v43
    v_accvgpr_read_b32 v40, a124
    v_accvgpr_read_b32 v41, a125
    v_accvgpr_read_b32 v42, a126
    v_accvgpr_read_b32 v43, a127
    v_mul_f32 v40, v40, v37
    v_mul_f32 v41, v41, v37
    v_mul_f32 v42, v42, v37
    v_mul_f32 v43, v43, v37
    v_accvgpr_write_b32 a124, v40
    v_accvgpr_write_b32 a125, v41
    v_accvgpr_write_b32 a126, v42
    v_accvgpr_write_b32 a127, v43
    s_nop 1
    s_branch L_attn_back2
L_attn_rare3:
    s_cmp_eq_u32 s30, 15
    s_cbranch_scc1 L_attn_back3
    s_nop 15
    v_mov_b32 v40, v35
    s_nop 1
    v_permlane32_swap_b32 v40, v35
    s_nop 1
    v_max3_f32 v40, v40, v35, 0
    v_sub_f32 v37, 0, v40
    v_exp_f32 v37, v37
    v_sub_f32 v48, v48, v40
    v_sub_f32 v80, v80, v40
    v_sub_f32 v49, v49, v40
    v_sub_f32 v81, v81, v40
    v_sub_f32 v50, v50, v40
    v_sub_f32 v82, v82, v40
    v_sub_f32 v51, v51, v40
    v_sub_f32 v83, v83, v40
    v_sub_f32 v52, v52, v40
    v_sub_f32 v84, v84, v40
    v_sub_f32 v53, v53, v40
    v_sub_f32 v85, v85, v40
    v_sub_f32 v54, v54, v40
    v_sub_f32 v86, v86, v40
    v_sub_f32 v55, v55, v40
    v_sub_f32 v87, v87, v40
    v_sub_f32 v56, v56, v40
    v_sub_f32 v88, v88, v40
    v_sub_f32 v57, v57, v40
    v_sub_f32 v89, v89, v40
    v_sub_f32 v58, v58, v40
    v_sub_f32 v90, v90, v40
    v_sub_f32 v59, v59, v40
    v_sub_f32 v91, v91, v40
    v_sub_f32 v60, v60, v40
    v_sub_f32 v92, v92, v40
    v_sub_f32 v61, v61, v40
    v_sub_f32 v93, v93, v40
    v_sub_f32 v62, v62, v40
    v_sub_f32 v94, v94, v40
    v_sub_f32 v63, v63, v40
    v_sub_f32 v95, v95, v40
    v_mul_f32 v34, v34, v37
    v_accvgpr_read_b32 v40, a0
    v_accvgpr_read_b32 v41, a1
    v_accvgpr_read_b32 v42, a2
    v_accvgpr_read_b32 v43, a3
    v_mul_f32 v40, v40, v37
    v_mul_f32 v41, v41, v37
    v_mul_f32 v42, v42, v37
    v_mul_f32 v43, v43, v37
    v_accvgpr_write_b32 a0, v40
    v_accvgpr_write_b32 a1, v41
    v_accvgpr_write_b32 a2, v42
    v_accvgpr_write_b32 a3, v43
    v_accvgpr_read_b32 v40, a4
    v_accvgpr_read_b32 v41, a5
    v_accvgpr_read_b32 v42, a6
    v_accvgpr_read_b32 v43, a7
    v_mul_f32 v40, v40, v37
    v_mul_f32 v41, v41, v37
    v_mul_f32 v42, v42, v37
    v_mul_f32 v43, v43, v37
    v_accvgpr_write_b32 a4, v40
    v_accvgpr_write_b32 a5, v41
    v_accvgpr_write_b32 a6, v42
    v_accvgpr_write_b32 a7, v43
    v_accvgpr_read_b32 v40, a8
    v_accvgpr_read_b32 v41, a9
    v_accvgpr_read_b32 v42, a10
    v_accvgpr_read_b32 v43, a11
    v_mul_f32 v40, v40, v37
    v_mul_f32 v41, v41, v37
    v_mul_f32 v42, v42, v37
    v_mul_f32 v43, v43, v37
    v_accvgpr_write_b32 a8, v40
    v_accvgpr_write_b32 a9, v41
    v_accvgpr_write_b32 a10, v42
    v_accvgpr_write_b32 a11, v43
    v_accvgpr_read_b32 v40, a12
    v_accvgpr_read_b32 v41, a13
    v_accvgpr_read_b32 v42, a14
    v_accvgpr_read_b32 v43, a15
    v_mul_f32 v40, v40, v37
    v_mul_f32 v41, v41, v37
    v_mul_f32 v42, v42, v37
    v_mul_f32 v43, v43, v37
    v_accvgpr_write_b32 a12, v40
    v_accvgpr_write_b32 a13, v41
    v_accvgpr_write_b32 a14, v42
    v_accvgpr_write_b32 a15, v43
    v_accvgpr_read_b32 v40, a16
    v_accvgpr_read_b32 v41, a17
    v_accvgpr_read_b32 v42, a18
    v_accvgpr_read_b32 v43, a19
    v_mul_f32 v40, v40, v37
    v_mul_f32 v41, v41, v37
    v_mul_f32 v42, v42, v37
    v_mul_f32 v43, v43, v37
    v_accvgpr_write_b32 a16, v40
    v_accvgpr_write_b32 a17, v41
    v_accvgpr_write_b32 a18, v42
    v_accvgpr_write_b32 a19, v43
    v_accvgpr_read_b32 v40, a20
    v_accvgpr_read_b32 v41, a21
    v_accvgpr_read_b32 v42, a22
    v_accvgpr_read_b32 v43, a23
    v_mul_f32 v40, v40, v37
    v_mul_f32 v41, v41, v37
    v_mul_f32 v42, v42, v37
    v_mul_f32 v43, v43, v37
    v_accvgpr_write_b32 a20, v40
    v_accvgpr_write_b32 a21, v41
    v_accvgpr_write_b32 a22, v42
    v_accvgpr_write_b32 a23, v43
    v_accvgpr_read_b32 v40, a24
    v_accvgpr_read_b32 v41, a25
    v_accvgpr_read_b32 v42, a26
    v_accvgpr_read_b32 v43, a27
    v_mul_f32 v40, v40, v37
    v_mul_f32 v41, v41, v37
    v_mul_f32 v42, v42, v37
    v_mul_f32 v43, v43, v37
    v_accvgpr_write_b32 a24, v40
    v_accvgpr_write_b32 a25, v41
    v_accvgpr_write_b32 a26, v42
    v_accvgpr_write_b32 a27, v43
    v_accvgpr_read_b32 v40, a28
    v_accvgpr_read_b32 v41, a29
    v_accvgpr_read_b32 v42, a30
    v_accvgpr_read_b32 v43, a31
    v_mul_f32 v40, v40, v37
    v_mul_f32 v41, v41, v37
    v_mul_f32 v42, v42, v37
    v_mul_f32 v43, v43, v37
    v_accvgpr_write_b32 a28, v40
    v_accvgpr_write_b32 a29, v41
    v_accvgpr_write_b32 a30, v42
    v_accvgpr_write_b32 a31, v43
    v_accvgpr_read_b32 v40, a32
    v_accvgpr_read_b32 v41, a33
    v_accvgpr_read_b32 v42, a34
    v_accvgpr_read_b32 v43, a35
    v_mul_f32 v40, v40, v37
    v_mul_f32 v41, v41, v37
    v_mul_f32 v42, v42, v37
    v_mul_f32 v43, v43, v37
    v_accvgpr_write_b32 a32, v40
    v_accvgpr_write_b32 a33, v41
    v_accvgpr_write_b32 a34, v42
    v_accvgpr_write_b32 a35, v43
    v_accvgpr_read_b32 v40, a36
    v_accvgpr_read_b32 v41, a37
    v_accvgpr_read_b32 v42, a38
    v_accvgpr_read_b32 v43, a39
    v_mul_f32 v40, v40, v37
    v_mul_f32 v41, v41, v37
    v_mul_f32 v42, v42, v37
    v_mul_f32 v43, v43, v37
    v_accvgpr_write_b32 a36, v40
    v_accvgpr_write_b32 a37, v41
    v_accvgpr_write_b32 a38, v42
    v_accvgpr_write_b32 a39, v43
    v_accvgpr_read_b32 v40, a40
    v_accvgpr_read_b32 v41, a41
    v_accvgpr_read_b32 v42, a42
    v_accvgpr_read_b32 v43, a43
    v_mul_f32 v40, v40, v37
    v_mul_f32 v41, v41, v37
    v_mul_f32 v42, v42, v37
    v_mul_f32 v43, v43, v37
    v_accvgpr_write_b32 a40, v40
    v_accvgpr_write_b32 a41, v41
    v_accvgpr_write_b32 a42, v42
    v_accvgpr_write_b32 a43, v43
    v_accvgpr_read_b32 v40, a44
    v_accvgpr_read_b32 v41, a45
    v_accvgpr_read_b32 v42, a46
    v_accvgpr_read_b32 v43, a47
    v_mul_f32 v40, v40, v37
    v_mul_f32 v41, v41, v37
    v_mul_f32 v42, v42, v37
    v_mul_f32 v43, v43, v37
    v_accvgpr_write_b32 a44, v40
    v_accvgpr_write_b32 a45, v41
    v_accvgpr_write_b32 a46, v42
    v_accvgpr_write_b32 a47, v43
    v_accvgpr_read_b32 v40, a48
    v_accvgpr_read_b32 v41, a49
    v_accvgpr_read_b32 v42, a50
    v_accvgpr_read_b32 v43, a51
    v_mul_f32 v40, v40, v37
    v_mul_f32 v41, v41, v37
    v_mul_f32 v42, v42, v37
    v_mul_f32 v43, v43, v37
    v_accvgpr_write_b32 a48, v40
    v_accvgpr_write_b32 a49, v41
    v_accvgpr_write_b32 a50, v42
    v_accvgpr_write_b32 a51, v43
    v_accvgpr_read_b32 v40, a52
    v_accvgpr_read_b32 v41, a53
    v_accvgpr_read_b32 v42, a54
    v_accvgpr_read_b32 v43, a55
    v_mul_f32 v40, v40, v37
    v_mul_f32 v41, v41, v37
    v_mul_f32 v42, v42, v37
    v_mul_f32 v43, v43, v37
    v_accvgpr_write_b32 a52, v40
    v_accvgpr_write_b32 a53, v41
    v_accvgpr_write_b32 a54, v42
    v_accvgpr_write_b32 a55, v43
    v_accvgpr_read_b32 v40, a56
    v_accvgpr_read_b32 v41, a57
    v_accvgpr_read_b32 v42, a58
    v_accvgpr_read_b32 v43, a59
    v_mul_f32 v40, v40, v37
    v_mul_f32 v41, v41, v37
    v_mul_f32 v42, v42, v37
    v_mul_f32 v43, v43, v37
    v_accvgpr_write_b32 a56, v40
    v_accvgpr_write_b32 a57, v41
    v_accvgpr_write_b32 a58, v42
    v_accvgpr_write_b32 a59, v43
    v_accvgpr_read_b32 v40, a60
    v_accvgpr_read_b32 v41, a61
    v_accvgpr_read_b32 v42, a62
    v_accvgpr_read_b32 v43, a63
    v_mul_f32 v40, v40, v37
    v_mul_f32 v41, v41, v37
    v_mul_f32 v42, v42, v37
    v_mul_f32 v43, v43, v37
    v_accvgpr_write_b32 a60, v40
    v_accvgpr_write_b32 a61, v41
    v_accvgpr_write_b32 a62, v42
    v_accvgpr_write_b32 a63, v43
    v_accvgpr_read_b32 v40, a64
    v_accvgpr_read_b32 v41, a65
    v_accvgpr_read_b32 v42, a66
    v_accvgpr_read_b32 v43, a67
    v_mul_f32 v40, v40, v37
    v_mul_f32 v41, v41, v37
    v_mul_f32 v42, v42, v37
    v_mul_f32 v43, v43, v37
    v_accvgpr_write_b32 a64, v40
    v_accvgpr_write_b32 a65, v41
    v_accvgpr_write_b32 a66, v42
    v_accvgpr_write_b32 a67, v43
    v_accvgpr_read_b32 v40, a68
    v_accvgpr_read_b32 v41, a69
    v_accvgpr_read_b32 v42, a70
    v_accvgpr_read_b32 v43, a71
    v_mul_f32 v40, v40, v37
    v_mul_f32 v41, v41, v37
    v_mul_f32 v42, v42, v37
    v_mul_f32 v43, v43, v37
    v_accvgpr_write_b32 a68, v40
    v_accvgpr_write_b32 a69, v41
    v_accvgpr_write_b32 a70, v42
    v_accvgpr_write_b32 a71, v43
    v_accvgpr_read_b32 v40, a72
    v_accvgpr_read_b32 v41, a73
    v_accvgpr_read_b32 v42, a74
    v_accvgpr_read_b32 v43, a75
    v_mul_f32 v40, v40, v37
    v_mul_f32 v41, v41, v37
    v_mul_f32 v42, v42, v37
    v_mul_f32 v43, v43, v37
    v_accvgpr_write_b32 a72, v40
    v_accvgpr_write_b32 a73, v41
    v_accvgpr_write_b32 a74, v42
    v_accvgpr_write_b32 a75, v43
    v_accvgpr_read_b32 v40, a76
    v_accvgpr_read_b32 v41, a77
    v_accvgpr_read_b32 v42, a78
    v_accvgpr_read_b32 v43, a79
    v_mul_f32 v40, v40, v37
    v_mul_f32 v41, v41, v37
    v_mul_f32 v42, v42, v37
    v_mul_f32 v43, v43, v37
    v_accvgpr_write_b32 a76, v40
    v_accvgpr_write_b32 a77, v41
    v_accvgpr_write_b32 a78, v42
    v_accvgpr_write_b32 a79, v43
    v_accvgpr_read_b32 v40, a80
    v_accvgpr_read_b32 v41, a81
    v_accvgpr_read_b32 v42, a82
    v_accvgpr_read_b32 v43, a83
    v_mul_f32 v40, v40, v37
    v_mul_f32 v41, v41, v37
    v_mul_f32 v42, v42, v37
    v_mul_f32 v43, v43, v37
    v_accvgpr_write_b32 a80, v40
    v_accvgpr_write_b32 a81, v41
    v_accvgpr_write_b32 a82, v42
    v_accvgpr_write_b32 a83, v43
    v_accvgpr_read_b32 v40, a84
    v_accvgpr_read_b32 v41, a85
    v_accvgpr_read_b32 v42, a86
    v_accvgpr_read_b32 v43, a87
    v_mul_f32 v40, v40, v37
    v_mul_f32 v41, v41, v37
    v_mul_f32 v42, v42, v37
    v_mul_f32 v43, v43, v37
    v_accvgpr_write_b32 a84, v40
    v_accvgpr_write_b32 a85, v41
    v_accvgpr_write_b32 a86, v42
    v_accvgpr_write_b32 a87, v43
    v_accvgpr_read_b32 v40, a88
    v_accvgpr_read_b32 v41, a89
    v_accvgpr_read_b32 v42, a90
    v_accvgpr_read_b32 v43, a91
    v_mul_f32 v40, v40, v37
    v_mul_f32 v41, v41, v37
    v_mul_f32 v42, v42, v37
    v_mul_f32 v43, v43, v37
    v_accvgpr_write_b32 a88, v40
    v_accvgpr_write_b32 a89, v41
    v_accvgpr_write_b32 a90, v42
    v_accvgpr_write_b32 a91, v43
    v_accvgpr_read_b32 v40, a92
    v_accvgpr_read_b32 v41, a93
    v_accvgpr_read_b32 v42, a94
    v_accvgpr_read_b32 v43, a95
    v_mul_f32 v40, v40, v37
    v_mul_f32 v41, v41, v37
    v_mul_f32 v42, v42, v37
    v_mul_f32 v43, v43, v37
    v_accvgpr_write_b32 a92, v40
    v_accvgpr_write_b32 a93, v41
    v_accvgpr_write_b32 a94, v42
    v_accvgpr_write_b32 a95, v43
    v_accvgpr_read_b32 v40, a96
    v_accvgpr_read_b32 v41, a97
    v_accvgpr_read_b32 v42, a98
    v_accvgpr_read_b32 v43, a99
    v_mul_f32 v40, v40, v37
    v_mul_f32 v41, v41, v37
    v_mul_f32 v42, v42, v37
    v_mul_f32 v43, v43, v37
    v_accvgpr_write_b32 a96, v40
    v_accvgpr_write_b32 a97, v41
    v_accvgpr_write_b32 a98, v42
    v_accvgpr_write_b32 a99, v43
    v_accvgpr_read_b32 v40, a100
    v_accvgpr_read_b32 v41, a101
    v_accvgpr_read_b32 v42, a102
    v_accvgpr_read_b32 v43, a103
    v_mul_f32 v40, v40, v37
    v_mul_f32 v41, v41, v37
    v_mul_f32 v42, v42, v37
    v_mul_f32 v43, v43, v37
    v_accvgpr_write_b32 a100, v40
    v_accvgpr_write_b32 a101, v41
    v_accvgpr_write_b32 a102, v42
    v_accvgpr_write_b32 a103, v43
    v_accvgpr_read_b32 v40, a104
    v_accvgpr_read_b32 v41, a105
    v_accvgpr_read_b32 v42, a106
    v_accvgpr_read_b32 v43, a107
    v_mul_f32 v40, v40, v37
    v_mul_f32 v41, v41, v37
    v_mul_f32 v42, v42, v37
    v_mul_f32 v43, v43, v37
    v_accvgpr_write_b32 a104, v40
    v_accvgpr_write_b32 a105, v41
    v_accvgpr_write_b32 a106, v42
    v_accvgpr_write_b32 a107, v43
    v_accvgpr_read_b32 v40, a108
    v_accvgpr_read_b32 v41, a109
    v_accvgpr_read_b32 v42, a110
    v_accvgpr_read_b32 v43, a111
    v_mul_f32 v40, v40, v37
    v_mul_f32 v41, v41, v37
    v_mul_f32 v42, v42, v37
    v_mul_f32 v43, v43, v37
    v_accvgpr_write_b32 a108, v40
    v_accvgpr_write_b32 a109, v41
    v_accvgpr_write_b32 a110, v42
    v_accvgpr_write_b32 a111, v43
    v_accvgpr_read_b32 v40, a112
    v_accvgpr_read_b32 v41, a113
    v_accvgpr_read_b32 v42, a114
    v_accvgpr_read_b32 v43, a115
    v_mul_f32 v40, v40, v37
    v_mul_f32 v41, v41, v37
    v_mul_f32 v42, v42, v37
    v_mul_f32 v43, v43, v37
    v_accvgpr_write_b32 a112, v40
    v_accvgpr_write_b32 a113, v41
    v_accvgpr_write_b32 a114, v42
    v_accvgpr_write_b32 a115, v43
    v_accvgpr_read_b32 v40, a116
    v_accvgpr_read_b32 v41, a117
    v_accvgpr_read_b32 v42, a118
    v_accvgpr_read_b32 v43, a119
    v_mul_f32 v40, v40, v37
    v_mul_f32 v41, v41, v37
    v_mul_f32 v42, v42, v37
    v_mul_f32 v43, v43, v37
    v_accvgpr_write_b32 a116, v40
    v_accvgpr_write_b32 a117, v41
    v_accvgpr_write_b32 a118, v42
    v_accvgpr_write_b32 a119, v43
    v_accvgpr_read_b32 v40, a120
    v_accvgpr_read_b32 v41, a121
    v_accvgpr_read_b32 v42, a122
    v_accvgpr_read_b32 v43, a123
    v_mul_f32 v40, v40, v37
    v_mul_f32 v41, v41, v37
    v_mul_f32 v42, v42, v37
    v_mul_f32 v43, v43, v37
    v_accvgpr_write_b32 a120, v40
    v_accvgpr_write_b32 a121, v41
    v_accvgpr_write_b32 a122, v42
    v_accvgpr_write_b32 a123, v43
    v_accvgpr_read_b32 v40, a124
    v_accvgpr_read_b32 v41, a125
    v_accvgpr_read_b32 v42, a126
    v_accvgpr_read_b32 v43, a127
    v_mul_f32 v40, v40, v37
    v_mul_f32 v41, v41, v37
    v_mul_f32 v42, v42, v37
    v_mul_f32 v43, v43, v37
    v_accvgpr_write_b32 a124, v40
    v_accvgpr_write_b32 a125, v41
    v_accvgpr_write_b32 a126, v42
    v_accvgpr_write_b32 a127, v43
    s_nop 1
    s_branch L_attn_back3
.globl fin_kernel
.p2align 8
.type fin_kernel,@function
fin_kernel:
    s_cmp_ge_u32 s2, 224
    s_cbranch_scc1 L_k4_end
    s_load_dwordx2 s[40:41], s[0:1], 72
    s_load_dwordx2 s[42:43], s[0:1], 0
    s_load_dwordx2 s[44:45], s[0:1], 80
    s_load_dwordx2 s[46:47], s[0:1], 96
    v_lshrrev_b32 v1, 6, v0
    s_and_b32 s50, s2, 7
    s_lshr_b32 s51, s2, 3
    v_readfirstlane_b32 s24, v1
    s_mul_i32 s52, s51, 37
    s_lshr_b32 s52, s52, 8
    s_mul_i32 s53, s52, 7
    s_sub_u32 s53, s51, s53
    s_lshl_b32 s54, s50, 2
    s_add_u32 s54, s54, s52
    s_lshl_b32 s25, s54, 6
    s_lshl_b32 s26, s53, 6
    s_waitcnt lgkmcnt(0)
    s_add_u32 s4, s46, 33554432
    s_addc_u32 s5, s47, 0
    s_mov_b32 s6, 3670016
    s_mov_b32 s7, 0x20000
    s_add_u32 s8, s40, 0
    s_addc_u32 s9, s41, 0
    s_mov_b32 s10, 802816
    s_mov_b32 s11, 0x20000
    s_add_u32 s12, s46, 50331648
    s_addc_u32 s13, s47, 0
    s_mov_b32 s14, 29360128
    s_mov_b32 s15, 0x20000
    s_add_u32 s16, s44, 0
    s_addc_u32 s17, s45, 0
    s_mov_b32 s18, 1835008
    s_mov_b32 s19, 0x20000
    s_add_u32 s20, s42, 0
    s_addc_u32 s21, s43, 0
    s_mov_b32 s22, 1835008
    s_mov_b32 s23, 0x20000
    v_and_b32 v241, 31, v0
    s_lshr_b32 s55, s24, 1
    s_lshl_b32 s55, s55, 5
    s_add_u32 s55, s55, s25
    v_add_u32 v241, s55, v241
    s_movk_i32 s55, 896
    v_mul_lo_u32 v240, v241, s55
    s_and_b32 s55, s24, 1
    s_lshl_b32 s55, s55, 5
    s_add_u32 s55, s55, s26
    s_lshl_b32 s55, s55, 1
    v_add_u32 v240, s55, v240
    v_bfe_u32 v241, v0, 5, 1
    v_lshl_add_u32 v240, v241, 4, v240
    s_lshr_b32 s55, s25, 5
    s_lshr_b32 s56, s24, 1
    s_add_u32 s55, s55, s56
    s_mul_i32 s55, s55, 28672
    s_lshr_b32 s56, s26, 5
    s_and_b32 s57, s24, 1
    s_add_u32 s56, s56, s57
    s_lshl_b32 s56, s56, 11
    s_add_u32 s55, s55, s56
    v_and_b32 v242, 63, v0
    v_lshlrev_b32 v242, 4, v242
    v_add_u32 v242, s55, v242
    v_and_b32 v2, 63, v0
    v_lshrrev_b32 v10, 5, v2
    s_lshr_b32 s67, s24, 1
    s_and_b32 s68, s24, 1
    s_mul_i32 s60, s24, 16
    v_lshrrev_b32 v3, 3, v2
    v_and_b32 v4, 7, v2
    s_mov_b32 s61, 1792
    v_add_u32 v5, 0, v3
    v_add_u32 v5, s60, v5
    v_bfe_u32 v6, v5, 1, 3
    v_xor_b32 v6, v6, v4
    v_lshlrev_b32 v6, 4, v6
    v_add_u32 v5, s25, v5
    v_mul_lo_u32 v5, v5, s61
    v_add_u32 v11, v5, v6
    v_add_u32 v5, 8, v3
    v_add_u32 v5, s60, v5
    v_bfe_u32 v6, v5, 1, 3
    v_xor_b32 v6, v6, v4
    v_lshlrev_b32 v6, 4, v6
    v_add_u32 v5, s25, v5
    v_mul_lo_u32 v5, v5, s61
    v_add_u32 v12, v5, v6
    s_mul_i32 s60, s24, 16
    v_lshrrev_b32 v3, 3, v2
    v_and_b32 v4, 7, v2
    s_mov_b32 s61, 896
    s_lshl_b32 s62, s26, 1
    v_add_u32 v5, 0, v3
    v_add_u32 v5, s60, v5
    v_bfe_u32 v6, v5, 1, 1
    v_lshlrev_b32 v6, 2, v6
    v_xor_b32 v6, v6, v4
    v_lshlrev_b32 v6, 4, v6
    v_mul_lo_u32 v5, v5, s61
    v_add3_u32 v13, v5, v6, s62
    v_add_u32 v5, 8, v3
    v_add_u32 v5, s60, v5
    v_bfe_u32 v6, v5, 1, 1
    v_lshlrev_b32 v6, 2, v6
    v_xor_b32 v6, v6, v4
    v_lshlrev_b32 v6, 4, v6
    v_mul_lo_u32 v5, v5, s61
    v_add3_u32 v14, v5, v6, s62
    s_mul_i32 s64, s24, 2048
    s_mul_i32 s65, s24, 2048
    s_add_u32 s65, s65, 8192
    v_and_b32 v3, 31, v2
    s_mul_i32 s60, s67, 32
    v_add_u32 v3, s60, v3
    v_bfe_u32 v4, v3, 1, 3
    v_add_u32 v5, 0, v10
    v_xor_b32 v5, v5, v4
    v_lshlrev_b32 v5, 4, v5
    v_mul_u32_u24 v6, 128, v3
    v_add_u32 v15, v5, v6
    v_add_u32 v5, 2, v10
    v_xor_b32 v5, v5, v4
    v_lshlrev_b32 v5, 4, v5
    v_mul_u32_u24 v6, 128, v3
    v_add_u32 v16, v5, v6
    v_add_u32 v5, 4, v10
    v_xor_b32 v5, v5, v4
    v_lshlrev_b32 v5, 4, v5
    v_mul_u32_u24 v6, 128, v3
    v_add_u32 v17, v5, v6
    v_add_u32 v5, 6, v10
    v_xor_b32 v5, v5, v4
    v_lshlrev_b32 v5, 4, v5
    v_mul_u32_u24 v6, 128, v3
    v_add_u32 v18, v5, v6
    v_bfe_u32 v7, v2, 2, 2
    v_bfe_u32 v8, v2, 4, 1
    v_and_b32 v9, 3, v2
    v_bfe_u32 v4, v7, 1, 1
    v_lshlrev_b32 v4, 2, v4
    s_mul_i32 s60, s68, 1
    v_lshrrev_b32 v5, 1, v9
    v_lshl_add_u32 v5, v8, 1, v5
    s_add_u32 s61, s60, 0
    s_lshl_b32 s61, s61, 2
    v_add_u32 v5, s61, v5
    v_xor_b32 v5, v5, v4
    v_lshlrev_b32 v5, 4, v5
    v_and_b32 v6, 1, v9
    v_lshl_add_u32 v5, v6, 3, v5
    v_lshl_add_u32 v6, v10, 3, v7
    v_mul_u32_u24 v6, 128, v6
    v_add_u32 v5, v5, v6
    v_add_u32 v19, 8192, v5
    s_mov_b32 s62, 0
    s_mov_b32 s63, 0
    s_add_u32 m0, s64, 0
    s_nop 0
    buffer_load_dwordx4 v11, s[4:7], s62 offen lds
    s_add_u32 m0, s64, 1024
    s_nop 0
    buffer_load_dwordx4 v12, s[4:7], s62 offen lds
    s_add_u32 m0, s65, 0
    s_nop 0
    buffer_load_dwordx4 v13, s[8:11], s63 offen lds
    s_add_u32 m0, s65, 1024
    s_nop 0
    buffer_load_dwordx4 v14, s[8:11], s63 offen lds
    s_add_u32 s62, s62, 128
    s_add_u32 s63, s63, 57344
    s_add_u32 m0, s64, 16384
    s_nop 0
    buffer_load_dwordx4 v11, s[4:7], s62 offen lds
    s_add_u32 m0, s64, 17408
    s_nop 0
    buffer_load_dwordx4 v12, s[4:7], s62 offen lds
    s_add_u32 m0, s65, 16384
    s_nop 0
    buffer_load_dwordx4 v13, s[8:11], s63 offen lds
    s_add_u32 m0, s65, 17408
    s_nop 0
    buffer_load_dwordx4 v14, s[8:11], s63 offen lds
    s_add_u32 s62, s62, 128
    s_add_u32 s63, s63, 57344
    s_add_u32 m0, s64, 32768
    s_nop 0
    buffer_load_dwordx4 v11, s[4:7], s62 offen lds
    s_add_u32 m0, s64, 33792
    s_nop 0
    buffer_load_dwordx4 v12, s[4:7], s62 offen lds
    s_add_u32 m0, s65, 32768
    s_nop 0
    buffer_load_dwordx4 v13, s[8:11], s63 offen lds
    s_add_u32 m0, s65, 33792
    s_nop 0
    buffer_load_dwordx4 v14, s[8:11], s63 offen lds
    s_add_u32 s62, s62, 128
    s_add_u32 s63, s63, 57344
    s_add_u32 m0, s64, 49152
    s_nop 0
    buffer_load_dwordx4 v11, s[4:7], s62 offen lds
    s_add_u32 m0, s64, 50176
    s_nop 0
    buffer_load_dwordx4 v12, s[4:7], s62 offen lds
    s_add_u32 m0, s65, 49152
    s_nop 0
    buffer_load_dwordx4 v13, s[8:11], s63 offen lds
    s_add_u32 m0, s65, 50176
    s_nop 0
    buffer_load_dwordx4 v14, s[8:11], s63 offen lds
    s_add_u32 s62, s62, 128
    s_add_u32 s63, s63, 57344
    v_mov_b32 v96, 0
    v_mov_b32 v97, 0
    v_mov_b32 v98, 0
    v_mov_b32 v99, 0
    v_mov_b32 v100, 0
    v_mov_b32 v101, 0
    v_mov_b32 v102, 0
    v_mov_b32 v103, 0
    v_mov_b32 v104, 0
    v_mov_b32 v105, 0
    v_mov_b32 v106, 0
    v_mov_b32 v107, 0
    v_mov_b32 v108, 0
    v_mov_b32 v109, 0
    v_mov_b32 v110, 0
    v_mov_b32 v111, 0
    s_waitcnt vmcnt(12)
    s_barrier
    ds_read_b128 v[20:23], v15 offset:0
    ds_read_b64_tr_b16 v[36:37], v19 offset:0
    ds_read_b64_tr_b16 v[38:39], v19 offset:512
    ds_read_b128 v[24:27], v16 offset:0
    ds_read_b64_tr_b16 v[40:41], v19 offset:2048
    ds_read_b64_tr_b16 v[42:43], v19 offset:2560
    ds_read_b128 v[28:31], v17 offset:0
    ds_read_b64_tr_b16 v[44:45], v19 offset:4096
    ds_read_b64_tr_b16 v[46:47], v19 offset:4608
    ds_read_b128 v[32:35], v18 offset:0
    ds_read_b64_tr_b16 v[48:49], v19 offset:6144
    ds_read_b64_tr_b16 v[50:51], v19 offset:6656
    s_waitcnt vmcnt(8) lgkmcnt(0)
    s_barrier
    v_mfma_f32_32x32x16_bf16 v[96:111], v[36:39], v[20:23], v[96:111]
    ds_read_b128 v[52:55], v15 offset:16384
    ds_read_b64_tr_b16 v[68:69], v19 offset:16384
    ds_read_b64_tr_b16 v[70:71], v19 offset:16896
    s_add_u32 m0, s64, 0
    s_nop 0
    buffer_load_dwordx4 v11, s[4:7], s62 offen lds
    buffer_load_dwordx4 v[244:247], v240, s[20:23], 0 offen offset:0
    buffer_load_dwordx4 v[248:251], v240, s[20:23], 0 offen offset:32
    v_mfma_f32_32x32x16_bf16 v[96:111], v[40:43], v[24:27], v[96:111]
    ds_read_b128 v[56:59], v16 offset:16384
    ds_read_b64_tr_b16 v[72:73], v19 offset:18432
    ds_read_b64_tr_b16 v[74:75], v19 offset:18944
    s_add_u32 m0, s64, 1024
    s_nop 0
    buffer_load_dwordx4 v12, s[4:7], s62 offen lds
    s_mov_b32 s58, 0
    buffer_load_dwordx4 v[112:115], v242, s[12:15], s58 offen offset:0
    buffer_load_dwordx4 v[116:119], v242, s[12:15], s58 offen offset:1024
    v_mfma_f32_32x32x16_bf16 v[96:111], v[44:47], v[28:31], v[96:111]
    ds_read_b128 v[60:63], v17 offset:16384
    ds_read_b64_tr_b16 v[76:77], v19 offset:20480
    ds_read_b64_tr_b16 v[78:79], v19 offset:20992
    s_add_u32 m0, s65, 0
    s_nop 0
    buffer_load_dwordx4 v13, s[8:11], s63 offen lds
    s_mov_b32 s58, 1835008
    buffer_load_dwordx4 v[120:123], v242, s[12:15], s58 offen offset:0
    buffer_load_dwordx4 v[124:127], v242, s[12:15], s58 offen offset:1024
    v_mfma_f32_32x32x16_bf16 v[96:111], v[48:51], v[32:35], v[96:111]
    ds_read_b128 v[64:67], v18 offset:16384
    ds_read_b64_tr_b16 v[80:81], v19 offset:22528
    ds_read_b64_tr_b16 v[82:83], v19 offset:23040
    s_add_u32 m0, s65, 1024
    s_nop 0
    buffer_load_dwordx4 v14, s[8:11], s63 offen lds
    s_mov_b32 s58, 3670016
    buffer_load_dwordx4 v[128:131], v242, s[12:15], s58 offen offset:0
    buffer_load_dwordx4 v[132:135], v242, s[12:15], s58 offen offset:1024
    s_add_u32 s62, s62, 128
    s_add_u32 s63, s63, 57344
    s_waitcnt vmcnt(8) lgkmcnt(0)
    s_barrier
    v_mfma_f32_32x32x16_bf16 v[96:111], v[68:71], v[52:55], v[96:111]
    ds_read_b128 v[20:23], v15 offset:32768
    ds_read_b64_tr_b16 v[36:37], v19 offset:32768
    ds_read_b64_tr_b16 v[38:39], v19 offset:33280
    s_add_u32 m0, s64, 16384
    s_nop 0
    buffer_load_dwordx4 v11, s[4:7], s62 offen lds
    s_mov_b32 s58, 5505024
    buffer_load_dwordx4 v[136:139], v242, s[12:15], s58 offen offset:0
    buffer_load_dwordx4 v[140:143], v242, s[12:15], s58 offen offset:1024
    v_mfma_f32_32x32x16_bf16 v[96:111], v[72:75], v[56:59], v[96:111]
    ds_read_b128 v[24:27], v16 offset:32768
    ds_read_b64_tr_b16 v[40:41], v19 offset:34816
    ds_read_b64_tr_b16 v[42:43], v19 offset:35328
    s_add_u32 m0, s64, 17408
    s_nop 0
    buffer_load_dwordx4 v12, s[4:7], s62 offen lds
    s_mov_b32 s58, 7340032
    buffer_load_dwordx4 v[144:147], v242, s[12:15], s58 offen offset:0
    buffer_load_dwordx4 v[148:151], v242, s[12:15], s58 offen offset:1024
    v_mfma_f32_32x32x16_bf16 v[96:111], v[76:79], v[60:63], v[96:111]
    ds_read_b128 v[28:31], v17 offset:32768
    ds_read_b64_tr_b16 v[44:45], v19 offset:36864
    ds_read_b64_tr_b16 v[46:47], v19 offset:37376
    s_add_u32 m0, s65, 16384
    s_nop 0
    buffer_load_dwordx4 v13, s[8:11], s63 offen lds
    s_mov_b32 s58, 9175040
    buffer_load_dwordx4 v[152:155], v242, s[12:15], s58 offen offset:0
    buffer_load_dwordx4 v[156:159], v242, s[12:15], s58 offen offset:1024
    v_mfma_f32_32x32x16_bf16 v[96:111], v[80:83], v[64:67], v[96:111]
    ds_read_b128 v[32:35], v18 offset:32768
    ds_read_b64_tr_b16 v[48:49], v19 offset:38912
    ds_read_b64_tr_b16 v[50:51], v19 offset:39424
    s_add_u32 m0, s65, 17408
    s_nop 0
    buffer_load_dwordx4 v14, s[8:11], s63 offen lds
    s_mov_b32 s58, 11010048
    buffer_load_dwordx4 v[160:163], v242, s[12:15], s58 offen offset:0
    buffer_load_dwordx4 v[164:167], v242, s[12:15], s58 offen offset:1024
    s_add_u32 s62, s62, 128
    s_add_u32 s63, s63, 57344
    s_waitcnt vmcnt(8) lgkmcnt(0)
    s_barrier
    v_mfma_f32_32x32x16_bf16 v[96:111], v[36:39], v[20:23], v[96:111]
    ds_read_b128 v[52:55], v15 offset:49152
    ds_read_b64_tr_b16 v[68:69], v19 offset:49152
    ds_read_b64_tr_b16 v[70:71], v19 offset:49664
    s_add_u32 m0, s64, 32768
    s_nop 0
    buffer_load_dwordx4 v11, s[4:7], s62 offen lds
    s_mov_b32 s58, 12845056
    buffer_load_dwordx4 v[168:171], v242, s[12:15], s58 offen offset:0
    buffer_load_dwordx4 v[172:175], v242, s[12:15], s58 offen offset:1024
    v_mfma_f32_32x32x16_bf16 v[96:111], v[40:43], v[24:27], v[96:111]
    ds_read_b128 v[56:59], v16 offset:49152
    ds_read_b64_tr_b16 v[72:73], v19 offset:51200
    ds_read_b64_tr_b16 v[74:75], v19 offset:51712
    s_add_u32 m0, s64, 33792
    s_nop 0
    buffer_load_dwordx4 v12, s[4:7], s62 offen lds
    s_mov_b32 s58, 14680064
    buffer_load_dwordx4 v[176:179], v242, s[12:15], s58 offen offset:0
    buffer_load_dwordx4 v[180:183], v242, s[12:15], s58 offen offset:1024
    v_mfma_f32_32x32x16_bf16 v[96:111], v[44:47], v[28:31], v[96:111]
    ds_read_b128 v[60:63], v17 offset:49152
    ds_read_b64_tr_b16 v[76:77], v19 offset:53248
    ds_read_b64_tr_b16 v[78:79], v19 offset:53760
    s_add_u32 m0, s65, 32768
    s_nop 0
    buffer_load_dwordx4 v13, s[8:11], s63 offen lds
    s_mov_b32 s58, 16515072
    buffer_load_dwordx4 v[184:187], v242, s[12:15], s58 offen offset:0
    buffer_load_dwordx4 v[188:191], v242, s[12:15], s58 offen offset:1024
    v_mfma_f32_32x32x16_bf16 v[96:111], v[48:51], v[32:35], v[96:111]
    ds_read_b128 v[64:67], v18 offset:49152
    ds_read_b64_tr_b16 v[80:81], v19 offset:55296
    ds_read_b64_tr_b16 v[82:83], v19 offset:55808
    s_add_u32 m0, s65, 33792
    s_nop 0
    buffer_load_dwordx4 v14, s[8:11], s63 offen lds
    s_mov_b32 s58, 18350080
    buffer_load_dwordx4 v[192:195], v242, s[12:15], s58 offen offset:0
    buffer_load_dwordx4 v[196:199], v242, s[12:15], s58 offen offset:1024
    s_add_u32 s62, s62, 128
    s_add_u32 s63, s63, 57344
    s_waitcnt vmcnt(8) lgkmcnt(0)
    s_barrier
    v_mfma_f32_32x32x16_bf16 v[96:111], v[68:71], v[52:55], v[96:111]
    ds_read_b128 v[20:23], v15 offset:0
    ds_read_b64_tr_b16 v[36:37], v19 offset:0
    ds_read_b64_tr_b16 v[38:39], v19 offset:512
    s_add_u32 m0, s64, 49152
    s_nop 0
    buffer_load_dwordx4 v11, s[4:7], s62 offen lds
    s_mov_b32 s58, 20185088
    buffer_load_dwordx4 v[200:203], v242, s[12:15], s58 offen offset:0
    buffer_load_dwordx4 v[204:207], v242, s[12:15], s58 offen offset:1024
    v_mfma_f32_32x32x16_bf16 v[96:111], v[72:75], v[56:59], v[96:111]
    ds_read_b128 v[24:27], v16 offset:0
    ds_read_b64_tr_b16 v[40:41], v19 offset:2048
    ds_read_b64_tr_b16 v[42:43], v19 offset:2560
    s_add_u32 m0, s64, 50176
    s_nop 0
    buffer_load_dwordx4 v12, s[4:7], s62 offen lds
    s_mov_b32 s58, 22020096
    buffer_load_dwordx4 v[208:211], v242, s[12:15], s58 offen offset:0
    buffer_load_dwordx4 v[212:215], v242, s[12:15], s58 offen offset:1024
    v_mfma_f32_32x32x16_bf16 v[96:111], v[76:79], v[60:63], v[96:111]
    ds_read_b128 v[28:31], v17 offset:0
    ds_read_b64_tr_b16 v[44:45], v19 offset:4096
    ds_read_b64_tr_b16 v[46:47], v19 offset:4608
    s_add_u32 m0, s65, 49152
    s_nop 0
    buffer_load_dwordx4 v13, s[8:11], s63 offen lds
    s_mov_b32 s58, 23855104
    buffer_load_dwordx4 v[216:219], v242, s[12:15], s58 offen offset:0
    buffer_load_dwordx4 v[220:223], v242, s[12:15], s58 offen offset:1024
    v_mfma_f32_32x32x16_bf16 v[96:111], v[80:83], v[64:67], v[96:111]
    ds_read_b128 v[32:35], v18 offset:0
    ds_read_b64_tr_b16 v[48:49], v19 offset:6144
    ds_read_b64_tr_b16 v[50:51], v19 offset:6656
    s_add_u32 m0, s65, 50176
    s_nop 0
    buffer_load_dwordx4 v14, s[8:11], s63 offen lds
    s_mov_b32 s58, 25690112
    buffer_load_dwordx4 v[224:227], v242, s[12:15], s58 offen offset:0
    buffer_load_dwordx4 v[228:231], v242, s[12:15], s58 offen offset:1024
    s_add_u32 s62, s62, 128
    s_add_u32 s63, s63, 57344
    s_waitcnt vmcnt(8) lgkmcnt(0)
    s_barrier
    v_mfma_f32_32x32x16_bf16 v[96:111], v[36:39], v[20:23], v[96:111]
    ds_read_b128 v[52:55], v15 offset:16384
    ds_read_b64_tr_b16 v[68:69], v19 offset:16384
    ds_read_b64_tr_b16 v[70:71], v19 offset:16896
    s_add_u32 m0, s64, 0
    s_nop 0
    buffer_load_dwordx4 v11, s[4:7], s62 offen lds
    s_mov_b32 s58, 27525120
    buffer_load_dwordx4 v[232:235], v242, s[12:15], s58 offen offset:0
    buffer_load_dwordx4 v[236:239], v242, s[12:15], s58 offen offset:1024
    v_mfma_f32_32x32x16_bf16 v[96:111], v[40:43], v[24:27], v[96:111]
    ds_read_b128 v[56:59], v16 offset:16384
    ds_read_b64_tr_b16 v[72:73], v19 offset:18432
    ds_read_b64_tr_b16 v[74:75], v19 offset:18944
    s_add_u32 m0, s64, 1024
    s_nop 0
    buffer_load_dwordx4 v12, s[4:7], s62 offen lds
    v_mfma_f32_32x32x16_bf16 v[96:111], v[44:47], v[28:31], v[96:111]
    ds_read_b128 v[60:63], v17 offset:16384
    ds_read_b64_tr_b16 v[76:77], v19 offset:20480
    ds_read_b64_tr_b16 v[78:79], v19 offset:20992
    s_add_u32 m0, s65, 0
    s_nop 0
    buffer_load_dwordx4 v13, s[8:11], s63 offen lds
    v_mfma_f32_32x32x16_bf16 v[96:111], v[48:51], v[32:35], v[96:111]
    ds_read_b128 v[64:67], v18 offset:16384
    ds_read_b64_tr_b16 v[80:81], v19 offset:22528
    ds_read_b64_tr_b16 v[82:83], v19 offset:23040
    s_add_u32 m0, s65, 1024
    s_nop 0
    buffer_load_dwordx4 v14, s[8:11], s63 offen lds
    s_add_u32 s62, s62, 128
    s_add_u32 s63, s63, 57344
    s_waitcnt vmcnt(8) lgkmcnt(0)
    s_barrier
    v_mfma_f32_32x32x16_bf16 v[96:111], v[68:71], v[52:55], v[96:111]
    ds_read_b128 v[20:23], v15 offset:32768
    ds_read_b64_tr_b16 v[36:37], v19 offset:32768
    ds_read_b64_tr_b16 v[38:39], v19 offset:33280
    s_add_u32 m0, s64, 16384
    s_nop 0
    buffer_load_dwordx4 v11, s[4:7], s62 offen lds
    v_mfma_f32_32x32x16_bf16 v[96:111], v[72:75], v[56:59], v[96:111]
    ds_read_b128 v[24:27], v16 offset:32768
    ds_read_b64_tr_b16 v[40:41], v19 offset:34816
    ds_read_b64_tr_b16 v[42:43], v19 offset:35328
    s_add_u32 m0, s64, 17408
    s_nop 0
    buffer_load_dwordx4 v12, s[4:7], s62 offen lds
    v_mfma_f32_32x32x16_bf16 v[96:111], v[76:79], v[60:63], v[96:111]
    ds_read_b128 v[28:31], v17 offset:32768
    ds_read_b64_tr_b16 v[44:45], v19 offset:36864
    ds_read_b64_tr_b16 v[46:47], v19 offset:37376
    s_add_u32 m0, s65, 16384
    s_nop 0
    buffer_load_dwordx4 v13, s[8:11], s63 offen lds
    v_mfma_f32_32x32x16_bf16 v[96:111], v[80:83], v[64:67], v[96:111]
    ds_read_b128 v[32:35], v18 offset:32768
    ds_read_b64_tr_b16 v[48:49], v19 offset:38912
    ds_read_b64_tr_b16 v[50:51], v19 offset:39424
    s_add_u32 m0, s65, 17408
    s_nop 0
    buffer_load_dwordx4 v14, s[8:11], s63 offen lds
    s_add_u32 s62, s62, 128
    s_add_u32 s63, s63, 57344
    s_waitcnt vmcnt(8) lgkmcnt(0)
    s_barrier
    v_mfma_f32_32x32x16_bf16 v[96:111], v[36:39], v[20:23], v[96:111]
    ds_read_b128 v[52:55], v15 offset:49152
    ds_read_b64_tr_b16 v[68:69], v19 offset:49152
    ds_read_b64_tr_b16 v[70:71], v19 offset:49664
    s_add_u32 m0, s64, 32768
    s_nop 0
    buffer_load_dwordx4 v11, s[4:7], s62 offen lds
    v_mfma_f32_32x32x16_bf16 v[96:111], v[40:43], v[24:27], v[96:111]
    ds_read_b128 v[56:59], v16 offset:49152
    ds_read_b64_tr_b16 v[72:73], v19 offset:51200
    ds_read_b64_tr_b16 v[74:75], v19 offset:51712
    s_add_u32 m0, s64, 33792
    s_nop 0
    buffer_load_dwordx4 v12, s[4:7], s62 offen lds
    v_mfma_f32_32x32x16_bf16 v[96:111], v[44:47], v[28:31], v[96:111]
    ds_read_b128 v[60:63], v17 offset:49152
    ds_read_b64_tr_b16 v[76:77], v19 offset:53248
    ds_read_b64_tr_b16 v[78:79], v19 offset:53760
    s_add_u32 m0, s65, 32768
    s_nop 0
    buffer_load_dwordx4 v13, s[8:11], s63 offen lds
    s_mov_b32 s59, 0xffff0000
    v_lshlrev_b32 v243, 16, v112
    v_lshlrev_b32 v252, 16, v120
    v_and_b32 v253, s59, v112
    v_and_b32 v120, s59, v120
    v_add_f32 v112, v243, v252
    v_add_f32 v120, v253, v120
    v_lshlrev_b32 v243, 16, v113
    v_lshlrev_b32 v252, 16, v121
    v_and_b32 v253, s59, v113
    v_and_b32 v121, s59, v121
    v_add_f32 v113, v243, v252
    v_add_f32 v121, v253, v121
    v_lshlrev_b32 v243, 16, v114
    v_lshlrev_b32 v252, 16, v122
    v_and_b32 v253, s59, v114
    v_and_b32 v122, s59, v122
    v_mfma_f32_32x32x16_bf16 v[96:111], v[48:51], v[32:35], v[96:111]
    ds_read_b128 v[64:67], v18 offset:49152
    ds_read_b64_tr_b16 v[80:81], v19 offset:55296
    ds_read_b64_tr_b16 v[82:83], v19 offset:55808
    s_add_u32 m0, s65, 33792
    s_nop 0
    buffer_load_dwordx4 v14, s[8:11], s63 offen lds
    v_add_f32 v114, v243, v252
    v_add_f32 v122, v253, v122
    v_lshlrev_b32 v243, 16, v115
    v_lshlrev_b32 v252, 16, v123
    v_and_b32 v253, s59, v115
    v_and_b32 v123, s59, v123
    v_add_f32 v115, v243, v252
    v_add_f32 v123, v253, v123
    v_lshlrev_b32 v243, 16, v116
    v_lshlrev_b32 v252, 16, v124
    v_and_b32 v253, s59, v116
    v_and_b32 v124, s59, v124
    v_add_f32 v116, v243, v252
    v_add_f32 v124, v253, v124
    v_lshlrev_b32 v243, 16, v117
    v_lshlrev_b32 v252, 16, v125
    v_and_b32 v253, s59, v117
    s_add_u32 s62, s62, 128
    s_add_u32 s63, s63, 57344
    s_waitcnt vmcnt(8) lgkmcnt(0)
    s_barrier
    v_mfma_f32_32x32x16_bf16 v[96:111], v[68:71], v[52:55], v[96:111]
    ds_read_b128 v[20:23], v15 offset:0
    ds_read_b64_tr_b16 v[36:37], v19 offset:0
    ds_read_b64_tr_b16 v[38:39], v19 offset:512
    s_add_u32 m0, s64, 49152
    s_nop 0
    buffer_load_dwordx4 v11, s[4:7], s62 offen lds
    v_and_b32 v125, s59, v125
    v_add_f32 v117, v243, v252
    v_add_f32 v125, v253, v125
    v_lshlrev_b32 v243, 16, v118
    v_lshlrev_b32 v252, 16, v126
    v_and_b32 v253, s59, v118
    v_and_b32 v126, s59, v126
    v_add_f32 v118, v243, v252
    v_add_f32 v126, v253, v126
    v_lshlrev_b32 v243, 16, v119
    v_lshlrev_b32 v252, 16, v127
    v_and_b32 v253, s59, v119
    v_and_b32 v127, s59, v127
    v_add_f32 v119, v243, v252
    v_add_f32 v127, v253, v127
    v_lshlrev_b32 v243, 16, v128
    v_and_b32 v128, s59, v128
    v_mfma_f32_32x32x16_bf16 v[96:111], v[72:75], v[56:59], v[96:111]
    ds_read_b128 v[24:27], v16 offset:0
    ds_read_b64_tr_b16 v[40:41], v19 offset:2048
    ds_read_b64_tr_b16 v[42:43], v19 offset:2560
    s_add_u32 m0, s64, 50176
    s_nop 0
    buffer_load_dwordx4 v12, s[4:7], s62 offen lds
    v_add_f32 v112, v112, v243
    v_add_f32 v120, v120, v128
    v_lshlrev_b32 v243, 16, v129
    v_and_b32 v129, s59, v129
    v_add_f32 v113, v113, v243
    v_add_f32 v121, v121, v129
    v_lshlrev_b32 v243, 16, v130
    v_and_b32 v130, s59, v130
    v_add_f32 v114, v114, v243
    v_add_f32 v122, v122, v130
    v_lshlrev_b32 v243, 16, v131
    v_and_b32 v131, s59, v131
    v_add_f32 v115, v115, v243
    v_add_f32 v123, v123, v131
    v_lshlrev_b32 v243, 16, v132
    v_and_b32 v132, s59, v132
    v_add_f32 v116, v116, v243
    v_mfma_f32_32x32x16_bf16 v[96:111], v[76:79], v[60:63], v[96:111]
    ds_read_b128 v[28:31], v17 offset:0
    ds_read_b64_tr_b16 v[44:45], v19 offset:4096
    ds_read_b64_tr_b16 v[46:47], v19 offset:4608
    s_add_u32 m0, s65, 49152
    s_nop 0
    buffer_load_dwordx4 v13, s[8:11], s63 offen lds
    v_add_f32 v124, v124, v132
    v_lshlrev_b32 v243, 16, v133
    v_and_b32 v133, s59, v133
    v_add_f32 v117, v117, v243
    v_add_f32 v125, v125, v133
    v_lshlrev_b32 v243, 16, v134
    v_and_b32 v134, s59, v134
    v_add_f32 v118, v118, v243
    v_add_f32 v126, v126, v134
    v_lshlrev_b32 v243, 16, v135
    v_and_b32 v135, s59, v135
    v_add_f32 v119, v119, v243
    v_add_f32 v127, v127, v135
    v_lshlrev_b32 v243, 16, v136
    v_and_b32 v136, s59, v136
    v_add_f32 v112, v112, v243
    v_add_f32 v120, v120, v136
    v_mfma_f32_32x32x16_bf16 v[96:111], v[80:83], v[64:67], v[96:111]
    ds_read_b128 v[32:35], v18 offset:0
    ds_read_b64_tr_b16 v[48:49], v19 offset:6144
    ds_read_b64_tr_b16 v[50:51], v19 offset:6656
    s_add_u32 m0, s65, 50176
    s_nop 0
    buffer_load_dwordx4 v14, s[8:11], s63 offen lds
    v_lshlrev_b32 v243, 16, v137
    v_and_b32 v137, s59, v137
    v_add_f32 v113, v113, v243
    v_add_f32 v121, v121, v137
    v_lshlrev_b32 v243, 16, v138
    v_and_b32 v138, s59, v138
    v_add_f32 v114, v114, v243
    v_add_f32 v122, v122, v138
    v_lshlrev_b32 v243, 16, v139
    v_and_b32 v139, s59, v139
    v_add_f32 v115, v115, v243
    v_add_f32 v123, v123, v139
    v_lshlrev_b32 v243, 16, v140
    v_and_b32 v140, s59, v140
    v_add_f32 v116, v116, v243
    v_add_f32 v124, v124, v140
    v_lshlrev_b32 v243, 16, v141
    s_add_u32 s62, s62, 128
    s_add_u32 s63, s63, 57344
    s_waitcnt vmcnt(8) lgkmcnt(0)
    s_barrier
    v_mfma_f32_32x32x16_bf16 v[96:111], v[36:39], v[20:23], v[96:111]
    ds_read_b128 v[52:55], v15 offset:16384
    ds_read_b64_tr_b16 v[68:69], v19 offset:16384
    ds_read_b64_tr_b16 v[70:71], v19 offset:16896
    s_add_u32 m0, s64, 0
    s_nop 0
    buffer_load_dwordx4 v11, s[4:7], s62 offen lds
    v_and_b32 v141, s59, v141
    v_add_f32 v117, v117, v243
    v_add_f32 v125, v125, v141
    v_lshlrev_b32 v243, 16, v142
    v_and_b32 v142, s59, v142
    v_add_f32 v118, v118, v243
    v_add_f32 v126, v126, v142
    v_lshlrev_b32 v243, 16, v143
    v_and_b32 v143, s59, v143
    v_add_f32 v119, v119, v243
    v_add_f32 v127, v127, v143
    v_lshlrev_b32 v243, 16, v144
    v_and_b32 v144, s59, v144
    v_add_f32 v112, v112, v243
    v_add_f32 v120, v120, v144
    v_lshlrev_b32 v243, 16, v145
    v_and_b32 v145, s59, v145
    v_mfma_f32_32x32x16_bf16 v[96:111], v[40:43], v[24:27], v[96:111]
    ds_read_b128 v[56:59], v16 offset:16384
    ds_read_b64_tr_b16 v[72:73], v19 offset:18432
    ds_read_b64_tr_b16 v[74:75], v19 offset:18944
    s_add_u32 m0, s64, 1024
    s_nop 0
    buffer_load_dwordx4 v12, s[4:7], s62 offen lds
    v_add_f32 v113, v113, v243
    v_add_f32 v121, v121, v145
    v_lshlrev_b32 v243, 16, v146
    v_and_b32 v146, s59, v146
    v_add_f32 v114, v114, v243
    v_add_f32 v122, v122, v146
    v_lshlrev_b32 v243, 16, v147
    v_and_b32 v147, s59, v147
    v_add_f32 v115, v115, v243
    v_add_f32 v123, v123, v147
    v_lshlrev_b32 v243, 16, v148
    v_and_b32 v148, s59, v148
    v_add_f32 v116, v116, v243
    v_add_f32 v124, v124, v148
    v_lshlrev_b32 v243, 16, v149
    v_and_b32 v149, s59, v149
    v_add_f32 v117, v117, v243
    v_mfma_f32_32x32x16_bf16 v[96:111], v[44:47], v[28:31], v[96:111]
    ds_read_b128 v[60:63], v17 offset:16384
    ds_read_b64_tr_b16 v[76:77], v19 offset:20480
    ds_read_b64_tr_b16 v[78:79], v19 offset:20992
    s_add_u32 m0, s65, 0
    s_nop 0
    buffer_load_dwordx4 v13, s[8:11], s63 offen lds
    v_add_f32 v125, v125, v149
    v_lshlrev_b32 v243, 16, v150
    v_and_b32 v150, s59, v150
    v_add_f32 v118, v118, v243
    v_add_f32 v126, v126, v150
    v_lshlrev_b32 v243, 16, v151
    v_and_b32 v151, s59, v151
    v_add_f32 v119, v119, v243
    v_add_f32 v127, v127, v151
    v_lshlrev_b32 v243, 16, v152
    v_and_b32 v152, s59, v152
    v_add_f32 v112, v112, v243
    v_add_f32 v120, v120, v152
    v_lshlrev_b32 v243, 16, v153
    v_and_b32 v153, s59, v153
    v_add_f32 v113, v113, v243
    v_add_f32 v121, v121, v153
    v_mfma_f32_32x32x16_bf16 v[96:111], v[48:51], v[32:35], v[96:111]
    ds_read_b128 v[64:67], v18 offset:16384
    ds_read_b64_tr_b16 v[80:81], v19 offset:22528
    ds_read_b64_tr_b16 v[82:83], v19 offset:23040
    s_add_u32 m0, s65, 1024
    s_nop 0
    buffer_load_dwordx4 v14, s[8:11], s63 offen lds
    v_lshlrev_b32 v243, 16, v154
    v_and_b32 v154, s59, v154
    v_add_f32 v114, v114, v243
    v_add_f32 v122, v122, v154
    v_lshlrev_b32 v243, 16, v155
    v_and_b32 v155, s59, v155
    v_add_f32 v115, v115, v243
    v_add_f32 v123, v123, v155
    v_lshlrev_b32 v243, 16, v156
    v_and_b32 v156, s59, v156
    v_add_f32 v116, v116, v243
    v_add_f32 v124, v124, v156
    v_lshlrev_b32 v243, 16, v157
    v_and_b32 v157, s59, v157
    v_add_f32 v117, v117, v243
    v_add_f32 v125, v125, v157
    v_lshlrev_b32 v243, 16, v158
    s_add_u32 s62, s62, 128
    s_add_u32 s63, s63, 57344
    s_waitcnt vmcnt(8) lgkmcnt(0)
    s_barrier
    v_mfma_f32_32x32x16_bf16 v[96:111], v[68:71], v[52:55], v[96:111]
    ds_read_b128 v[20:23], v15 offset:32768
    ds_read_b64_tr_b16 v[36:37], v19 offset:32768
    ds_read_b64_tr_b16 v[38:39], v19 offset:33280
    s_add_u32 m0, s64, 16384
    s_nop 0
    buffer_load_dwordx4 v11, s[4:7], s62 offen lds
    v_and_b32 v158, s59, v158
    v_add_f32 v118, v118, v243
    v_add_f32 v126, v126, v158
    v_lshlrev_b32 v243, 16, v159
    v_and_b32 v159, s59, v159
    v_add_f32 v119, v119, v243
    v_add_f32 v127, v127, v159
    v_lshlrev_b32 v243, 16, v160
    v_and_b32 v160, s59, v160
    v_add_f32 v112, v112, v243
    v_add_f32 v120, v120, v160
    v_lshlrev_b32 v243, 16, v161
    v_and_b32 v161, s59, v161
    v_add_f32 v113, v113, v243
    v_add_f32 v121, v121, v161
    v_lshlrev_b32 v243, 16, v162
    v_and_b32 v162, s59, v162
    v_mfma_f32_32x32x16_bf16 v[96:111], v[72:75], v[56:59], v[96:111]
    ds_read_b128 v[24:27], v16 offset:32768
    ds_read_b64_tr_b16 v[40:41], v19 offset:34816
    ds_read_b64_tr_b16 v[42:43], v19 offset:35328
    s_add_u32 m0, s64, 17408
    s_nop 0
    buffer_load_dwordx4 v12, s[4:7], s62 offen lds
    v_add_f32 v114, v114, v243
    v_add_f32 v122, v122, v162
    v_lshlrev_b32 v243, 16, v163
    v_and_b32 v163, s59, v163
    v_add_f32 v115, v115, v243
    v_add_f32 v123, v123, v163
    v_lshlrev_b32 v243, 16, v164
    v_and_b32 v164, s59, v164
    v_add_f32 v116, v116, v243
    v_add_f32 v124, v124, v164
    v_lshlrev_b32 v243, 16, v165
    v_and_b32 v165, s59, v165
    v_add_f32 v117, v117, v243
    v_add_f32 v125, v125, v165
    v_lshlrev_b32 v243, 16, v166
    v_and_b32 v166, s59, v166
    v_add_f32 v118, v118, v243
    v_mfma_f32_32x32x16_bf16 v[96:111], v[76:79], v[60:63], v[96:111]
    ds_read_b128 v[28:31], v17 offset:32768
    ds_read_b64_tr_b16 v[44:45], v19 offset:36864
    ds_read_b64_tr_b16 v[46:47], v19 offset:37376
    s_add_u32 m0, s65, 16384
    s_nop 0
    buffer_load_dwordx4 v13, s[8:11], s63 offen lds
    v_add_f32 v126, v126, v166
    v_lshlrev_b32 v243, 16, v167
    v_and_b32 v167, s59, v167
    v_add_f32 v119, v119, v243
    v_add_f32 v127, v127, v167
    v_lshlrev_b32 v243, 16, v168
    v_and_b32 v168, s59, v168
    v_add_f32 v112, v112, v243
    v_add_f32 v120, v120, v168
    v_lshlrev_b32 v243, 16, v169
    v_and_b32 v169, s59, v169
    v_add_f32 v113, v113, v243
    v_add_f32 v121, v121, v169
    v_lshlrev_b32 v243, 16, v170
    v_and_b32 v170, s59, v170
    v_add_f32 v114, v114, v243
    v_add_f32 v122, v122, v170
    v_mfma_f32_32x32x16_bf16 v[96:111], v[80:83], v[64:67], v[96:111]
    ds_read_b128 v[32:35], v18 offset:32768
    ds_read_b64_tr_b16 v[48:49], v19 offset:38912
    ds_read_b64_tr_b16 v[50:51], v19 offset:39424
    s_add_u32 m0, s65, 17408
    s_nop 0
    buffer_load_dwordx4 v14, s[8:11], s63 offen lds
    v_lshlrev_b32 v243, 16, v171
    v_and_b32 v171, s59, v171
    v_add_f32 v115, v115, v243
    v_add_f32 v123, v123, v171
    v_lshlrev_b32 v243, 16, v172
    v_and_b32 v172, s59, v172
    v_add_f32 v116, v116, v243
    v_add_f32 v124, v124, v172
    v_lshlrev_b32 v243, 16, v173
    v_and_b32 v173, s59, v173
    v_add_f32 v117, v117, v243
    v_add_f32 v125, v125, v173
    v_lshlrev_b32 v243, 16, v174
    v_and_b32 v174, s59, v174
    v_add_f32 v118, v118, v243
    v_add_f32 v126, v126, v174
    v_lshlrev_b32 v243, 16, v175
    s_add_u32 s62, s62, 128
    s_add_u32 s63, s63, 57344
    s_waitcnt vmcnt(8) lgkmcnt(0)
    s_barrier
    v_mfma_f32_32x32x16_bf16 v[96:111], v[36:39], v[20:23], v[96:111]
    ds_read_b128 v[52:55], v15 offset:49152
    ds_read_b64_tr_b16 v[68:69], v19 offset:49152
    ds_read_b64_tr_b16 v[70:71], v19 offset:49664
    s_add_u32 m0, s64, 32768
    s_nop 0
    buffer_load_dwordx4 v11, s[4:7], s62 offen lds
    v_and_b32 v175, s59, v175
    v_add_f32 v119, v119, v243
    v_add_f32 v127, v127, v175
    v_lshlrev_b32 v243, 16, v176
    v_and_b32 v176, s59, v176
    v_add_f32 v112, v112, v243
    v_add_f32 v120, v120, v176
    v_lshlrev_b32 v243, 16, v177
    v_and_b32 v177, s59, v177
    v_add_f32 v113, v113, v243
    v_add_f32 v121, v121, v177
    v_lshlrev_b32 v243, 16, v178
    v_and_b32 v178, s59, v178
    v_add_f32 v114, v114, v243
    v_add_f32 v122, v122, v178
    v_lshlrev_b32 v243, 16, v179
    v_and_b32 v179, s59, v179
    v_mfma_f32_32x32x16_bf16 v[96:111], v[40:43], v[24:27], v[96:111]
    ds_read_b128 v[56:59], v16 offset:49152
    ds_read_b64_tr_b16 v[72:73], v19 offset:51200
    ds_read_b64_tr_b16 v[74:75], v19 offset:51712
    s_add_u32 m0, s64, 33792
    s_nop 0
    buffer_load_dwordx4 v12, s[4:7], s62 offen lds
    v_add_f32 v115, v115, v243
    v_add_f32 v123, v123, v179
    v_lshlrev_b32 v243, 16, v180
    v_and_b32 v180, s59, v180
    v_add_f32 v116, v116, v243
    v_add_f32 v124, v124, v180
    v_lshlrev_b32 v243, 16, v181
    v_and_b32 v181, s59, v181
    v_add_f32 v117, v117, v243
    v_add_f32 v125, v125, v181
    v_lshlrev_b32 v243, 16, v182
    v_and_b32 v182, s59, v182
    v_add_f32 v118, v118, v243
    v_add_f32 v126, v126, v182
    v_lshlrev_b32 v243, 16, v183
    v_and_b32 v183, s59, v183
    v_add_f32 v119, v119, v243
    v_mfma_f32_32x32x16_bf16 v[96:111], v[44:47], v[28:31], v[96:111]
    ds_read_b128 v[60:63], v17 offset:49152
    ds_read_b64_tr_b16 v[76:77], v19 offset:53248
    ds_read_b64_tr_b16 v[78:79], v19 offset:53760
    s_add_u32 m0, s65, 32768
    s_nop 0
    buffer_load_dwordx4 v13, s[8:11], s63 offen lds
    v_add_f32 v127, v127, v183
    v_lshlrev_b32 v243, 16, v184
    v_and_b32 v184, s59, v184
    v_add_f32 v112, v112, v243
    v_add_f32 v120, v120, v184
    v_lshlrev_b32 v243, 16, v185
    v_and_b32 v185, s59, v185
    v_add_f32 v113, v113, v243
    v_add_f32 v121, v121, v185
    v_lshlrev_b32 v243, 16, v186
    v_and_b32 v186, s59, v186
    v_add_f32 v114, v114, v243
    v_add_f32 v122, v122, v186
    v_lshlrev_b32 v243, 16, v187
    v_and_b32 v187, s59, v187
    v_add_f32 v115, v115, v243
    v_add_f32 v123, v123, v187
    v_mfma_f32_32x32x16_bf16 v[96:111], v[48:51], v[32:35], v[96:111]
    ds_read_b128 v[64:67], v18 offset:49152
    ds_read_b64_tr_b16 v[80:81], v19 offset:55296
    ds_read_b64_tr_b16 v[82:83], v19 offset:55808
    s_add_u32 m0, s65, 33792
    s_nop 0
    buffer_load_dwordx4 v14, s[8:11], s63 offen lds
    v_lshlrev_b32 v243, 16, v188
    v_and_b32 v188, s59, v188
    v_add_f32 v116, v116, v243
    v_add_f32 v124, v124, v188
    v_lshlrev_b32 v243, 16, v189
    v_and_b32 v189, s59, v189
    v_add_f32 v117, v117, v243
    v_add_f32 v125, v125, v189
    v_lshlrev_b32 v243, 16, v190
    v_and_b32 v190, s59, v190
    v_add_f32 v118, v118, v243
    v_add_f32 v126, v126, v190
    v_lshlrev_b32 v243, 16, v191
    v_and_b32 v191, s59, v191
    v_add_f32 v119, v119, v243
    v_add_f32 v127, v127, v191
    v_lshlrev_b32 v243, 16, v192
    s_add_u32 s62, s62, 128
    s_add_u32 s63, s63, 57344
    s_waitcnt vmcnt(8) lgkmcnt(0)
    s_barrier
    v_mfma_f32_32x32x16_bf16 v[96:111], v[68:71], v[52:55], v[96:111]
    ds_read_b128 v[20:23], v15 offset:0
    ds_read_b64_tr_b16 v[36:37], v19 offset:0
    ds_read_b64_tr_b16 v[38:39], v19 offset:512
    s_add_u32 m0, s64, 49152
    s_nop 0
    buffer_load_dwordx4 v11, s[4:7], s62 offen lds
    v_and_b32 v192, s59, v192
    v_add_f32 v112, v112, v243
    v_add_f32 v120, v120, v192
    v_lshlrev_b32 v243, 16, v193
    v_and_b32 v193, s59, v193
    v_add_f32 v113, v113, v243
    v_add_f32 v121, v121, v193
    v_lshlrev_b32 v243, 16, v194
    v_and_b32 v194, s59, v194
    v_add_f32 v114, v114, v243
    v_add_f32 v122, v122, v194
    v_lshlrev_b32 v243, 16, v195
    v_and_b32 v195, s59, v195
    v_add_f32 v115, v115, v243
    v_add_f32 v123, v123, v195
    v_lshlrev_b32 v243, 16, v196
    v_and_b32 v196, s59, v196
    v_mfma_f32_32x32x16_bf16 v[96:111], v[72:75], v[56:59], v[96:111]
    ds_read_b128 v[24:27], v16 offset:0
    ds_read_b64_tr_b16 v[40:41], v19 offset:2048
    ds_read_b64_tr_b16 v[42:43], v19 offset:2560
    s_add_u32 m0, s64, 50176
    s_nop 0
    buffer_load_dwordx4 v12, s[4:7], s62 offen lds
    v_add_f32 v116, v116, v243
    v_add_f32 v124, v124, v196
    v_lshlrev_b32 v243, 16, v197
    v_and_b32 v197, s59, v197
    v_add_f32 v117, v117, v243
    v_add_f32 v125, v125, v197
    v_lshlrev_b32 v243, 16, v198
    v_and_b32 v198, s59, v198
    v_add_f32 v118, v118, v243
    v_add_f32 v126, v126, v198
    v_lshlrev_b32 v243, 16, v199
    v_and_b32 v199, s59, v199
    v_add_f32 v119, v119, v243
    v_add_f32 v127, v127, v199
    v_lshlrev_b32 v243, 16, v200
    v_and_b32 v200, s59, v200
    v_add_f32 v112, v112, v243
    v_mfma_f32_32x32x16_bf16 v[96:111], v[76:79], v[60:63], v[96:111]
    ds_read_b128 v[28:31], v17 offset:0
    ds_read_b64_tr_b16 v[44:45], v19 offset:4096
    ds_read_b64_tr_b16 v[46:47], v19 offset:4608
    s_add_u32 m0, s65, 49152
    s_nop 0
    buffer_load_dwordx4 v13, s[8:11], s63 offen lds
    v_add_f32 v120, v120, v200
    v_lshlrev_b32 v243, 16, v201
    v_and_b32 v201, s59, v201
    v_add_f32 v113, v113, v243
    v_add_f32 v121, v121, v201
    v_lshlrev_b32 v243, 16, v202
    v_and_b32 v202, s59, v202
    v_add_f32 v114, v114, v243
    v_add_f32 v122, v122, v202
    v_lshlrev_b32 v243, 16, v203
    v_and_b32 v203, s59, v203
    v_add_f32 v115, v115, v243
    v_add_f32 v123, v123, v203
    v_lshlrev_b32 v243, 16, v204
    v_and_b32 v204, s59, v204
    v_add_f32 v116, v116, v243
    v_add_f32 v124, v124, v204
    v_mfma_f32_32x32x16_bf16 v[96:111], v[80:83], v[64:67], v[96:111]
    ds_read_b128 v[32:35], v18 offset:0
    ds_read_b64_tr_b16 v[48:49], v19 offset:6144
    ds_read_b64_tr_b16 v[50:51], v19 offset:6656
    s_add_u32 m0, s65, 50176
    s_nop 0
    buffer_load_dwordx4 v14, s[8:11], s63 offen lds
    v_lshlrev_b32 v243, 16, v205
    v_and_b32 v205, s59, v205
    v_add_f32 v117, v117, v243
    v_add_f32 v125, v125, v205
    v_lshlrev_b32 v243, 16, v206
    v_and_b32 v206, s59, v206
    v_add_f32 v118, v118, v243
    v_add_f32 v126, v126, v206
    v_lshlrev_b32 v243, 16, v207
    v_and_b32 v207, s59, v207
    v_add_f32 v119, v119, v243
    v_add_f32 v127, v127, v207
    v_lshlrev_b32 v243, 16, v208
    v_and_b32 v208, s59, v208
    v_add_f32 v112, v112, v243
    v_add_f32 v120, v120, v208
    v_lshlrev_b32 v243, 16, v209
    s_add_u32 s62, s62, 128
    s_add_u32 s63, s63, 57344
    s_waitcnt vmcnt(8) lgkmcnt(0)
    s_barrier
    v_mfma_f32_32x32x16_bf16 v[96:111], v[36:39], v[20:23], v[96:111]
    ds_read_b128 v[52:55], v15 offset:16384
    ds_read_b64_tr_b16 v[68:69], v19 offset:16384
    ds_read_b64_tr_b16 v[70:71], v19 offset:16896
    s_add_u32 m0, s64, 0
    s_nop 0
    buffer_load_dwordx4 v11, s[4:7], s62 offen lds
    v_and_b32 v209, s59, v209
    v_add_f32 v113, v113, v243
    v_add_f32 v121, v121, v209
    v_lshlrev_b32 v243, 16, v210
    v_and_b32 v210, s59, v210
    v_add_f32 v114, v114, v243
    v_add_f32 v122, v122, v210
    v_lshlrev_b32 v243, 16, v211
    v_and_b32 v211, s59, v211
    v_add_f32 v115, v115, v243
    v_add_f32 v123, v123, v211
    v_lshlrev_b32 v243, 16, v212
    v_and_b32 v212, s59, v212
    v_add_f32 v116, v116, v243
    v_add_f32 v124, v124, v212
    v_lshlrev_b32 v243, 16, v213
    v_and_b32 v213, s59, v213
    v_mfma_f32_32x32x16_bf16 v[96:111], v[40:43], v[24:27], v[96:111]
    ds_read_b128 v[56:59], v16 offset:16384
    ds_read_b64_tr_b16 v[72:73], v19 offset:18432
    ds_read_b64_tr_b16 v[74:75], v19 offset:18944
    s_add_u32 m0, s64, 1024
    s_nop 0
    buffer_load_dwordx4 v12, s[4:7], s62 offen lds
    v_add_f32 v117, v117, v243
    v_add_f32 v125, v125, v213
    v_lshlrev_b32 v243, 16, v214
    v_and_b32 v214, s59, v214
    v_add_f32 v118, v118, v243
    v_add_f32 v126, v126, v214
    v_lshlrev_b32 v243, 16, v215
    v_and_b32 v215, s59, v215
    v_add_f32 v119, v119, v243
    v_add_f32 v127, v127, v215
    v_lshlrev_b32 v243, 16, v216
    v_and_b32 v216, s59, v216
    v_add_f32 v112, v112, v243
    v_add_f32 v120, v120, v216
    v_lshlrev_b32 v243, 16, v217
    v_and_b32 v217, s59, v217
    v_add_f32 v113, v113, v243
    v_mfma_f32_32x32x16_bf16 v[96:111], v[44:47], v[28:31], v[96:111]
    ds_read_b128 v[60:63], v17 offset:16384
    ds_read_b64_tr_b16 v[76:77], v19 offset:20480
    ds_read_b64_tr_b16 v[78:79], v19 offset:20992
    s_add_u32 m0, s65, 0
    s_nop 0
    buffer_load_dwordx4 v13, s[8:11], s63 offen lds
    v_add_f32 v121, v121, v217
    v_lshlrev_b32 v243, 16, v218
    v_and_b32 v218, s59, v218
    v_add_f32 v114, v114, v243
    v_add_f32 v122, v122, v218
    v_lshlrev_b32 v243, 16, v219
    v_and_b32 v219, s59, v219
    v_add_f32 v115, v115, v243
    v_add_f32 v123, v123, v219
    v_lshlrev_b32 v243, 16, v220
    v_and_b32 v220, s59, v220
    v_add_f32 v116, v116, v243
    v_add_f32 v124, v124, v220
    v_lshlrev_b32 v243, 16, v221
    v_and_b32 v221, s59, v221
    v_add_f32 v117, v117, v243
    v_add_f32 v125, v125, v221
    v_mfma_f32_32x32x16_bf16 v[96:111], v[48:51], v[32:35], v[96:111]
    ds_read_b128 v[64:67], v18 offset:16384
    ds_read_b64_tr_b16 v[80:81], v19 offset:22528
    ds_read_b64_tr_b16 v[82:83], v19 offset:23040
    s_add_u32 m0, s65, 1024
    s_nop 0
    buffer_load_dwordx4 v14, s[8:11], s63 offen lds
    v_lshlrev_b32 v243, 16, v222
    v_and_b32 v222, s59, v222
    v_add_f32 v118, v118, v243
    v_add_f32 v126, v126, v222
    v_lshlrev_b32 v243, 16, v223
    v_and_b32 v223, s59, v223
    v_add_f32 v119, v119, v243
    v_add_f32 v127, v127, v223
    v_lshlrev_b32 v243, 16, v224
    v_and_b32 v224, s59, v224
    v_add_f32 v112, v112, v243
    v_add_f32 v120, v120, v224
    v_lshlrev_b32 v243, 16, v225
    v_and_b32 v225, s59, v225
    v_add_f32 v113, v113, v243
    v_add_f32 v121, v121, v225
    v_lshlrev_b32 v243, 16, v226
    s_add_u32 s62, s62, 128
    s_add_u32 s63, s63, 57344
    s_waitcnt vmcnt(8) lgkmcnt(0)
    s_barrier
    v_mfma_f32_32x32x16_bf16 v[96:111], v[68:71], v[52:55], v[96:111]
    s_add_u32 m0, s64, 16384
    s_nop 0
    buffer_load_dwordx4 v11, s[4:7], s62 offen lds
    v_and_b32 v226, s59, v226
    v_add_f32 v114, v114, v243
    v_add_f32 v122, v122, v226
    v_lshlrev_b32 v243, 16, v227
    v_and_b32 v227, s59, v227
    v_add_f32 v115, v115, v243
    v_add_f32 v123, v123, v227
    v_lshlrev_b32 v243, 16, v228
    v_and_b32 v228, s59, v228
    v_add_f32 v116, v116, v243
    v_add_f32 v124, v124, v228
    v_lshlrev_b32 v243, 16, v229
    v_and_b32 v229, s59, v229
    v_add_f32 v117, v117, v243
    v_add_f32 v125, v125, v229
    v_lshlrev_b32 v243, 16, v230
    v_and_b32 v230, s59, v230
    v_mfma_f32_32x32x16_bf16 v[96:111], v[72:75], v[56:59], v[96:111]
    s_add_u32 m0, s64, 17408
    s_nop 0
    buffer_load_dwordx4 v12, s[4:7], s62 offen lds
    v_add_f32 v118, v118, v243
    v_add_f32 v126, v126, v230
    v_lshlrev_b32 v243, 16, v231
    v_and_b32 v231, s59, v231
    v_add_f32 v119, v119, v243
    v_add_f32 v127, v127, v231
    v_lshlrev_b32 v243, 16, v232
    v_and_b32 v232, s59, v232
    v_add_f32 v112, v112, v243
    v_add_f32 v120, v120, v232
    v_lshlrev_b32 v243, 16, v233
    v_and_b32 v233, s59, v233
    v_add_f32 v113, v113, v243
    v_add_f32 v121, v121, v233
    v_lshlrev_b32 v243, 16, v234
    v_and_b32 v234, s59, v234
    v_add_f32 v114, v114, v243
    v_mfma_f32_32x32x16_bf16 v[96:111], v[76:79], v[60:63], v[96:111]
    s_add_u32 m0, s65, 16384
    s_nop 0
    buffer_load_dwordx4 v13, s[8:11], s63 offen lds
    v_add_f32 v122, v122, v234
    v_lshlrev_b32 v243, 16, v235
    v_and_b32 v235, s59, v235
    v_add_f32 v115, v115, v243
    v_add_f32 v123, v123, v235
    v_lshlrev_b32 v243, 16, v236
    v_and_b32 v236, s59, v236
    v_add_f32 v116, v116, v243
    v_add_f32 v124, v124, v236
    v_lshlrev_b32 v243, 16, v237
    v_and_b32 v237, s59, v237
    v_add_f32 v117, v117, v243
    v_add_f32 v125, v125, v237
    v_lshlrev_b32 v243, 16, v238
    v_and_b32 v238, s59, v238
    v_add_f32 v118, v118, v243
    v_add_f32 v126, v126, v238
    v_mfma_f32_32x32x16_bf16 v[96:111], v[80:83], v[64:67], v[96:111]
    s_add_u32 m0, s65, 17408
    s_nop 0
    buffer_load_dwordx4 v14, s[8:11], s63 offen lds
    v_lshlrev_b32 v243, 16, v239
    v_and_b32 v239, s59, v239
    v_add_f32 v119, v119, v243
    v_add_f32 v127, v127, v239
    s_add_u32 s62, s62, 128
    s_add_u32 s63, s63, 57344
    s_waitcnt vmcnt(0) lgkmcnt(0)
    s_nop 15
    v_mov_b32 v28, v244
    v_mov_b32 v29, v245
    v_mov_b32 v30, v246
    v_mov_b32 v31, v247
    v_mov_b32 v32, v248
    v_mov_b32 v33, v249
    v_mov_b32 v34, v250
    v_mov_b32 v35, v251
    s_mov_b32 s57, 0xbfb8aa3b
    v_cvt_pk_bf16_f32 v20, v112, v120
    v_cvt_pk_bf16_f32 v21, v113, v121
    v_cvt_pk_bf16_f32 v22, v114, v122
    v_cvt_pk_bf16_f32 v23, v115, v123
    v_cvt_pk_bf16_f32 v24, v116, v124
    v_cvt_pk_bf16_f32 v25, v117, v125
    v_cvt_pk_bf16_f32 v26, v118, v126
    v_cvt_pk_bf16_f32 v27, v119, v127
    v_cvt_pk_bf16_f32 v36, v96, v97
    v_cvt_pk_bf16_f32 v37, v98, v99
    v_cvt_pk_bf16_f32 v38, v100, v101
    v_cvt_pk_bf16_f32 v39, v102, v103
    s_nop 1
    v_permlane32_swap_b32 v36, v38
    v_permlane32_swap_b32 v37, v39
    v_lshlrev_b32 v96, 16, v36
    v_mul_f32 v40, s57, v96
    v_exp_f32 v40, v40
    s_nop 0
    v_add_f32 v40, 1.0, v40
    v_rcp_f32 v40, v40
    s_nop 0
    v_mul_f32 v96, v96, v40
    v_and_b32 v97, 0xffff0000, v36
    v_mul_f32 v41, s57, v97
    v_exp_f32 v41, v41
    s_nop 0
    v_add_f32 v41, 1.0, v41
    v_rcp_f32 v41, v41
    s_nop 0
    v_mul_f32 v97, v97, v41
    v_cvt_pk_bf16_f32 v36, v96, v97
    v_lshlrev_b32 v96, 16, v36
    v_and_b32 v97, 0xffff0000, v36
    v_lshlrev_b32 v40, 16, v20
    v_and_b32 v41, 0xffff0000, v20
    v_mul_f32 v96, v96, v40
    v_mul_f32 v97, v97, v41
    v_cvt_pk_bf16_f32 v36, v96, v97
    v_lshlrev_b32 v96, 16, v36
    v_and_b32 v97, 0xffff0000, v36
    v_lshlrev_b32 v40, 16, v28
    v_and_b32 v41, 0xffff0000, v28
    v_add_f32 v96, v96, v40
    v_add_f32 v97, v97, v41
    v_cvt_pk_bf16_f32 v20, v96, v97
    v_lshlrev_b32 v98, 16, v37
    v_mul_f32 v40, s57, v98
    v_exp_f32 v40, v40
    s_nop 0
    v_add_f32 v40, 1.0, v40
    v_rcp_f32 v40, v40
    s_nop 0
    v_mul_f32 v98, v98, v40
    v_and_b32 v99, 0xffff0000, v37
    v_mul_f32 v41, s57, v99
    v_exp_f32 v41, v41
    s_nop 0
    v_add_f32 v41, 1.0, v41
    v_rcp_f32 v41, v41
    s_nop 0
    v_mul_f32 v99, v99, v41
    v_cvt_pk_bf16_f32 v37, v98, v99
    v_lshlrev_b32 v98, 16, v37
    v_and_b32 v99, 0xffff0000, v37
    v_lshlrev_b32 v40, 16, v21
    v_and_b32 v41, 0xffff0000, v21
    v_mul_f32 v98, v98, v40
    v_mul_f32 v99, v99, v41
    v_cvt_pk_bf16_f32 v37, v98, v99
    v_lshlrev_b32 v98, 16, v37
    v_and_b32 v99, 0xffff0000, v37
    v_lshlrev_b32 v40, 16, v29
    v_and_b32 v41, 0xffff0000, v29
    v_add_f32 v98, v98, v40
    v_add_f32 v99, v99, v41
    v_cvt_pk_bf16_f32 v21, v98, v99
    v_lshlrev_b32 v100, 16, v38
    v_mul_f32 v40, s57, v100
    v_exp_f32 v40, v40
    s_nop 0
    v_add_f32 v40, 1.0, v40
    v_rcp_f32 v40, v40
    s_nop 0
    v_mul_f32 v100, v100, v40
    v_and_b32 v101, 0xffff0000, v38
    v_mul_f32 v41, s57, v101
    v_exp_f32 v41, v41
    s_nop 0
    v_add_f32 v41, 1.0, v41
    v_rcp_f32 v41, v41
    s_nop 0
    v_mul_f32 v101, v101, v41
    v_cvt_pk_bf16_f32 v38, v100, v101
    v_lshlrev_b32 v100, 16, v38
    v_and_b32 v101, 0xffff0000, v38
    v_lshlrev_b32 v40, 16, v22
    v_and_b32 v41, 0xffff0000, v22
    v_mul_f32 v100, v100, v40
    v_mul_f32 v101, v101, v41
    v_cvt_pk_bf16_f32 v38, v100, v101
    v_lshlrev_b32 v100, 16, v38
    v_and_b32 v101, 0xffff0000, v38
    v_lshlrev_b32 v40, 16, v30
    v_and_b32 v41, 0xffff0000, v30
    v_add_f32 v100, v100, v40
    v_add_f32 v101, v101, v41
    v_cvt_pk_bf16_f32 v22, v100, v101
    v_lshlrev_b32 v102, 16, v39
    v_mul_f32 v40, s57, v102
    v_exp_f32 v40, v40
    s_nop 0
    v_add_f32 v40, 1.0, v40
    v_rcp_f32 v40, v40
    s_nop 0
    v_mul_f32 v102, v102, v40
    v_and_b32 v103, 0xffff0000, v39
    v_mul_f32 v41, s57, v103
    v_exp_f32 v41, v41
    s_nop 0
    v_add_f32 v41, 1.0, v41
    v_rcp_f32 v41, v41
    s_nop 0
    v_mul_f32 v103, v103, v41
    v_cvt_pk_bf16_f32 v39, v102, v103
    v_lshlrev_b32 v102, 16, v39
    v_and_b32 v103, 0xffff0000, v39
    v_lshlrev_b32 v40, 16, v23
    v_and_b32 v41, 0xffff0000, v23
    v_mul_f32 v102, v102, v40
    v_mul_f32 v103, v103, v41
    v_cvt_pk_bf16_f32 v39, v102, v103
    v_lshlrev_b32 v102, 16, v39
    v_and_b32 v103, 0xffff0000, v39
    v_lshlrev_b32 v40, 16, v31
    v_and_b32 v41, 0xffff0000, v31
    v_add_f32 v102, v102, v40
    v_add_f32 v103, v103, v41
    v_cvt_pk_bf16_f32 v23, v102, v103
    buffer_store_dwordx4 v[20:23], v240, s[16:19], 0 offen offset:0
    v_cvt_pk_bf16_f32 v36, v104, v105
    v_cvt_pk_bf16_f32 v37, v106, v107
    v_cvt_pk_bf16_f32 v38, v108, v109
    v_cvt_pk_bf16_f32 v39, v110, v111
    s_nop 1
    v_permlane32_swap_b32 v36, v38
    v_permlane32_swap_b32 v37, v39
    v_lshlrev_b32 v104, 16, v36
    v_mul_f32 v40, s57, v104
    v_exp_f32 v40, v40
    s_nop 0
    v_add_f32 v40, 1.0, v40
    v_rcp_f32 v40, v40
    s_nop 0
    v_mul_f32 v104, v104, v40
    v_and_b32 v105, 0xffff0000, v36
    v_mul_f32 v41, s57, v105
    v_exp_f32 v41, v41
    s_nop 0
    v_add_f32 v41, 1.0, v41
    v_rcp_f32 v41, v41
    s_nop 0
    v_mul_f32 v105, v105, v41
    v_cvt_pk_bf16_f32 v36, v104, v105
    v_lshlrev_b32 v104, 16, v36
    v_and_b32 v105, 0xffff0000, v36
    v_lshlrev_b32 v40, 16, v24
    v_and_b32 v41, 0xffff0000, v24
    v_mul_f32 v104, v104, v40
    v_mul_f32 v105, v105, v41
    v_cvt_pk_bf16_f32 v36, v104, v105
    v_lshlrev_b32 v104, 16, v36
    v_and_b32 v105, 0xffff0000, v36
    v_lshlrev_b32 v40, 16, v32
    v_and_b32 v41, 0xffff0000, v32
    v_add_f32 v104, v104, v40
    v_add_f32 v105, v105, v41
    v_cvt_pk_bf16_f32 v24, v104, v105
    v_lshlrev_b32 v106, 16, v37
    v_mul_f32 v40, s57, v106
    v_exp_f32 v40, v40
    s_nop 0
    v_add_f32 v40, 1.0, v40
    v_rcp_f32 v40, v40
    s_nop 0
    v_mul_f32 v106, v106, v40
    v_and_b32 v107, 0xffff0000, v37
    v_mul_f32 v41, s57, v107
    v_exp_f32 v41, v41
    s_nop 0
    v_add_f32 v41, 1.0, v41
    v_rcp_f32 v41, v41
    s_nop 0
    v_mul_f32 v107, v107, v41
    v_cvt_pk_bf16_f32 v37, v106, v107
    v_lshlrev_b32 v106, 16, v37
    v_and_b32 v107, 0xffff0000, v37
    v_lshlrev_b32 v40, 16, v25
    v_and_b32 v41, 0xffff0000, v25
    v_mul_f32 v106, v106, v40
    v_mul_f32 v107, v107, v41
    v_cvt_pk_bf16_f32 v37, v106, v107
    v_lshlrev_b32 v106, 16, v37
    v_and_b32 v107, 0xffff0000, v37
    v_lshlrev_b32 v40, 16, v33
    v_and_b32 v41, 0xffff0000, v33
    v_add_f32 v106, v106, v40
    v_add_f32 v107, v107, v41
    v_cvt_pk_bf16_f32 v25, v106, v107
    v_lshlrev_b32 v108, 16, v38
    v_mul_f32 v40, s57, v108
    v_exp_f32 v40, v40
    s_nop 0
    v_add_f32 v40, 1.0, v40
    v_rcp_f32 v40, v40
    s_nop 0
    v_mul_f32 v108, v108, v40
    v_and_b32 v109, 0xffff0000, v38
    v_mul_f32 v41, s57, v109
    v_exp_f32 v41, v41
    s_nop 0
    v_add_f32 v41, 1.0, v41
    v_rcp_f32 v41, v41
    s_nop 0
    v_mul_f32 v109, v109, v41
    v_cvt_pk_bf16_f32 v38, v108, v109
    v_lshlrev_b32 v108, 16, v38
    v_and_b32 v109, 0xffff0000, v38
    v_lshlrev_b32 v40, 16, v26
    v_and_b32 v41, 0xffff0000, v26
    v_mul_f32 v108, v108, v40
    v_mul_f32 v109, v109, v41
    v_cvt_pk_bf16_f32 v38, v108, v109
    v_lshlrev_b32 v108, 16, v38
    v_and_b32 v109, 0xffff0000, v38
    v_lshlrev_b32 v40, 16, v34
    v_and_b32 v41, 0xffff0000, v34
    v_add_f32 v108, v108, v40
    v_add_f32 v109, v109, v41
    v_cvt_pk_bf16_f32 v26, v108, v109
    v_lshlrev_b32 v110, 16, v39
    v_mul_f32 v40, s57, v110
    v_exp_f32 v40, v40
    s_nop 0
    v_add_f32 v40, 1.0, v40
    v_rcp_f32 v40, v40
    s_nop 0
    v_mul_f32 v110, v110, v40
    v_and_b32 v111, 0xffff0000, v39
    v_mul_f32 v41, s57, v111
    v_exp_f32 v41, v41
    s_nop 0
    v_add_f32 v41, 1.0, v41
    v_rcp_f32 v41, v41
    s_nop 0
    v_mul_f32 v111, v111, v41
    v_cvt_pk_bf16_f32 v39, v110, v111
    v_lshlrev_b32 v110, 16, v39
    v_and_b32 v111, 0xffff0000, v39
    v_lshlrev_b32 v40, 16, v27
    v_and_b32 v41, 0xffff0000, v27
    v_mul_f32 v110, v110, v40
    v_mul_f32 v111, v111, v41
    v_cvt_pk_bf16_f32 v39, v110, v111
    v_lshlrev_b32 v110, 16, v39
    v_and_b32 v111, 0xffff0000, v39
    v_lshlrev_b32 v40, 16, v35
    v_and_b32 v41, 0xffff0000, v35
    v_add_f32 v110, v110, v40
    v_add_f32 v111, v111, v41
    v_cvt_pk_bf16_f32 v27, v110, v111
    buffer_store_dwordx4 v[24:27], v240, s[16:19], 0 offen offset:32
    s_waitcnt vmcnt(0)
L_k4_end:
    s_endpgm
.section .rodata,"a"
.p2align 6
.amdhsa_kernel attn_kernel
  .amdhsa_next_free_vgpr 496
  .amdhsa_next_free_sgpr 100
  .amdhsa_accum_offset 256
  .amdhsa_group_segment_fixed_size 0
  .amdhsa_kernarg_size 104
  .amdhsa_user_sgpr_count 2
  .amdhsa_user_sgpr_kernarg_segment_ptr 1
  .amdhsa_system_sgpr_workgroup_id_x 1
.end_amdhsa_kernel
.p2align 6
.amdhsa_kernel fin_kernel
  .amdhsa_next_free_vgpr 256
  .amdhsa_next_free_sgpr 100
  .amdhsa_accum_offset 256
  .amdhsa_group_segment_fixed_size 0
  .amdhsa_kernarg_size 104
  .amdhsa_user_sgpr_count 2
  .amdhsa_user_sgpr_kernarg_segment_ptr 1
  .amdhsa_system_sgpr_workgroup_id_x 1
.end_amdhsa_kernel
```
